```python
import torch

def _softmax(x, axis=-1):
    return torch.softmax(x, dim=axis)
def _gelu(x):
    return torch.nn.functional.gelu(x, approximate="tanh")
def _silu(x):
    return torch.nn.functional.silu(x)
def _sigmoid(x):
    return torch.sigmoid(x)
def _layernorm(x, axis=-1, eps=1e-5):
    m = x.mean(dim=axis, keepdim=True)
    v = x.var(dim=axis, keepdim=True, unbiased=False)
    return (x - m) / torch.sqrt(v + eps)
def _scatter_add(tgt, idx, src, axis=0):
    return tgt.clone().index_add_(axis, idx, src)
def _segment_sum(src, seg, n):
    out = torch.zeros((n,) + src.shape[1:], dtype=src.dtype)
    return out.index_add_(0, seg, src)
def _pad(x, pw):
    flat = tuple(v for pair in reversed(pw) for v in pair)
    return torch.nn.functional.pad(x, flat)

kernel_name = 'interleave_layers__ssm_conv_s4d__glu_gated_bilinear__prompt'

def setup_inputs():

    _w = (lambda a: (lambda t: t.to(torch.bfloat16) if t.is_floating_point() else t)(torch.as_tensor(a)))
    def _A_setup():
        Bsz, L, D, N = 1, 2048, 512, 128
        return {
            "u": _w((lambda *s: torch.randn(*s, dtype=torch.bfloat16) * 0.05)(Bsz, L, D)),
            "log_A_real": _w((lambda *s: torch.randn(*s, dtype=torch.bfloat16) * 3.2)(D, N) * 0.5),
            "A_imag": _w((lambda *s: torch.randn(*s, dtype=torch.bfloat16) * 0.05)(D, N) * 3.14),
            "C_real": _w((lambda *s: torch.randn(*s, dtype=torch.bfloat16) * 0.05)(D, N) / N ** 0.5),
            "C_imag": _w((lambda *s: torch.randn(*s, dtype=torch.bfloat16) * 0.05)(D, N) / N ** 0.5),
            "log_dt": _w((lambda *s: torch.randn(*s, dtype=torch.bfloat16) * 0.05)(D) * 0.5 - 4.0),
            "D_skip": _w((lambda *s: torch.randn(*s, dtype=torch.bfloat16) * 0.05)(D)),
        }
    _A_in = _A_setup()

    def _B_setup():
        B, S, D, F = 1, 2048, 512, 1376
        return {
            "x": _w((lambda *s: torch.randn(*s, dtype=torch.bfloat16) * 0.05)(B, S, D)),
            "w_gate": _w((lambda *s: torch.randn(*s, dtype=torch.bfloat16) * 0.4)(D, F) * (D ** -0.5)),
            "w_up": _w((lambda *s: torch.randn(*s, dtype=torch.bfloat16) * 0.4)(D, F) * (D ** -0.5)),
            "w_down": _w((lambda *s: torch.randn(*s, dtype=torch.bfloat16) * 0.4)(F, D) * (F ** -0.5)),
        }
    _B_in = _B_setup()

    return {
        "A_u": _A_in["u"],
        "A_log_A_real": _A_in["log_A_real"],
        "A_A_imag": _A_in["A_imag"],
        "A_C_real": _A_in["C_real"],
        "A_C_imag": _A_in["C_imag"],
        "A_log_dt": _A_in["log_dt"],
        "A_D_skip": _A_in["D_skip"],
        "B_x": _B_in["x"],
        "B_w_gate": _B_in["w_gate"],
        "B_w_up": _B_in["w_up"],
        "B_w_down": _B_in["w_down"],
    }

def reference(A_u, A_log_A_real, A_A_imag, A_C_real, A_C_imag, A_log_dt, A_D_skip, B_x, B_w_gate, B_w_up, B_w_down):
    def _A_ref(u, log_A_real, A_imag, C_real, C_imag, log_dt, D_skip):
        L = u.shape[1]
        dt = torch.exp(log_dt)
        A = -torch.exp(log_A_real) + 1j * A_imag
        C = (C_real + 1j * C_imag) * dt[:, None]
        pos = (lambda x, dt: x.to(dt))(torch.arange(L), log_dt.dtype)
        P = torch.exp((A * dt[:, None])[:, :, None] * pos[None, None, :])
        K = 2.0 * torch.einsum("dn,dnl->dl", C, P).real
        L2 = 2 * L
        u_t = (lambda x, *d: x.permute(*d))(u, 0, 2, 1)
        Kf = (lambda x, *a, **k: torch.fft.rfft(x.float(), *a, **k))(K, L2)
        Uf = (lambda x, *a, **k: torch.fft.rfft(x.float(), *a, **k))(u_t, L2)
        y = (lambda x, *a, **k: torch.fft.irfft(x, *a, **k).to(torch.bfloat16))(Uf * Kf[None, :, :], L2)[:, :, :L]
        y = (lambda x, *d: x.permute(*d))(y, 0, 2, 1)
        return y + u * D_skip[None, None, :]

    def _B_ref(x, w_gate, w_up, w_down):
        g = torch.einsum("bsd,df->bsf", x, w_gate)
        u = torch.einsum("bsd,df->bsf", x, w_up)
        h = g * u
        return torch.einsum("bsf,fd->bsd", h, w_down)

    x = A_u
    x = x + _A_ref(_layernorm(x, axis=-1), A_log_A_real, A_A_imag, A_C_real, A_C_imag, A_log_dt, A_D_skip)
    x = x + _B_ref(_layernorm(x, axis=-1), B_w_gate, B_w_up, B_w_down)
    x = x + _A_ref(_layernorm(x, axis=-1), A_log_A_real, A_A_imag, A_C_real, A_C_imag, A_log_dt, A_D_skip)
    x = x + _B_ref(_layernorm(x, axis=-1), B_w_gate, B_w_up, B_w_down)
    return x
```

```asm
; @launch kernel=mega_kernel grid=(256,1,1) block=(256,1,1) lds=163840
.amdgcn_target "amdgcn-amd-amdhsa--gfx950"
.text
.globl mega_kernel
.p2align 12
.type mega_kernel,@function
mega_kernel:
  s_load_dwordx16 s[8:23], s[0:1], 0
  s_load_dwordx8 s[24:31], s[0:1], 64
  s_load_dwordx4 s[4:7], s[0:1], 96
  s_getpc_b64 s[56:57]
mega_pc:
  s_and_b32 s3, s2, 0xf8
  v_and_b32 v6, 15, v0
  v_lshlrev_b32 v6, 7, v6
  v_lshl_add_u32 v6, s3, 8, v6
  v_min_u32 v6, mega_cend-mega_pc-4, v6
  global_load_dword v226, v6, s[56:57]
  s_cmp_ge_u32 s2, 256
  s_cbranch_scc1 mega_end
  v_lshrrev_b32 v6, 6, v0
  v_and_b32 v7, 63, v0
  s_and_b32 s54, s2, 7
  v_readfirstlane_b32 s3, v6
  s_lshr_b32 s55, s2, 3
  s_lshr_b32 s32, s54, 1
  s_lshl_b32 s32, s32, 2
  s_and_b32 s100, s55, 3
  s_add_u32 s32, s32, s100
  s_and_b32 s34, s54, 1
  s_lshr_b32 s35, s55, 2
  s_xor_b32 s35, s35, 3
  s_lshl_b32 s33, s34, 3
  s_add_u32 s33, s33, s35
  s_lshl_b32 s36, s54, 5
  s_add_u32 s36, s36, s55
  s_lshl2_add_u32 s51, s36, s3
  s_lshl_b32 s52, s51, 11
  v_lshl_add_u32 v60, v7, 4, s52
  s_lshl_b32 s59, s36, 5
  s_and_b32 s52, s59, 0x1000
  s_add_u32 s59, s59, s52
  s_add_u32 s59, s59, 19922944
  s_lshr_b32 s53, s3, 1
  s_lshl_b32 s51, s36, 1
  s_add_u32 s51, s51, s53
  v_and_b32 v5, 127, v0
  s_lshl_b32 s52, s51, 8
  v_lshl_add_u32 v3, v5, 1, s52
  v_xor_b32 v2, 256, v3
  s_lshl_b32 s52, s51, 1
  v_mov_b32 v4, s52
  v_xor_b32 v1, 2, v4
  s_lshl_b32 s52, s36, 2
  s_lshl_b32 s53, s53, 15
  s_sub_u32 s51, 131072, s53
  v_lshl_add_u32 v68, v5, 4, s51
  s_add_u32 s51, s53, 98304
  v_lshl_add_u32 v69, v5, 4, s51
  v_add_u32 v20, 0, v7
  v_mul_u32_u24 v21, 43691, v20
  v_lshrrev_b32 v21, 19, v21
  v_mul_u32_u24 v22, 12, v21
  v_sub_u32 v20, v20, v22
  v_and_b32 v22, 4, v21
  v_mul_u32_u24 v21, 2752, v21
  v_lshlrev_b32 v22, 3, v22
  v_lshlrev_b32 v20, 4, v20
  v_xor_b32 v20, v20, v22
  v_xor_b32 v22, 16, v20
  v_min_u32 v20, 160, v20
  v_min_u32 v22, 160, v22
  v_add_u32 v212, v20, v21
  v_add_u32 v194, v22, v21
  v_add_u32 v20, 64, v7
  v_mul_u32_u24 v21, 43691, v20
  v_lshrrev_b32 v21, 19, v21
  v_mul_u32_u24 v22, 12, v21
  v_sub_u32 v20, v20, v22
  v_and_b32 v22, 4, v21
  v_mul_u32_u24 v21, 2752, v21
  v_lshlrev_b32 v22, 3, v22
  v_add_u32 v21, -1024, v21
  v_lshlrev_b32 v20, 4, v20
  v_xor_b32 v20, v20, v22
  v_xor_b32 v22, 16, v20
  v_min_u32 v20, 160, v20
  v_min_u32 v22, 160, v22
  v_add_u32 v213, v20, v21
  v_add_u32 v195, v22, v21
  v_add_u32 v20, 128, v7
  v_mul_u32_u24 v21, 43691, v20
  v_lshrrev_b32 v21, 19, v21
  v_mul_u32_u24 v22, 12, v21
  v_sub_u32 v20, v20, v22
  v_and_b32 v22, 4, v21
  v_mul_u32_u24 v21, 2752, v21
  v_lshlrev_b32 v22, 3, v22
  v_add_u32 v21, -2048, v21
  v_lshlrev_b32 v20, 4, v20
  v_xor_b32 v20, v20, v22
  v_xor_b32 v22, 16, v20
  v_min_u32 v20, 160, v20
  v_min_u32 v22, 160, v22
  v_add_u32 v214, v20, v21
  v_add_u32 v196, v22, v21
  s_mul_i32 s58, s3, 6144
  v_mov_b32 v8, 0x80000000
  s_mul_i32 s51, s36, 7
  v_add_u32 v20, s51, v0
  v_mov_b32 v21, 35651584
  v_cmp_gt_u32 vcc, 1536, v20
  v_lshl_add_u32 v21, v20, 8, v21
  v_lshrrev_b32 v22, 5, v0
  v_mov_b32 v58, 32
  v_cndmask_b32 v58, 16, v58, vcc
  v_cmp_gt_u32 vcc, 7, v0
  s_lshl_b32 s51, s36, 7
  s_add_u32 s51, s51, 19955712
  v_cndmask_b32 v59, v8, v21, vcc
  v_cmp_eq_u32 vcc, 2, v22
  v_lshl_add_u32 v21, v7, 2, s51
  s_nop 0
  v_cndmask_b32 v59, v59, v21, vcc
  v_cndmask_b32 v58, v58, 0, vcc
  s_and_b32 s51, s2, 31
  s_lshl_b32 s51, s51, 11
  v_lshl_add_u32 v62, v0, 8, s51
  v_cmp_gt_u32 vcc, 8, v0
  s_mov_b32 s37, 36175872
  s_nop 0
  v_cndmask_b32 v62, v8, v62, vcc
  s_waitcnt lgkmcnt(0)
  global_load_dwordx4 v[96:99], v60, s[8:9] offset:0
  global_load_dwordx4 v[100:103], v60, s[8:9] offset:1024
  global_load_short_d16_hi v148, v4, s[18:19]
  global_load_short_d16_hi v144, v3, s[10:11]
  global_load_short_d16_hi v145, v3, s[12:13]
  global_load_short_d16_hi v72, v1, s[18:19]
  global_load_short_d16_hi v70, v2, s[10:11]
  global_load_short_d16_hi v71, v2, s[12:13]
  global_load_short_d16_hi v146, v3, s[14:15]
  global_load_short_d16_hi v147, v3, s[16:17]
  s_load_dword s44, s[20:21], s52
  s_mov_b32 s20, s24
  s_mov_b32 s21, s25
  s_mov_b32 s22, 1409024
  s_mov_b32 s23, 0x20000
  s_mov_b32 s16, s26
  s_mov_b32 s17, s27
  s_mov_b32 s18, 1409024
  s_mov_b32 s19, 0x20000
  s_mov_b32 s96, s4
  s_mov_b32 s97, s5
  s_mov_b32 s98, 256
  s_mov_b32 s99, 0x20000
  s_mov_b32 s4, s6
  s_mov_b32 s5, s7
  s_mov_b32 s6, 56623104
  s_mov_b32 s7, 0x20000
  v_mov_b32 v142, 0
  buffer_atomic_add v142, v62, s[4:7], s37 offen sc0 sc1
  s_mov_b32 s24, s28
  s_mov_b32 s25, s29
  s_mov_b32 s26, 1409024
  s_mov_b32 s27, 0x20000
  s_mov_b32 s12, s30
  s_mov_b32 s13, s31
  s_mov_b32 s14, 2097152
  s_mov_b32 s15, 0x20000
  buffer_atomic_swap v58, v59, s[4:7], 0 offen sc1
  buffer_atomic_swap v58, v59, s[4:7], s14 offen sc1
  s_lshl3_add_u32 s31, s3, 49152
  v_mul_u32_u24 v61, 144, v7
  v_add_u32 v104, s31, v61
  v_lshrrev_b32 v61, 3, v0
  v_mul_u32_u24 v61, 144, v61
  v_and_b32 v63, 7, v0
  v_lshl_add_u32 v105, v63, 4, v61
  v_lshlrev_b32 v106, 4, v0
  v_lshrrev_b32 v107, 4, v0
  v_lshlrev_b32 v107, 2, v107
  v_cmp_gt_u32 vcc, 4, v0
  s_lshl_b32 s30, s36, 13
  s_add_u32 s30, s30, 14680064
  s_add_u32 s31, s30, 4096
  v_mul_u32_u24 v122, 0x1008, v0
  v_and_b32 v122, 0x1010, v122
  v_cndmask_b32 v122, v8, v122, vcc
  buffer_load_dword v227, v122, s[4:7], s59 offen
  s_mov_b32 s38, 2097152
  s_mov_b32 s40, 35651584
  s_mov_b32 s41, 36044800
  s_mov_b32 s46, 0x3b000000
  s_mov_b32 s47, 0x3b000000
  s_mov_b32 s48, 0x3727c5ac
  s_mov_b32 s49, 0x3727c5ac
  s_mov_b32 s50, 0x3f803f80
  v_mov_b32 v4, 1
  s_and_b32 s51, s55, 7
  s_lshl_b32 s51, s51, 8
  v_lshl_add_u32 v1, v0, 11, s51
  v_cmp_gt_u32 vcc, 32, v0
  s_and_b32 s51, s2, 7
  s_lshl_b32 s51, s51, 8
  v_xor_b32 v160, 192, v0
  v_cndmask_b32 v1, v8, v1, vcc
  v_cmp_gt_u32 vcc, 32, v160
  v_lshl_add_u32 v160, v160, 11, s51
  s_nop 0
  v_cndmask_b32 v160, v8, v160, vcc
  v_mov_b32 v3, v62
  v_and_b32 v9, 15, v7
  v_lshrrev_b32 v31, 2, v7
  v_mul_u32_u24 v19, 192, v31
  s_lshl_b32 s51, s3, 5
  s_lshl3_add_u32 s53, s3, 0x80000
  s_bfe_u32 s53, 0x48508080, s53
  v_add_u32 v19, s51, v19
  v_and_b32 v32, 3, v7
  v_lshlrev_b32 v35, 1, v7
  v_lshl_add_u32 v215, v32, 3, v19
  v_and_b32 v35, 32, v35
  v_and_b32 v36, 1, v7
  v_xor_b32 v215, v35, v215
  v_mul_u32_u24 v33, 3072, v36
  v_bfe_u32 v34, v7, 1, 1
  v_lshl_add_u32 v35, v36, 4, v35
  v_lshl_add_u32 v33, v34, 3, v33
  v_xor_b32 v197, 16, v215
  v_add3_u32 v216, v33, v19, s53
  v_add_u32 v217, 49152, v215
  v_xor_b32 v216, v35, v216
  v_and_b32 v33, 0x42, v0
  v_mov_b32 v35, 176
  v_cmp_eq_u32 vcc, 0x42, v33
  v_and_b32 v225, 7, v0
  v_mul_u32_u24 v225, 6144, v225
  v_cndmask_b32 v216, v216, v35, vcc
  v_add_u32 v225, v35, v225
  v_add_u32 v198, 49152, v197
  v_add_u32 v218, 49152, v216
  v_mul_u32_u24 v34, 2176, v34
  v_lshl_add_u32 v34, v31, 4, v34
  v_lshl_add_u32 v158, v36, 3, v34
  s_mul_i32 s42, s33, 176
  s_mul_i32 s51, s3, 44032
  s_add_u32 s42, s42, s51
  v_mov_b32 v228, s50
  v_mov_b32 v229, s50
  v_mov_b32 v230, s50
  v_mov_b32 v231, s50
  s_lshr_b32 s57, s2, 2
  s_bitcmp1_b32 0x66666666, s57
  s_cselect_b32 s57, 1, -1
  s_lshl_b32 s51, s2, 29
  s_and_b32 s51, s51, 0x80000000
  s_xor_b32 s52, s51, 0x80000000
  v_or_b32 v199, s52, v160
  v_or_b32 v160, s51, v160
  s_lshr_b32 s8, s2, 3
  s_and_b32 s10, s2, 3
  s_lshl2_add_u32 s8, s8, s10
  s_lshl2_add_u32 s8, s8, s3
  v_and_b32 v202, 63, v0
  s_mul_i32 s8, s8, 2816
  s_add_u32 s8, s8, 0
  s_bitcmp1_b32 s2, 2
  s_cselect_b32 s8, s8, 0x80000000
  v_lshl_add_u32 v202, v202, 7, s8
  s_mov_b64 exec, 0x3fffff
  buffer_load_dword v203, v202, s[20:23], 0 offen
  buffer_load_dword v202, v202, s[16:19], 0 offen
  s_mov_b64 exec, -1
  v_lshlrev_b32 v15, 3, v0
  v_sub_u32 v15, 2047, v15
  v_cvt_f32_i32 v21, v15
  v_mov_b32 v15, 98304
  v_mov_b32 v40, 135168
  v_cmp_ne_u32 vcc, 255, v0
  v_add_f32 v22, -1.0, v21
  v_add_f32 v23, -2.0, v21
  v_add_f32 v24, -2.0, v22
  v_add_f32 v25, -4.0, v21
  v_add_f32 v26, -4.0, v22
  v_add_f32 v27, -4.0, v23
  v_add_f32 v28, -4.0, v24
  v_add_f32 v29, -4.0, v25
  v_cvt_pk_bf16_f32 v32, v21, v22
  v_cvt_pk_bf16_f32 v33, v23, v24
  v_cvt_pk_bf16_f32 v34, v25, v26
  v_cvt_pk_bf16_f32 v35, v27, v28
  v_cvt_pk_bf16_f32 v36, v29, v29
  v_lshlrev_b32 v21, 16, v32
  v_and_b32 v22, 0xffff0000, v32
  v_lshlrev_b32 v23, 16, v33
  v_and_b32 v24, 0xffff0000, v33
  v_lshlrev_b32 v25, 16, v34
  v_and_b32 v26, 0xffff0000, v34
  v_lshlrev_b32 v27, 16, v35
  v_and_b32 v28, 0xffff0000, v35
  v_lshlrev_b32 v29, 16, v36
  v_mul_f32 v21, 0x3f840000, v21
  v_mul_f32 v22, 0x3f840000, v22
  v_mul_f32 v23, 0x3f840000, v23
  v_mul_f32 v24, 0x3f840000, v24
  v_mul_f32 v25, 0x3f840000, v25
  v_mul_f32 v26, 0x3f840000, v26
  v_mul_f32 v27, 0x3f840000, v27
  v_mul_f32 v28, 0x3f840000, v28
  v_mul_f32 v29, 0x3f840000, v29
  v_cvt_u32_f32 v21, v21
  v_cvt_u32_f32 v22, v22
  v_cvt_u32_f32 v23, v23
  v_cvt_u32_f32 v24, v24
  v_cvt_u32_f32 v25, v25
  v_cvt_u32_f32 v26, v26
  v_cvt_u32_f32 v27, v27
  v_cvt_u32_f32 v28, v28
  v_cvt_u32_f32 v29, v29
  v_lshl_add_u32 v21, v21, 2, v15
  v_lshl_add_u32 v22, v22, 2, v15
  v_lshl_add_u32 v23, v23, 2, v15
  v_lshl_add_u32 v24, v24, 2, v15
  v_lshl_add_u32 v25, v25, 2, v15
  v_lshl_add_u32 v26, v26, 2, v15
  v_lshl_add_u32 v27, v27, 2, v15
  v_lshl_add_u32 v28, v28, 2, v15
  v_lshl_add_u32 v29, v29, 2, v15
  v_cndmask_b32 v29, v40, v29, vcc
  v_mov_b32 v33, 0x10000
  v_mov_b32 v35, 0x1000204
  s_mov_b32 exec_lo, 0xffff0000
  v_mov_b32 v33, 0x10004
  v_mov_b32 v35, 0x1000600
  s_mov_b32 exec_lo, 0
  v_mov_b32 v33, 0x20100
  s_mov_b32 exec_hi, 0xffff0000
  v_mov_b32 v33, 0x1000200
  s_mov_b64 exec, -1
  s_and_b32 s51, s3, 1
  s_lshr_b32 s52, s3, 1
  s_lshl_b32 s53, s51, 7
  s_lshl1_add_u32 s54, s52, 98304
  v_and_b32 v34, 0xffff, v33
  v_lshrrev_b32 v33, 16, v33
  v_lshl_add_u32 v34, v9, 3, v34
  v_add_u32 v132, s53, v34
  v_add_u32 v133, v132, v33
  v_add_u32 v134, v133, v33
  v_add_u32 v135, v134, v33
  v_lshrrev_b32 v40, 5, v132
  v_lshrrev_b32 v41, 5, v133
  v_lshrrev_b32 v42, 5, v134
  v_lshrrev_b32 v43, 5, v135
  v_add_u32 v132, v40, v132
  v_add_u32 v133, v41, v133
  v_add_u32 v134, v42, v134
  v_add_u32 v135, v43, v135
  v_lshl_add_u32 v132, v132, 2, s54
  v_lshl_add_u32 v133, v133, 2, s54
  v_lshl_add_u32 v134, v134, 2, s54
  v_lshl_add_u32 v135, v135, 2, s54
  v_and_b32 v34, 0xffff, v35
  v_lshrrev_b32 v35, 16, v35
  v_lshl_add_u32 v34, v9, 3, v34
  v_add_u32 v136, s53, v34
  v_add_u32 v137, v136, v35
  v_add_u32 v138, v137, v35
  v_add_u32 v139, v138, v35
  v_lshrrev_b32 v40, 5, v136
  v_lshrrev_b32 v41, 5, v137
  v_lshrrev_b32 v42, 5, v138
  v_lshrrev_b32 v43, 5, v139
  v_add_u32 v136, v40, v136
  v_add_u32 v137, v41, v137
  v_add_u32 v138, v42, v138
  v_add_u32 v139, v43, v139
  v_lshl_add_u32 v136, v136, 2, s54
  v_lshl_add_u32 v137, v137, 2, s54
  v_lshl_add_u32 v138, v138, 2, s54
  v_lshl_add_u32 v139, v139, 2, s54
  s_lshl_b32 s52, s52, 15
  s_sub_u32 s52, 131072, s52
  v_add_u32 v158, s52, v158
  s_mul_i32 s51, s51, 4352
  v_add_u32 v159, s51, v158
  s_lshl_b32 s51, s36, 5
  s_add_u32 s51, s51, 14680064
  v_lshrrev_b32 v33, 1, v0
  s_mov_b64 exec, 0
  s_cmp_eq_u32 s3, 0
  s_cbranch_scc1 wpad_0_0
  s_cmp_eq_u32 s3, 1
  s_cbranch_scc1 wpad_0_1
  s_cmp_eq_u32 s3, 2
  s_cbranch_scc1 wpad_0_2
  s_branch wpad_0_3
wret_0:
  s_mov_b64 exec, -1
  v_and_b32 v34, 1, v0
  v_lshl_add_u32 v33, v33, 13, s51
  v_add_u32 v162, 19922944, v106
  v_lshl_add_u32 v161, v34, 4, v33
  v_add_u32 v163, 19927040, v106
  s_mul_i32 s52, s3, 4160
  s_add_u32 s52, s52, 135168
  v_lshl_add_u32 v164, v9, 2, s52
  s_lshr_b32 s52, s3, 1
  s_mul_i32 s52, s52, 4096
  s_add_u32 s52, s52, 147712
  v_lshl_add_u32 v165, v0, 2, s52
  v_mov_b32 v166, 0
  v_add_u32 v167, 131072, v106
  v_mov_b32 v169, 158720
  v_cmp_gt_u32 vcc, 8, v0
  v_lshl_add_u32 v168, v0, 2, v169
  v_add_u32 v12, 114688, v106
  v_cndmask_b32 v143, 0, 32, vcc
  s_lshr_b32 s51, s3, 1
  s_and_b32 s52, s3, 1
  v_and_b32 v16, 15, v0
  v_bfe_u32 v17, v0, 4, 2
  v_or_b32 v18, 1, v16
  v_lshlrev_b32 v18, 1, v18
  v_lshlrev_b32 v19, 4, v17
  v_sub_u32 v18, v19, v18
  v_and_b32 v20, 1, v16
  v_mul_u32_u24 v20, 4160, v20
  v_sub_u32 v18, v18, v20
  s_mul_i32 s53, s51, 8320
  s_lshl_b32 s54, s52, 8
  s_sub_u32 s53, s53, s54
  s_add_u32 s53, s53, 137566
  v_add_u32 v8, s53, v18
  v_add_u32 v9, 1024, v8
  v_lshl_add_u32 v18, v16, 5, v19
  s_mul_i32 s53, s51, 4608
  s_sub_u32 s53, s53, s54
  s_add_u32 s53, s53, 148000
  v_add_u32 v140, s53, v18
  v_mov_b32 v20, 148224
  v_lshl_add_u32 v141, v0, 3, v20
  v_lshl_add_u32 v18, v16, 6, v19
  s_lshl_b32 s53, s3, 11
  s_add_u32 s53, s53, 114688
  v_add_u32 v13, s53, v18
  v_and_b32 v18, 63, v0
  s_add_u32 s53, s53, 8192
  v_lshl_add_u32 v14, v18, 4, s53
  v_and_b32 v18, 1, v17
  v_lshrrev_b32 v19, 2, v16
  v_lshl_add_u32 v18, v18, 2, v19
  v_lshlrev_b32 v18, 17, v18
  v_and_b32 v19, 3, v16
  v_lshl_add_u32 v18, v19, 5, v18
  v_lshrrev_b32 v19, 1, v17
  v_lshl_add_u32 v15, v19, 4, v18
  v_add_u32 v6, -2048, v8
  v_add_u32 v7, -1024, v8
  s_waitcnt vmcnt(14)
  ds_write2_b32 v104, v96, v100 offset0:0 offset1:1
  ds_write2_b32 v104, v97, v101 offset0:8 offset1:9
  ds_write2_b32 v104, v98, v102 offset0:16 offset1:17
  ds_write2_b32 v104, v99, v103 offset0:24 offset1:25
  v_dot2_f32_bf16 v116, v96, s50, 0
  v_dot2_f32_bf16 v117, v96, v96, 0
  v_dot2_f32_bf16 v118, v100, s50, 0
  v_dot2_f32_bf16 v119, v100, v100, 0
  v_dot2_f32_bf16 v116, v97, s50, v116
  v_dot2_f32_bf16 v117, v97, v97, v117
  v_dot2_f32_bf16 v118, v101, s50, v118
  v_dot2_f32_bf16 v119, v101, v101, v119
  v_dot2_f32_bf16 v116, v98, s50, v116
  v_dot2_f32_bf16 v117, v98, v98, v117
  v_dot2_f32_bf16 v118, v102, s50, v118
  v_dot2_f32_bf16 v119, v102, v102, v119
  v_dot2_f32_bf16 v116, v99, s50, v116
  v_dot2_f32_bf16 v117, v99, v99, v117
  v_dot2_f32_bf16 v118, v103, s50, v118
  v_dot2_f32_bf16 v119, v103, v103, v119
  s_nop 1
  v_permlane32_swap_b32 v116, v118
  v_permlane32_swap_b32 v117, v119
  v_add_f32 v116, v116, v118
  v_add_f32 v117, v117, v119
  s_nop 1
  v_permlane16_swap_b32 v116, v117
  v_add_f32 v116, v116, v117
  s_nop 1
  v_add_f32_dpp v116, v116, v116 row_ror:8 row_mask:0xf bank_mask:0xf
  s_nop 1
  v_add_f32_dpp v116, v116, v116 row_ror:4 row_mask:0xf bank_mask:0xf
  s_nop 1
  v_add_f32_dpp v116, v116, v116 row_ror:2 row_mask:0xf bank_mask:0xf
  s_nop 1
  v_add_f32_dpp v116, v116, v116 row_ror:1 row_mask:0xf bank_mask:0xf
  ds_write_b32 v107, v116 offset:58368
  s_waitcnt lgkmcnt(0)
  s_barrier
  ds_read_b128 v[108:111], v105 offset:49152
  ds_read_b128 v[112:115], v105 offset:53760
  ds_read_b128 v[116:119], v105 offset:58368
  s_waitcnt lgkmcnt(2)
  buffer_store_dwordx4 v[108:111], v106, s[4:7], s30 offen sc1
  s_waitcnt lgkmcnt(1)
  buffer_store_dwordx4 v[112:115], v106, s[4:7], s31 offen sc1
  s_waitcnt lgkmcnt(0)
  buffer_store_dwordx4 v[116:119], v122, s[4:7], s59 offen sc1
  s_waitcnt vmcnt(9)
  v_mul_f32 v148, 0x3fb8aa3b, v148
  v_mul_f32 v72, 0x3fb8aa3b, v72
  v_mul_f32 v70, 0x3fb8aa3b, v70
  v_mul_f32 v144, 0x3fb8aa3b, v144
  v_exp_f32 v72, v72
  v_exp_f32 v148, v148
  v_exp_f32 v70, v70
  v_exp_f32 v144, v144
  v_cvt_pk_bf16_f32 v73, v72, v70
  v_cvt_pk_bf16_f32 v149, v148, v144
  v_lshlrev_b32 v72, 16, v73
  v_lshlrev_b32 v148, 16, v149
  v_and_b32 v70, 0xffff0000, v73
  v_and_b32 v144, 0xffff0000, v149
  v_mul_f32 v70, v70, v72
  v_mul_f32 v144, v144, v148
  v_mul_f32 v71, v71, v72
  v_mul_f32 v145, v145, v148
  v_mul_f32 v70, 0xbfb8aa3b, v70
  v_mul_f32 v144, 0xbfb8aa3b, v144
  v_mul_f32 v71, 0x3e22f983, v71
  v_mul_f32 v145, 0x3e22f983, v145
  v_mul_f32 v88, 0x41000000, v70
  v_exp_f32 v56, v144
  v_mul_f32 v89, 0x41000000, v71
  v_fract_f32 v57, v145
  v_exp_f32 v88, v88
  v_cos_f32 v30, v57
  v_fract_f32 v89, v89
  v_cos_f32 v76, v89
  v_sin_f32 v31, v57
  v_sin_f32 v77, v89
  v_pk_mul_f32 v[30:31], v[30:31], v[56:57] op_sel:[0,0] op_sel_hi:[1,0]
  v_pk_mul_f32 v[76:77], v[76:77], v[88:89] op_sel:[0,0] op_sel_hi:[1,0]
  v_mul_f32 v58, 0x43800000, v144
  v_pk_mul_f32 v[90:91], v[76:77], v[76:77] op_sel:[1,1] op_sel_hi:[1,0]
  v_mul_f32 v59, 0x43800000, v145
  v_pk_fma_f32 v[74:75], v[76:77], v[76:77], v[90:91] op_sel:[0,0,0] op_sel_hi:[0,1,1] neg_lo:[0,0,1]
  v_exp_f32 v58, v58
  v_cvt_pk_bf16_f32 v170, 1.0, v76
  v_fract_f32 v59, v59
  v_cvt_pk_bf16_f32 v174, 0, v77
  v_cos_f32 v32, v59
  v_pk_mul_f32 v[90:91], v[76:77], v[74:75] op_sel:[1,1] op_sel_hi:[1,0]
  v_sin_f32 v33, v59
  v_pk_fma_f32 v[80:81], v[76:77], v[74:75], v[90:91] op_sel:[0,0,0] op_sel_hi:[0,1,1] neg_lo:[0,0,1]
  v_pk_mul_f32 v[32:33], v[32:33], v[58:59] op_sel:[0,0] op_sel_hi:[1,0]
  v_cvt_pk_bf16_f32 v171, v74, v80
  v_add_f32 v148, v148, v148
  v_cvt_pk_bf16_f32 v175, v75, v81
  v_mul_f32 v34, v146, v148
  v_pk_mul_f32 v[88:89], v[74:75], v[74:75] op_sel:[1,1] op_sel_hi:[1,0]
  v_mul_f32 v35, v147, v148
  v_pk_fma_f32 v[82:83], v[74:75], v[74:75], v[88:89] op_sel:[0,0,0] op_sel_hi:[0,1,1] neg_lo:[0,0,1]
  v_pk_mul_f32 v[56:57], v[34:35], v[30:31] op_sel:[1,1] op_sel_hi:[1,0]
  v_pk_mul_f32 v[90:91], v[80:81], v[74:75] op_sel:[1,1] op_sel_hi:[1,0]
  v_pk_fma_f32 v[78:79], v[80:81], v[74:75], v[90:91] op_sel:[0,0,0] op_sel_hi:[0,1,1] neg_lo:[0,0,1]
  v_pk_fma_f32 v[36:37], v[34:35], v[30:31], v[56:57] op_sel:[0,0,0] op_sel_hi:[0,1,1] neg_lo:[0,0,1]
  v_cvt_pk_bf16_f32 v172, v82, v78
  v_pk_mul_f32 v[58:59], v[34:35], v[32:33] op_sel:[1,1] op_sel_hi:[1,0]
wpad_0_0:
  s_cbranch_execz wpad_0_4
  v_cvt_pk_bf16_f32 v176, v83, v79
  v_pk_fma_f32 v[54:55], v[34:35], v[32:33], v[58:59] op_sel:[0,0,0] op_sel_hi:[0,1,1] neg_lo:[0,0,1]
  v_pk_mul_f32 v[88:89], v[82:83], v[74:75] op_sel:[1,1] op_sel_hi:[1,0]
  v_cvt_pk_bf16_f32 v60, v34, v36
  v_pk_fma_f32 v[84:85], v[82:83], v[74:75], v[88:89] op_sel:[0,0,0] op_sel_hi:[0,1,1] neg_lo:[0,0,1]
  v_cvt_pk_bf16_f32 v64, -v35, -v37
  v_pk_mul_f32 v[90:91], v[78:79], v[74:75] op_sel:[1,1] op_sel_hi:[1,0]
  v_pk_mul_f32 v[56:57], v[36:37], v[30:31] op_sel:[1,1] op_sel_hi:[1,0]
  v_pk_fma_f32 v[80:81], v[78:79], v[74:75], v[90:91] op_sel:[0,0,0] op_sel_hi:[0,1,1] neg_lo:[0,0,1]
  v_pk_fma_f32 v[38:39], v[36:37], v[30:31], v[56:57] op_sel:[0,0,0] op_sel_hi:[0,1,1] neg_lo:[0,0,1]
  v_cvt_pk_bf16_f32 v173, v84, v80
  v_pk_mul_f32 v[58:59], v[54:55], v[32:33] op_sel:[1,1] op_sel_hi:[1,0]
  v_cvt_pk_bf16_f32 v177, v85, v81
  v_pk_fma_f32 v[52:53], v[54:55], v[32:33], v[58:59] op_sel:[0,0,0] op_sel_hi:[0,1,1] neg_lo:[0,0,1]
  ds_write_b128 v69, v[170:173] offset:13056
  ds_write_b128 v69, v[174:177] offset:21760
  v_pk_mul_f32 v[56:57], v[38:39], v[30:31] op_sel:[1,1] op_sel_hi:[1,0]
  v_pk_mul_f32 v[88:89], v[84:85], v[74:75] op_sel:[1,1] op_sel_hi:[1,0]
  v_pk_fma_f32 v[40:41], v[38:39], v[30:31], v[56:57] op_sel:[0,0,0] op_sel_hi:[0,1,1] neg_lo:[0,0,1]
  v_pk_fma_f32 v[82:83], v[84:85], v[74:75], v[88:89] op_sel:[0,0,0] op_sel_hi:[0,1,1] neg_lo:[0,0,1]
  v_pk_mul_f32 v[58:59], v[52:53], v[32:33] op_sel:[1,1] op_sel_hi:[1,0]
  v_pk_mul_f32 v[90:91], v[80:81], v[74:75] op_sel:[1,1] op_sel_hi:[1,0]
  v_pk_fma_f32 v[50:51], v[52:53], v[32:33], v[58:59] op_sel:[0,0,0] op_sel_hi:[0,1,1] neg_lo:[0,0,1]
  v_pk_fma_f32 v[78:79], v[80:81], v[74:75], v[90:91] op_sel:[0,0,0] op_sel_hi:[0,1,1] neg_lo:[0,0,1]
  v_cvt_pk_bf16_f32 v178, v82, v78
  v_cvt_pk_bf16_f32 v61, v38, v40
  v_cvt_pk_bf16_f32 v182, v83, v79
  v_cvt_pk_bf16_f32 v65, -v39, -v41
  v_pk_mul_f32 v[88:89], v[82:83], v[74:75] op_sel:[1,1] op_sel_hi:[1,0]
  v_cvt_pk_bf16_f32 v188, v52, v50
  v_pk_fma_f32 v[84:85], v[82:83], v[74:75], v[88:89] op_sel:[0,0,0] op_sel_hi:[0,1,1] neg_lo:[0,0,1]
  v_cvt_pk_bf16_f32 v192, -v53, -v51
  v_pk_mul_f32 v[90:91], v[78:79], v[74:75] op_sel:[1,1] op_sel_hi:[1,0]
  v_pk_mul_f32 v[56:57], v[40:41], v[30:31] op_sel:[1,1] op_sel_hi:[1,0]
  v_pk_fma_f32 v[80:81], v[78:79], v[74:75], v[90:91] op_sel:[0,0,0] op_sel_hi:[0,1,1] neg_lo:[0,0,1]
  v_pk_fma_f32 v[42:43], v[40:41], v[30:31], v[56:57] op_sel:[0,0,0] op_sel_hi:[0,1,1] neg_lo:[0,0,1]
  v_cvt_pk_bf16_f32 v179, v84, v80
  v_pk_mul_f32 v[58:59], v[50:51], v[32:33] op_sel:[1,1] op_sel_hi:[1,0]
  v_cvt_pk_bf16_f32 v183, v85, v81
  v_pk_fma_f32 v[52:53], v[50:51], v[32:33], v[58:59] op_sel:[0,0,0] op_sel_hi:[0,1,1] neg_lo:[0,0,1]
  v_pk_mul_f32 v[88:89], v[84:85], v[74:75] op_sel:[1,1] op_sel_hi:[1,0]
  v_pk_mul_f32 v[56:57], v[42:43], v[30:31] op_sel:[1,1] op_sel_hi:[1,0]
  v_pk_fma_f32 v[82:83], v[84:85], v[74:75], v[88:89] op_sel:[0,0,0] op_sel_hi:[0,1,1] neg_lo:[0,0,1]
  v_pk_fma_f32 v[44:45], v[42:43], v[30:31], v[56:57] op_sel:[0,0,0] op_sel_hi:[0,1,1] neg_lo:[0,0,1]
  v_pk_mul_f32 v[90:91], v[80:81], v[74:75] op_sel:[1,1] op_sel_hi:[1,0]
  v_pk_mul_f32 v[58:59], v[52:53], v[32:33] op_sel:[1,1] op_sel_hi:[1,0]
  v_pk_fma_f32 v[78:79], v[80:81], v[74:75], v[90:91] op_sel:[0,0,0] op_sel_hi:[0,1,1] neg_lo:[0,0,1]
  v_pk_fma_f32 v[50:51], v[52:53], v[32:33], v[58:59] op_sel:[0,0,0] op_sel_hi:[0,1,1] neg_lo:[0,0,1]
  v_cvt_pk_bf16_f32 v180, v82, v78
  v_cvt_pk_bf16_f32 v62, v42, v44
  v_cvt_pk_bf16_f32 v184, v83, v79
  v_pk_mul_f32 v[88:89], v[82:83], v[74:75] op_sel:[1,1] op_sel_hi:[1,0]
  v_cvt_pk_bf16_f32 v66, -v43, -v45
  v_pk_fma_f32 v[84:85], v[82:83], v[74:75], v[88:89] op_sel:[0,0,0] op_sel_hi:[0,1,1] neg_lo:[0,0,1]
  v_cvt_pk_bf16_f32 v189, v52, v50
  v_pk_mul_f32 v[90:91], v[78:79], v[74:75] op_sel:[1,1] op_sel_hi:[1,0]
  v_cvt_pk_bf16_f32 v193, -v53, -v51
  v_pk_fma_f32 v[80:81], v[78:79], v[74:75], v[90:91] op_sel:[0,0,0] op_sel_hi:[0,1,1] neg_lo:[0,0,1]
  v_pk_mul_f32 v[56:57], v[44:45], v[30:31] op_sel:[1,1] op_sel_hi:[1,0]
  v_cvt_pk_bf16_f32 v181, v84, v80
  v_pk_fma_f32 v[46:47], v[44:45], v[30:31], v[56:57] op_sel:[0,0,0] op_sel_hi:[0,1,1] neg_lo:[0,0,1]
  v_cvt_pk_bf16_f32 v185, v85, v81
  v_pk_mul_f32 v[58:59], v[50:51], v[32:33] op_sel:[1,1] op_sel_hi:[1,0]
  ds_write_b128 v69, v[178:181] offset:15232
  ds_write_b128 v69, v[182:185] offset:23936
  v_pk_fma_f32 v[52:53], v[50:51], v[32:33], v[58:59] op_sel:[0,0,0] op_sel_hi:[0,1,1] neg_lo:[0,0,1]
  v_pk_mul_f32 v[88:89], v[84:85], v[74:75] op_sel:[1,1] op_sel_hi:[1,0]
  v_pk_mul_f32 v[56:57], v[46:47], v[30:31] op_sel:[1,1] op_sel_hi:[1,0]
  v_pk_fma_f32 v[82:83], v[84:85], v[74:75], v[88:89] op_sel:[0,0,0] op_sel_hi:[0,1,1] neg_lo:[0,0,1]
  v_pk_fma_f32 v[48:49], v[46:47], v[30:31], v[56:57] op_sel:[0,0,0] op_sel_hi:[0,1,1] neg_lo:[0,0,1]
  v_pk_mul_f32 v[90:91], v[80:81], v[74:75] op_sel:[1,1] op_sel_hi:[1,0]
  v_pk_mul_f32 v[58:59], v[52:53], v[32:33] op_sel:[1,1] op_sel_hi:[1,0]
  v_pk_fma_f32 v[78:79], v[80:81], v[74:75], v[90:91] op_sel:[0,0,0] op_sel_hi:[0,1,1] neg_lo:[0,0,1]
  v_pk_fma_f32 v[50:51], v[52:53], v[32:33], v[58:59] op_sel:[0,0,0] op_sel_hi:[0,1,1] neg_lo:[0,0,1]
  v_cvt_pk_bf16_f32 v170, v82, v78
  v_cvt_pk_bf16_f32 v63, v46, v48
  v_cvt_pk_bf16_f32 v174, v83, v79
  s_bitcmp1_b32 s2, 2
  s_cbranch_scc1 sig_skip
  s_mov_b32 s28, -1
sig_cnt:
  s_getreg_b32 s29, hwreg(HW_REG_IB_STS, 0, 4)
  s_add_u32 s28, s28, 1
  s_cmp_gt_u32 s29, 1
  s_cbranch_scc1 sig_cnt
  s_min_u32 s28, s28, 24
  s_mul_i32 s30, s28, s57
  v_lshl_add_u32 v5, s30, 13, 1
  s_waitcnt vmcnt(0)
  s_barrier
sig_skip:
  buffer_atomic_add v5, v160, s[4:7], s37 offen sc1
  s_add_u32 m0, s58, 0
  s_add_u32 s9, s42, 0
  buffer_load_dwordx4 v212, s[20:23], s9 offen offset:0 lds
  v_cvt_pk_bf16_f32 v67, -v47, -v49
  v_pk_mul_f32 v[88:89], v[82:83], v[74:75] op_sel:[1,1] op_sel_hi:[1,0]
  v_pk_fma_f32 v[84:85], v[82:83], v[74:75], v[88:89] op_sel:[0,0,0] op_sel_hi:[0,1,1] neg_lo:[0,0,1]
  ds_write_b128 v68, v[60:63] offset:0
  ds_write_b128 v68, v[64:67] offset:6528
  v_pk_mul_f32 v[90:91], v[78:79], v[74:75] op_sel:[1,1] op_sel_hi:[1,0]
  v_cvt_pk_bf16_f32 v126, v52, v50
  v_pk_fma_f32 v[80:81], v[78:79], v[74:75], v[90:91] op_sel:[0,0,0] op_sel_hi:[0,1,1] neg_lo:[0,0,1]
  v_cvt_pk_bf16_f32 v130, -v53, -v51
  buffer_load_dwordx4 v213, s[20:23], s9 offen offset:1024 lds
  v_cvt_pk_bf16_f32 v171, v84, v80
  v_pk_mul_f32 v[58:59], v[50:51], v[32:33] op_sel:[1,1] op_sel_hi:[1,0]
  v_cvt_pk_bf16_f32 v175, v85, v81
  v_pk_fma_f32 v[52:53], v[50:51], v[32:33], v[58:59] op_sel:[0,0,0] op_sel_hi:[0,1,1] neg_lo:[0,0,1]
  v_pk_mul_f32 v[88:89], v[84:85], v[74:75] op_sel:[1,1] op_sel_hi:[1,0]
  v_cvt_pk_bf16_f32 v127, v52, v52
  v_pk_fma_f32 v[82:83], v[84:85], v[74:75], v[88:89] op_sel:[0,0,0] op_sel_hi:[0,1,1] neg_lo:[0,0,1]
  v_cvt_pk_bf16_f32 v131, -v53, -v53
  v_pk_mul_f32 v[90:91], v[80:81], v[74:75] op_sel:[1,1] op_sel_hi:[1,0]
  v_pk_mul_f32 v[56:57], v[38:39], v[32:33] op_sel:[1,1] op_sel_hi:[1,0]
  v_pk_fma_f32 v[78:79], v[80:81], v[74:75], v[90:91] op_sel:[0,0,0] op_sel_hi:[0,1,1] neg_lo:[0,0,1]
  buffer_load_dwordx4 v214, s[20:23], s9 offen offset:2048 lds
  v_pk_fma_f32 v[50:51], v[38:39], v[32:33], v[56:57] op_sel:[0,0,0] op_sel_hi:[0,1,1] neg_lo:[0,0,1]
  v_cvt_pk_bf16_f32 v172, v82, v78
  v_pk_mul_f32 v[58:59], v[42:43], v[32:33] op_sel:[1,1] op_sel_hi:[1,0]
  v_cvt_pk_bf16_f32 v176, v83, v79
  v_pk_fma_f32 v[52:53], v[42:43], v[32:33], v[58:59] op_sel:[0,0,0] op_sel_hi:[0,1,1] neg_lo:[0,0,1]
  v_pk_mul_f32 v[88:89], v[82:83], v[74:75] op_sel:[1,1] op_sel_hi:[1,0]
  v_pk_mul_f32 v[56:57], v[46:47], v[32:33] op_sel:[1,1] op_sel_hi:[1,0]
  v_pk_fma_f32 v[84:85], v[82:83], v[74:75], v[88:89] op_sel:[0,0,0] op_sel_hi:[0,1,1] neg_lo:[0,0,1]
  v_pk_fma_f32 v[34:35], v[46:47], v[32:33], v[56:57] op_sel:[0,0,0] op_sel_hi:[0,1,1] neg_lo:[0,0,1]
  v_pk_mul_f32 v[90:91], v[78:79], v[74:75] op_sel:[1,1] op_sel_hi:[1,0]
  v_pk_fma_f32 v[80:81], v[78:79], v[74:75], v[90:91] op_sel:[0,0,0] op_sel_hi:[0,1,1] neg_lo:[0,0,1]
  s_add_u32 m0, s58, 3072
  s_add_u32 s9, s42, 0
  buffer_load_dwordx4 v194, s[16:19], s9 offen offset:0 lds
  v_cvt_pk_bf16_f32 v186, v54, v50
  v_cvt_pk_bf16_f32 v173, v84, v80
  v_cvt_pk_bf16_f32 v190, -v55, -v51
  v_cvt_pk_bf16_f32 v177, v85, v81
  v_pk_mul_f32 v[58:59], v[52:53], v[32:33] op_sel:[1,1] op_sel_hi:[1,0]
  ds_write_b128 v69, v[170:173] offset:17408
  ds_write_b128 v69, v[174:177] offset:26112
  v_pk_fma_f32 v[36:37], v[52:53], v[32:33], v[58:59] op_sel:[0,0,0] op_sel_hi:[0,1,1] neg_lo:[0,0,1]
  v_pk_mul_f32 v[88:89], v[84:85], v[74:75] op_sel:[1,1] op_sel_hi:[1,0]
  buffer_load_dwordx4 v195, s[16:19], s9 offen offset:1024 lds
  v_cvt_pk_bf16_f32 v187, v52, v34
  v_pk_fma_f32 v[82:83], v[84:85], v[74:75], v[88:89] op_sel:[0,0,0] op_sel_hi:[0,1,1] neg_lo:[0,0,1]
  v_cvt_pk_bf16_f32 v191, -v53, -v35
  v_pk_mul_f32 v[90:91], v[80:81], v[74:75] op_sel:[1,1] op_sel_hi:[1,0]
  ds_write_b128 v68, v[186:189] offset:2176
  ds_write_b128 v68, v[190:193] offset:8704
  v_pk_fma_f32 v[78:79], v[80:81], v[74:75], v[90:91] op_sel:[0,0,0] op_sel_hi:[0,1,1] neg_lo:[0,0,1]
  v_pk_mul_f32 v[56:57], v[36:37], v[32:33] op_sel:[1,1] op_sel_hi:[1,0]
  v_cvt_pk_bf16_f32 v178, v82, v78
  buffer_load_dwordx4 v196, s[16:19], s9 offen offset:2048 lds
  v_pk_fma_f32 v[40:41], v[36:37], v[32:33], v[56:57] op_sel:[0,0,0] op_sel_hi:[0,1,1] neg_lo:[0,0,1]
  v_cvt_pk_bf16_f32 v182, v83, v79
  v_cvt_pk_bf16_f32 v124, v36, v40
  v_pk_mul_f32 v[88:89], v[82:83], v[74:75] op_sel:[1,1] op_sel_hi:[1,0]
  v_cvt_pk_bf16_f32 v128, -v37, -v41
  v_pk_fma_f32 v[84:85], v[82:83], v[74:75], v[88:89] op_sel:[0,0,0] op_sel_hi:[0,1,1] neg_lo:[0,0,1]
  ds_write_b128 v68, v[124:127] offset:4352
  ds_write_b128 v68, v[128:131] offset:10880
  v_pk_mul_f32 v[90:91], v[78:79], v[74:75] op_sel:[1,1] op_sel_hi:[1,0]
  s_add_u32 m0, s58, 24576
  s_add_u32 s9, s42, 176128
  buffer_load_dwordx4 v212, s[20:23], s9 offen offset:0 lds
  v_pk_fma_f32 v[80:81], v[78:79], v[74:75], v[90:91] op_sel:[0,0,0] op_sel_hi:[0,1,1] neg_lo:[0,0,1]
  v_cvt_pk_bf16_f32 v179, v84, v80
  v_cvt_pk_bf16_f32 v183, v85, v81
  v_pk_mul_f32 v[88:89], v[84:85], v[74:75] op_sel:[1,1] op_sel_hi:[1,0]
  v_pk_fma_f32 v[82:83], v[84:85], v[74:75], v[88:89] op_sel:[0,0,0] op_sel_hi:[0,1,1] neg_lo:[0,0,1]
  v_pk_mul_f32 v[90:91], v[80:81], v[74:75] op_sel:[1,1] op_sel_hi:[1,0]
  v_pk_fma_f32 v[78:79], v[80:81], v[74:75], v[90:91] op_sel:[0,0,0] op_sel_hi:[0,1,1] neg_lo:[0,0,1]
  v_cvt_pk_bf16_f32 v180, v82, v78
  v_cvt_pk_bf16_f32 v184, v83, v79
  v_pk_mul_f32 v[88:89], v[82:83], v[74:75] op_sel:[1,1] op_sel_hi:[1,0]
  v_pk_fma_f32 v[84:85], v[82:83], v[74:75], v[88:89] op_sel:[0,0,0] op_sel_hi:[0,1,1] neg_lo:[0,0,1]
  buffer_load_dwordx4 v213, s[20:23], s9 offen offset:1024 lds
  v_pk_mul_f32 v[90:91], v[78:79], v[74:75] op_sel:[1,1] op_sel_hi:[1,0]
  v_pk_fma_f32 v[80:81], v[78:79], v[74:75], v[90:91] op_sel:[0,0,0] op_sel_hi:[0,1,1] neg_lo:[0,0,1]
  v_cvt_pk_bf16_f32 v181, v84, v80
  v_cvt_pk_bf16_f32 v185, v85, v81
  ds_write_b128 v69, v[178:181] offset:19584
  ds_write_b128 v69, v[182:185] offset:28288
  s_waitcnt lgkmcnt(0)
  s_barrier
  buffer_load_dwordx4 v214, s[20:23], s9 offen offset:2048 lds
  ds_read_b64_tr_b16 v[30:31], v159 offset:13056
  ds_read_b64_tr_b16 v[34:35], v158 offset:0
  ds_read_b64_tr_b16 v[38:39], v158 offset:4352
  ds_read_b64_tr_b16 v[32:33], v159 offset:21760
  ds_read_b64_tr_b16 v[36:37], v158 offset:6528
  ds_read_b64_tr_b16 v[40:41], v158 offset:10880
  ds_read_b64_tr_b16 v[42:43], v159 offset:13312
  ds_read_b64_tr_b16 v[46:47], v158 offset:256
  ds_read_b64_tr_b16 v[50:51], v158 offset:4608
  s_add_u32 m0, s58, 27648
  s_add_u32 s9, s42, 176128
  buffer_load_dwordx4 v194, s[16:19], s9 offen offset:0 lds
  ds_read_b64_tr_b16 v[44:45], v159 offset:22016
  ds_read_b64_tr_b16 v[48:49], v158 offset:6784
  ds_read_b64_tr_b16 v[52:53], v158 offset:11136
  ds_read_b64_tr_b16 v[54:55], v159 offset:13568
  ds_read_b64_tr_b16 v[58:59], v158 offset:512
  ds_read_b64_tr_b16 v[62:63], v158 offset:4864
  ds_read_b64_tr_b16 v[56:57], v159 offset:22272
  ds_read_b64_tr_b16 v[60:61], v158 offset:7040
  ds_read_b64_tr_b16 v[64:65], v158 offset:11392
  s_waitcnt lgkmcnt(12)
  buffer_load_dwordx4 v195, s[16:19], s9 offen offset:1024 lds
  v_mfma_f32_16x16x32_bf16 v[150:153], v[34:37], v[30:33], 0
  v_mfma_f32_16x16x32_bf16 v[154:157], v[38:41], v[30:33], 0
  s_mov_b64 exec, 15
  v_mov_b32 v5, 0
  buffer_atomic_add v5, v3, s[4:7], s37 offen sc0 sc1
  s_mov_b64 exec, -1
  ds_read_b64_tr_b16 v[66:67], v159 offset:13824
  ds_read_b64_tr_b16 v[70:71], v158 offset:768
  ds_read_b64_tr_b16 v[74:75], v158 offset:5120
  ds_read_b64_tr_b16 v[68:69], v159 offset:22528
  ds_read_b64_tr_b16 v[72:73], v158 offset:7296
  ds_read_b64_tr_b16 v[76:77], v158 offset:11648
  s_waitcnt lgkmcnt(12)
  v_mfma_f32_16x16x32_bf16 v[150:153], v[46:49], v[42:45], v[150:153]
  buffer_load_dwordx4 v196, s[16:19], s9 offen offset:2048 lds
  v_mfma_f32_16x16x32_bf16 v[154:157], v[50:53], v[42:45], v[154:157]
  ds_read_b64_tr_b16 v[78:79], v159 offset:14080
  ds_read_b64_tr_b16 v[82:83], v158 offset:1024
  ds_read_b64_tr_b16 v[86:87], v158 offset:5376
  ds_read_b64_tr_b16 v[80:81], v159 offset:22784
  ds_read_b64_tr_b16 v[84:85], v158 offset:7552
  ds_read_b64_tr_b16 v[88:89], v158 offset:11904
  s_waitcnt lgkmcnt(12)
  v_mfma_f32_16x16x32_bf16 v[150:153], v[58:61], v[54:57], v[150:153]
  v_mfma_f32_16x16x32_bf16 v[154:157], v[62:65], v[54:57], v[154:157]
  s_add_u32 m0, s58, 49152
  s_add_u32 s9, s42, 352256
  s_bitset0_b32 exec_lo, 11
  buffer_load_dwordx4 v212, s[20:23], s9 offen offset:0 lds
  s_mov_b32 exec_lo, -1
  ds_read_b64_tr_b16 v[90:91], v159 offset:14336
  ds_read_b64_tr_b16 v[94:95], v158 offset:1280
  ds_read_b64_tr_b16 v[98:99], v158 offset:5632
  ds_read_b64_tr_b16 v[92:93], v159 offset:23040
  ds_read_b64_tr_b16 v[96:97], v158 offset:7808
  ds_read_b64_tr_b16 v[100:101], v158 offset:12160
  s_waitcnt lgkmcnt(12)
  v_mfma_f32_16x16x32_bf16 v[150:153], v[70:73], v[66:69], v[150:153]
  v_mfma_f32_16x16x32_bf16 v[154:157], v[74:77], v[66:69], v[154:157]
  ds_read_b64_tr_b16 v[102:103], v159 offset:14592
  ds_read_b64_tr_b16 v[106:107], v158 offset:1536
  ds_read_b64_tr_b16 v[110:111], v158 offset:5888
  ds_read_b64_tr_b16 v[104:105], v159 offset:23296
  ds_read_b64_tr_b16 v[108:109], v158 offset:8064
  ds_read_b64_tr_b16 v[112:113], v158 offset:12416
  s_waitcnt lgkmcnt(12)
  buffer_load_dwordx4 v213, s[20:23], s9 offen offset:1024 lds
  v_mfma_f32_16x16x32_bf16 v[150:153], v[82:85], v[78:81], v[150:153]
  v_mfma_f32_16x16x32_bf16 v[154:157], v[86:89], v[78:81], v[154:157]
  ds_read_b64_tr_b16 v[114:115], v159 offset:14848
  ds_read_b64_tr_b16 v[118:119], v158 offset:1792
  ds_read_b64_tr_b16 v[122:123], v158 offset:6144
  ds_read_b64_tr_b16 v[116:117], v159 offset:23552
  ds_read_b64_tr_b16 v[120:121], v158 offset:8320
  ds_read_b64_tr_b16 v[124:125], v158 offset:12672
  s_waitcnt lgkmcnt(12)
  v_mfma_f32_16x16x32_bf16 v[150:153], v[94:97], v[90:93], v[150:153]
  v_mfma_f32_16x16x32_bf16 v[154:157], v[98:101], v[90:93], v[154:157]
  s_waitcnt lgkmcnt(6)
  v_mfma_f32_16x16x32_bf16 v[150:153], v[106:109], v[102:105], v[150:153]
  buffer_load_dwordx4 v214, s[20:23], s9 offen offset:2048 lds
  v_mfma_f32_16x16x32_bf16 v[154:157], v[110:113], v[102:105], v[154:157]
  s_waitcnt lgkmcnt(0)
  s_waitcnt vmcnt(17)
  s_barrier
  buffer_atomic_add v4, v199, s[4:7], s37 offen sc1
  v_mfma_f32_16x16x32_bf16 v[150:153], v[118:121], v[114:117], v[150:153]
  v_mfma_f32_16x16x32_bf16 v[154:157], v[122:125], v[114:117], v[154:157]
  s_and_b32 s45, s44, 0xffff0000
  s_lshl_b32 s44, s44, 16
  ds_write_b32 v164, v166
  ds_write_b32 v165, v166
  s_nop 2
  v_cvt_pk_bf16_f32 v150, v150, v151
  v_cvt_pk_bf16_f32 v152, v152, v153
  v_cvt_pk_bf16_f32 v154, v154, v155
  v_cvt_pk_bf16_f32 v156, v156, v157
  ds_write_b16 v132, v150
  ds_write_b16_d16_hi v133, v150
  ds_write_b16 v134, v152
  ds_write_b16_d16_hi v135, v152
  s_mov_b32 exec_hi, 0
  ds_write_b16 v136, v154
  ds_write_b16_d16_hi v137, v154
  ds_write_b16 v138, v156
  ds_write_b16_d16_hi v139, v156
  s_mov_b32 exec_hi, -1
  s_mov_b32 s10, 0x100000
  s_movk_i32 s11, 8192
  s_mov_b32 s28, 0x05040100
  s_mov_b32 s29, 0x07060302
  s_waitcnt vmcnt(5)
  v_sub_u32 v144, v5, v142
  v_and_b32 v145, 0xff, v144
  v_cmp_ne_u32 vcc, v143, v145
  s_and_b32 s55, vcc_lo, 15
  s_cbranch_scc1 dpoll0_s
dpoll0_ok:
  s_add_u32 m0, s58, 52224
  s_add_u32 s9, s42, 352256
  buffer_load_dwordx4 v194, s[16:19], s9 offen offset:0 lds
  v_add_u32_dpp v144, v144, v144 row_shr:1 row_mask:0xf bank_mask:0xf
  s_nop 1
  v_add_u32_dpp v144, v144, v144 row_shr:2 row_mask:0xf bank_mask:0xf
  ds_write_b32 v168, v144
  s_waitcnt vmcnt(5)
  s_waitcnt lgkmcnt(0)
  s_barrier
  ds_read_b32 v32, v21
  ds_read_b32 v33, v22
  ds_read_b32 v34, v23
  ds_read_b32 v35, v24
  ds_read_b32 v36, v25
  ds_read_b32 v37, v26
  ds_read_b32 v38, v27
  ds_read_b32 v39, v28
  ds_read_b32 v40, v29
  buffer_load_dwordx4 v[128:131], v161, s[4:7], 0 offen sc1
  buffer_load_dwordx4 v[132:135], v162, s[4:7], 0 offen sc1
  buffer_load_dwordx4 v[136:139], v163, s[4:7], 0 offen sc1
  s_mov_b64 exec, 255
  ds_write2st64_b64 v225, v[228:229], v[228:229] offset0:0 offset1:96
  s_mov_b64 exec, -1
  ds_read_b64_tr_b16 a[0:1], v215 offset:0
  ds_read_b64_tr_b16 a[64:65], v197 offset:3072
  ds_read_b64_tr_b16 a[128:129], v216 offset:0
  ds_read_b64_tr_b16 a[2:3], v215 offset:6144
  ds_read_b64_tr_b16 a[66:67], v197 offset:9216
  ds_read_b64_tr_b16 a[130:131], v216 offset:6144
  ds_read_b64_tr_b16 a[4:5], v215 offset:12288
  s_waitcnt lgkmcnt(8)
  buffer_load_dwordx4 v195, s[16:19], s9 offen offset:1024 lds
  v_perm_b32 v56, v33, v32, s28
  v_perm_b32 v57, v35, v34, s28
  v_perm_b32 v58, v37, v36, s28
  v_perm_b32 v59, v39, v38, s28
  ds_write_b128 v167, v[56:59] offset:0
  v_perm_b32 v60, v34, v33, s28
  v_perm_b32 v61, v36, v35, s28
  v_perm_b32 v62, v38, v37, s28
  v_perm_b32 v63, v40, v39, s28
  ds_write_b128 v167, v[60:63] offset:4160
  v_perm_b32 v64, v33, v32, s29
  v_perm_b32 v65, v35, v34, s29
  v_perm_b32 v66, v37, v36, s29
  buffer_load_dwordx4 v196, s[16:19], s9 offen offset:2048 lds
  v_perm_b32 v67, v39, v38, s29
  ds_write_b128 v167, v[64:67] offset:8320
  v_perm_b32 v68, v34, v33, s29
  v_perm_b32 v69, v36, v35, s29
  v_perm_b32 v70, v38, v37, s29
  v_perm_b32 v71, v40, v39, s29
  ds_write_b128 v167, v[68:71] offset:12480
  ds_read_b64_tr_b16 a[68:69], v197 offset:15360
  ds_read_b64_tr_b16 a[132:133], v216 offset:12288
  ds_read_b64_tr_b16 a[6:7], v215 offset:18432
  s_add_u32 m0, s58, 73728
  s_add_u32 s9, s42, 528384
  s_bitset0_b32 exec_lo, 11
  buffer_load_dwordx4 v212, s[20:23], s9 offen offset:0 lds
  s_mov_b32 exec_lo, -1
  ds_read_b64_tr_b16 a[70:71], v197 offset:21504
  ds_read_b64_tr_b16 a[134:135], v216 offset:18432
  ds_read_b64_tr_b16 a[8:9], v215 offset:24576
  ds_read_b64_tr_b16 a[72:73], v197 offset:27648
  ds_read_b64_tr_b16 a[136:137], v216 offset:24576
  ds_read_b64_tr_b16 a[10:11], v215 offset:30720
  ds_read_b64_tr_b16 a[74:75], v197 offset:33792
  ds_read_b64_tr_b16 a[138:139], v216 offset:30720
  buffer_load_dwordx4 v213, s[20:23], s9 offen offset:1024 lds
  ds_read_b64_tr_b16 a[12:13], v215 offset:36864
  ds_read_b64_tr_b16 a[76:77], v197 offset:39936
  ds_read_b64_tr_b16 a[140:141], v216 offset:36864
  ds_read_b64_tr_b16 a[14:15], v215 offset:43008
  ds_read_b64_tr_b16 a[78:79], v197 offset:46080
  ds_read_b64_tr_b16 a[142:143], v216 offset:43008
  s_waitcnt lgkmcnt(0)
  s_barrier
  buffer_load_dwordx4 v214, s[20:23], s9 offen offset:2048 lds
  ds_read_b32 v169, v169 offset:12
  ds_read2_b32 v[16:17], v9 offset0:176 offset1:177
  ds_read2_b32 v[18:19], v9 offset0:178 offset1:179
  ds_read2_b32 v[20:21], v9 offset0:48 offset1:49
  ds_read2_b32 v[22:23], v9 offset0:50 offset1:51
  ds_read2_b32 v[24:25], v8 offset0:176 offset1:177
  s_add_u32 m0, s58, 76800
  s_add_u32 s9, s42, 528384
  buffer_load_dwordx4 v194, s[16:19], s9 offen offset:0 lds
  ds_read2_b32 v[26:27], v8 offset0:178 offset1:179
  ds_read2_b32 v[28:29], v8 offset0:48 offset1:49
  ds_read2_b32 v[30:31], v8 offset0:50 offset1:51
  ds_read2_b32 v[32:33], v9 offset0:160 offset1:161
  ds_read2_b32 v[34:35], v9 offset0:162 offset1:163
  ds_read2_b32 v[36:37], v9 offset0:32 offset1:33
  buffer_load_dwordx4 v195, s[16:19], s9 offen offset:1024 lds
  ds_read2_b32 v[38:39], v9 offset0:34 offset1:35
  s_waitcnt lgkmcnt(12)
  s_mov_b64 exec, 240
  v_mov_b32 v5, 0
  buffer_atomic_add v5, v3, s[4:7], s37 offen sc0 sc1
  s_mov_b64 exec, -1
  s_waitcnt vmcnt(8)
  buffer_load_dwordx4 v196, s[16:19], s9 offen offset:2048 lds
  v_mfma_f32_16x16x32_bf16 v[244:247], a[0:3], v[228:231], 0
  ds_read2_b32 v[40:41], v8 offset0:160 offset1:161
  v_pk_mul_f32 v[132:133], v[132:133], s[46:47]
  v_pk_mul_f32 v[136:137], v[136:137], s[46:47]
  v_pk_mul_f32 v[134:135], v[134:135], s[46:47]
  v_pk_mul_f32 v[138:139], v[138:139], s[46:47]
  v_fma_f32 v133, -v132, v132, v133
  ds_read2_b32 v[42:43], v8 offset0:162 offset1:163
  v_mfma_f32_16x16x32_bf16 v[248:251], a[64:67], v[228:231], 0
  v_fma_f32 v137, -v136, v136, v137
  v_fma_f32 v135, -v134, v134, v135
  v_fma_f32 v139, -v138, v138, v139
  v_cvt_pk_bf16_f32 v133, v133, v135
  ds_read2_b32 v[44:45], v8 offset0:32 offset1:33
  ds_read2_b32 v[46:47], v8 offset0:34 offset1:35
  v_cvt_pk_bf16_f32 v137, v137, v139
  v_cvt_pk_bf16_f32 v132, v132, v134
  v_cvt_pk_bf16_f32 v136, v136, v138
  s_add_u32 m0, s58, 0
  s_add_u32 s9, s42, 704512
  s_bitset0_b32 exec_lo, 11
  buffer_load_dwordx4 v212, s[20:23], s9 offen offset:0 lds
  s_mov_b32 exec_lo, -1
  v_pk_max_i16 v133, v133, 0
  v_mfma_f32_16x16x32_bf16 v[252:255], a[128:131], v[228:231], 0
  ds_read2_b32 v[48:49], v9 offset0:144 offset1:145
  v_pk_max_i16 v137, v137, 0
  v_lshlrev_b32 v96, 16, v132
  v_lshlrev_b32 v98, 16, v136
  v_and_b32 v97, 0xffff0000, v132
  v_mfma_f32_16x16x32_bf16 v[244:247], a[4:7], v[228:231], v[244:247]
  ds_read2_b32 v[50:51], v9 offset0:146 offset1:147
  v_and_b32 v99, 0xffff0000, v136
  v_lshlrev_b32 v100, 16, v133
  v_lshlrev_b32 v102, 16, v137
  v_and_b32 v101, 0xffff0000, v133
  v_and_b32 v103, 0xffff0000, v137
  ds_read2_b32 v[52:53], v9 offset0:16 offset1:17
  v_mfma_f32_16x16x32_bf16 v[248:251], a[68:71], v[228:231], v[248:251]
  v_pk_add_f32 v[100:101], v[100:101], s[48:49]
  v_pk_add_f32 v[102:103], v[102:103], s[48:49]
  v_lshlrev_b32 v80, 16, v128
  v_lshlrev_b32 v84, 16, v130
  buffer_load_dwordx4 v213, s[20:23], s9 offen offset:1024 lds
  ds_read2_b32 v[54:55], v9 offset0:18 offset1:19
  ds_read2_b32 v[56:57], v8 offset0:144 offset1:145
  v_cvt_pk_bf16_f32 v133, v100, v101
  v_cvt_pk_bf16_f32 v137, v102, v103
  v_lshlrev_b32 v82, 16, v129
  v_lshlrev_b32 v86, 16, v131
  v_mfma_f32_16x16x32_bf16 v[252:255], a[132:135], v[228:231], v[252:255]
  ds_read2_b32 v[58:59], v8 offset0:146 offset1:147
  v_lshlrev_b32 v100, 16, v133
  v_lshlrev_b32 v102, 16, v137
  v_and_b32 v81, 0xffff0000, v128
  v_and_b32 v85, 0xffff0000, v130
  v_mfma_f32_16x16x32_bf16 v[244:247], a[8:11], v[228:231], v[244:247]
  ds_read2_b32 v[60:61], v8 offset0:16 offset1:17
  v_and_b32 v101, 0xffff0000, v133
  v_and_b32 v103, 0xffff0000, v137
  v_and_b32 v83, 0xffff0000, v129
  v_and_b32 v87, 0xffff0000, v131
  v_sqrt_f32 v100, v100
  buffer_load_dwordx4 v214, s[20:23], s9 offen offset:2048 lds
  ds_read2_b32 v[62:63], v8 offset0:18 offset1:19
  v_mfma_f32_16x16x32_bf16 v[248:251], a[72:75], v[228:231], v[248:251]
  v_sqrt_f32 v102, v102
  v_pk_add_f32 v[88:89], v[80:81], v[96:97] op_sel:[0,0] op_sel_hi:[1,0] neg_lo:[0,1] neg_hi:[0,1]
  v_pk_add_f32 v[92:93], v[84:85], v[98:99] op_sel:[0,0] op_sel_hi:[1,0] neg_lo:[0,1] neg_hi:[0,1]
  v_sqrt_f32 v101, v101
  ds_read2_b32 v[64:65], v9 offset0:128 offset1:129
  ds_read2_b32 v[66:67], v9 offset0:130 offset1:131
  v_sqrt_f32 v103, v103
  v_pk_add_f32 v[90:91], v[82:83], v[96:97] op_sel:[0,1] op_sel_hi:[1,1] neg_lo:[0,1] neg_hi:[0,1]
  v_pk_add_f32 v[94:95], v[86:87], v[98:99] op_sel:[0,1] op_sel_hi:[1,1] neg_lo:[0,1] neg_hi:[0,1]
  v_cvt_pk_bf16_f32 v133, v100, v101
  v_mfma_f32_16x16x32_bf16 v[252:255], a[136:139], v[228:231], v[252:255]
  ds_read2_b32 v[68:69], v9 offset0:0 offset1:1
  v_cvt_pk_bf16_f32 v137, v102, v103
  v_cvt_pk_bf16_f32 v128, v88, v89
  s_add_u32 m0, s58, 3072
  s_add_u32 s9, s42, 704512
  buffer_load_dwordx4 v194, s[16:19], s9 offen offset:0 lds
  v_cvt_pk_bf16_f32 v130, v92, v93
  v_lshlrev_b32 v100, 16, v133
  v_mfma_f32_16x16x32_bf16 v[244:247], a[12:15], v[228:231], v[244:247]
  ds_read2_b32 v[70:71], v9 offset0:2 offset1:3
  v_lshlrev_b32 v102, 16, v137
  v_cvt_pk_bf16_f32 v129, v90, v91
  v_cvt_pk_bf16_f32 v131, v94, v95
  v_and_b32 v101, 0xffff0000, v133
  v_and_b32 v103, 0xffff0000, v137
  ds_read2_b32 v[72:73], v8 offset0:128 offset1:129
  v_mfma_f32_16x16x32_bf16 v[248:251], a[76:79], v[228:231], v[248:251]
  v_lshlrev_b32 v88, 16, v128
  v_lshlrev_b32 v92, 16, v130
  v_rcp_f32 v100, v100
  v_rcp_f32 v102, v102
  ds_read2_b32 v[74:75], v8 offset0:130 offset1:131
  ds_read2_b32 v[76:77], v8 offset0:0 offset1:1
  buffer_load_dwordx4 v195, s[16:19], s9 offen offset:1024 lds
  v_lshlrev_b32 v90, 16, v129
  v_lshlrev_b32 v94, 16, v131
  v_rcp_f32 v101, v101
  v_rcp_f32 v103, v103
  v_mfma_f32_16x16x32_bf16 v[252:255], a[140:143], v[228:231], v[252:255]
  ds_read2_b32 v[78:79], v8 offset0:2 offset1:3
  v_and_b32 v89, 0xffff0000, v128
  v_and_b32 v93, 0xffff0000, v130
  v_and_b32 v91, 0xffff0000, v129
  v_and_b32 v95, 0xffff0000, v131
  v_pk_mul_f32 v[88:89], v[88:89], v[100:101] op_sel:[0,0] op_sel_hi:[1,0]
  v_pk_mul_f32 v[90:91], v[90:91], v[100:101] op_sel:[0,1] op_sel_hi:[1,1]
  v_pk_mul_f32 v[92:93], v[92:93], v[102:103] op_sel:[0,0] op_sel_hi:[1,0]
  v_pk_mul_f32 v[94:95], v[94:95], v[102:103] op_sel:[0,1] op_sel_hi:[1,1]
  v_cvt_pk_bf16_f32 v128, v88, v90
  v_cvt_pk_bf16_f32 v129, v92, v94
  ds_write_b64 v141, v[128:129] offset:0
  v_cvt_pk_bf16_f32 v130, v89, v91
  v_cvt_pk_bf16_f32 v131, v93, v95
  buffer_load_dwordx4 v196, s[16:19], s9 offen offset:2048 lds
  ds_write_b64 v141, v[130:131] offset:4608
  v_fma_f32 v132, v88, s44, v80
  v_fma_f32 v133, v90, s44, v82
  v_fma_f32 v134, v92, s44, v84
  v_fma_f32 v135, v94, s44, v86
  ds_write_b128 v12, v[132:135] offset:0
  v_fma_f32 v136, v89, s45, v81
  v_fma_f32 v137, v91, s45, v83
  v_fma_f32 v138, v93, s45, v85
  v_fma_f32 v139, v95, s45, v87
  ds_write_b128 v12, v[136:139] offset:4096
  s_waitcnt vmcnt(7)
  v_sub_u32 v144, v5, v142
  v_and_b32 v145, 0xff, v144
  v_cmp_ne_u32 vcc, v143, v145
  s_and_b32 s55, vcc_lo, 240
  s_cbranch_scc1 dpoll1_s
dpoll1_ok:
  s_waitcnt vmcnt(6)
  s_waitcnt lgkmcnt(0)
  s_barrier
  s_add_u32 m0, s58, 24576
  s_add_u32 s9, s42, 880640
  s_bitset0_b32 exec_lo, 11
  buffer_load_dwordx4 v212, s[20:23], s9 offen offset:0 lds
  s_mov_b32 exec_lo, -1
  ds_read_b128 v[80:83], v140 offset:192
  ds_read_b128 v[84:87], v140 offset:704
  ds_read_b128 v[88:91], v140 offset:1216
  ds_read_b128 v[92:95], v140 offset:1728
wpad_0_1:
  s_cbranch_execz wpad_0_5
  ds_read_b128 v[96:99], v140 offset:128
  ds_read_b128 v[100:103], v140 offset:640
  ds_read_b128 v[104:107], v140 offset:1152
  ds_read_b128 v[108:111], v140 offset:1664
  ds_read_b128 v[132:135], v13 offset:0
  ds_read_b128 v[136:139], v13 offset:1024
  buffer_load_dwordx4 v[240:243], v161, s[4:7], s10 offen sc1
  buffer_load_dwordx4 v[232:235], v162, s[4:7], s11 offen sc1
  buffer_load_dwordx4 v[236:239], v163, s[4:7], s11 offen sc1
  v_readfirstlane_b32 s37, v169
  s_or_b32 s37, s37, 1
  s_cmp_lt_i32 s37, 0
  s_cselect_b32 s10, s14, 0
  s_add_u32 s4, s4, s10
  s_addc_u32 s5, s5, 0
  s_lshl_b32 s51, s36, 1
  s_lshr_b32 s52, s3, 1
  s_add_u32 s51, s51, s52
  s_lshl_b32 s51, s51, 7
  s_and_b32 s53, s51, 0xe000
  s_add_u32 s51, s51, s53
  s_and_b32 s52, s3, 1
  s_lshl_b32 s53, s52, 13
  s_add_u32 s51, s51, s53
  s_add_u32 s29, s51, s38
  buffer_load_dwordx4 v213, s[20:23], s9 offen offset:1024 lds
  v_xor_b32 v142, 2048, v14
  s_waitcnt lgkmcnt(9)
  v_mfma_f32_16x16x32_bf16 v[112:115], v[16:19], v[80:83], 0
  v_mfma_f32_16x16x32_bf16 v[116:119], v[20:23], v[80:83], 0
  s_and_b32 s10, s32, 7
  s_lshl_b32 s39, s10, 19
  v_mfma_f32_16x16x32_bf16 v[120:123], v[24:27], v[80:83], 0
  ds_read_b64_tr_b16 a[16:17], v217 offset:0
  s_lshr_b32 s10, s32, 2
  v_mfma_f32_16x16x32_bf16 v[124:127], v[28:31], v[80:83], 0
  ds_read_b128 v[80:83], v140 offset:64
  s_waitcnt lgkmcnt(10)
  v_mfma_f32_16x16x32_bf16 v[116:119], v[16:19], v[84:87], v[116:119]
  buffer_load_dwordx4 v214, s[20:23], s9 offen offset:2048 lds
  v_mfma_f32_16x16x32_bf16 v[120:123], v[20:23], v[84:87], v[120:123]
  s_add_u32 m0, s58, 27648
  s_add_u32 s9, s42, 880640
  v_mfma_f32_16x16x32_bf16 v[124:127], v[24:27], v[84:87], v[124:127]
  ds_read_b128 v[84:87], v140 offset:576
  ds_read_b64_tr_b16 a[80:81], v198 offset:3072
  s_waitcnt lgkmcnt(10)
  v_mfma_f32_16x16x32_bf16 v[120:123], v[16:19], v[88:91], v[120:123]
  buffer_load_dwordx4 v194, s[16:19], s9 offen offset:0 lds
  v_mfma_f32_16x16x32_bf16 v[124:127], v[20:23], v[88:91], v[124:127]
  ds_read_b128 v[88:91], v140 offset:1088
  ds_read_b64_tr_b16 a[144:145], v218 offset:0
  v_mfma_f32_16x16x32_bf16 v[124:127], v[16:19], v[92:95], v[124:127]
  ds_read_b128 v[92:95], v140 offset:1600
  ds_read_b64_tr_b16 a[18:19], v217 offset:6144
  s_waitcnt lgkmcnt(10)
  v_mfma_f32_16x16x32_bf16 v[112:115], v[32:35], v[96:99], v[112:115]
  ds_read_b64_tr_b16 a[82:83], v198 offset:9216
  ds_read_b64_tr_b16 a[146:147], v218 offset:6144
  v_mfma_f32_16x16x32_bf16 v[116:119], v[36:39], v[96:99], v[116:119]
  ds_read_b64_tr_b16 a[20:21], v217 offset:12288
  ds_read_b64_tr_b16 a[84:85], v198 offset:15360
  v_mfma_f32_16x16x32_bf16 v[120:123], v[40:43], v[96:99], v[120:123]
  buffer_load_dwordx4 v195, s[16:19], s9 offen offset:1024 lds
  v_mfma_f32_16x16x32_bf16 v[124:127], v[44:47], v[96:99], v[124:127]
  ds_read_b128 v[96:99], v140 offset:0
  s_lshr_b32 s10, 49152, s10
  v_mfma_f32_16x16x32_bf16 v[116:119], v[32:35], v[100:103], v[116:119]
  ds_read_b64_tr_b16 a[148:149], v218 offset:12288
  ds_read_b64_tr_b16 a[22:23], v217 offset:18432
  v_mfma_f32_16x16x32_bf16 v[120:123], v[36:39], v[100:103], v[120:123]
  ds_read_b64_tr_b16 a[86:87], v198 offset:21504
  s_and_b32 s10, s10, 0x2000
  v_mfma_f32_16x16x32_bf16 v[124:127], v[40:43], v[100:103], v[124:127]
  ds_read_b128 v[100:103], v140 offset:512
  s_add_u32 s39, s39, s10
  v_mfma_f32_16x16x32_bf16 v[120:123], v[32:35], v[104:107], v[120:123]
  buffer_load_dwordx4 v196, s[16:19], s9 offen offset:2048 lds
  v_mfma_f32_16x16x32_bf16 v[124:127], v[36:39], v[104:107], v[124:127]
  ds_read_b128 v[104:107], v140 offset:1024
  ds_read_b64_tr_b16 a[150:151], v218 offset:18432
  v_mfma_f32_16x16x32_bf16 v[124:127], v[32:35], v[108:111], v[124:127]
  ds_read_b128 v[108:111], v140 offset:1536
  ds_read_b64_tr_b16 a[24:25], v217 offset:24576
  s_waitcnt lgkmcnt(15)
  v_mfma_f32_16x16x32_bf16 v[112:115], v[48:51], v[80:83], v[112:115]
  ds_read_b64_tr_b16 a[88:89], v198 offset:27648
  ds_read_b64_tr_b16 a[152:153], v218 offset:24576
  v_mfma_f32_16x16x32_bf16 v[116:119], v[52:55], v[80:83], v[116:119]
  ds_read_b64_tr_b16 a[26:27], v217 offset:30720
  s_lshl_b32 s30, s34, 18
  v_mfma_f32_16x16x32_bf16 v[120:123], v[56:59], v[80:83], v[120:123]
  ds_read_b64_tr_b16 a[90:91], v198 offset:33792
  s_add_u32 s39, s39, 39845888
  v_mfma_f32_16x16x32_bf16 v[124:127], v[60:63], v[80:83], v[124:127]
  ds_read_b64_tr_b16 a[154:155], v218 offset:30720
  s_waitcnt lgkmcnt(15)
  v_mfma_f32_16x16x32_bf16 v[116:119], v[48:51], v[84:87], v[116:119]
  ds_read_b64_tr_b16 a[28:29], v217 offset:36864
  s_add_u32 s30, s30, -120832
  v_mfma_f32_16x16x32_bf16 v[120:123], v[52:55], v[84:87], v[120:123]
  ds_read_b64_tr_b16 a[92:93], v198 offset:39936
  s_add_u32 s30, s30, s39
  v_mfma_f32_16x16x32_bf16 v[124:127], v[56:59], v[84:87], v[124:127]
  ds_read_b64_tr_b16 a[156:157], v218 offset:36864
  s_waitcnt lgkmcnt(15)
  v_mfma_f32_16x16x32_bf16 v[120:123], v[48:51], v[88:91], v[120:123]
  ds_read_b64_tr_b16 a[30:31], v217 offset:43008
  s_mul_i32 s10, s35, 0x200400
  v_mfma_f32_16x16x32_bf16 v[124:127], v[52:55], v[88:91], v[124:127]
  ds_read_b64_tr_b16 a[94:95], v198 offset:46080
  s_mul_i32 s11, s3, 40960
  v_mfma_f32_16x16x32_bf16 v[124:127], v[48:51], v[92:95], v[124:127]
  ds_read_b64_tr_b16 a[158:159], v218 offset:43008
  s_waitcnt lgkmcnt(15)
  v_mfma_f32_16x16x32_bf16 v[112:115], v[64:67], v[96:99], v[112:115]
  ds_read2_b32 v[92:93], v6 offset0:0 offset1:1
  v_add_u32 v217, 16384, v217
  v_mfma_f32_16x16x32_bf16 v[116:119], v[68:71], v[96:99], v[116:119]
  ds_read2_b32 v[94:95], v6 offset0:2 offset1:3
  v_add_u32 v218, 16384, v218
  v_mfma_f32_16x16x32_bf16 v[120:123], v[72:75], v[96:99], v[120:123]
  ds_read2_b32 v[88:89], v6 offset0:128 offset1:129
  v_add_u32 v198, 16384, v198
  v_mfma_f32_16x16x32_bf16 v[124:127], v[76:79], v[96:99], v[124:127]
  ds_read2_b32 v[90:91], v6 offset0:130 offset1:131
  s_waitcnt lgkmcnt(15)
  v_mfma_f32_16x16x32_bf16 v[116:119], v[64:67], v[100:103], v[116:119]
  ds_read2_b32 v[84:85], v7 offset0:0 offset1:1
  s_and_b32 s10, s10, 0xc00400
  v_mfma_f32_16x16x32_bf16 v[120:123], v[68:71], v[100:103], v[120:123]
  ds_read2_b32 v[86:87], v7 offset0:2 offset1:3
  v_lshlrev_b32 v207, 7, v0
  v_mfma_f32_16x16x32_bf16 v[124:127], v[72:75], v[100:103], v[124:127]
  ds_read2_b32 v[80:81], v7 offset0:128 offset1:129
  s_waitcnt lgkmcnt(15)
  v_mfma_f32_16x16x32_bf16 v[120:123], v[64:67], v[104:107], v[120:123]
  ds_read2_b32 v[82:83], v7 offset0:130 offset1:131
  s_add_u32 s10, s10, s11
  v_mfma_f32_16x16x32_bf16 v[124:127], v[68:71], v[104:107], v[124:127]
  s_add_u32 s11, s30, 157696
  s_add_u32 s10, s10, s11
  v_mfma_f32_16x16x32_bf16 v[124:127], v[64:67], v[108:111], v[124:127]
  s_and_b32 s11, s35, 2
  s_cmp_eq_u32 s52, 0
  s_nop 6
  s_cbranch_scc1 cx_1_0
  ds_write_b128 v14, v[112:115] offset:0
  ds_write_b128 v14, v[116:119] offset:1024
  v_pk_add_f32 v[132:133], v[132:133], v[120:121]
  v_pk_add_f32 v[134:135], v[134:135], v[122:123]
  v_pk_add_f32 v[136:137], v[136:137], v[124:125]
  v_pk_add_f32 v[138:139], v[138:139], v[126:127]
  s_branch cx_1_1
cx_1_0:
  ds_write_b128 v14, v[120:123] offset:0
  ds_write_b128 v14, v[124:127] offset:1024
  v_pk_add_f32 v[132:133], v[132:133], v[112:113]
  v_pk_add_f32 v[134:135], v[134:135], v[114:115]
  v_pk_add_f32 v[136:137], v[136:137], v[116:117]
  v_pk_add_f32 v[138:139], v[138:139], v[118:119]
cx_1_1:
  s_waitcnt lgkmcnt(6)
  v_mfma_f32_16x16x32_bf16 v[124:127], v[92:95], v[96:99], 0
  ds_read2_b32 v[92:93], v6 offset0:16 offset1:17
  s_waitcnt lgkmcnt(1)
  s_barrier
  v_mfma_f32_16x16x32_bf16 v[120:123], v[88:91], v[96:99], 0
  ds_read2_b32 v[94:95], v6 offset0:18 offset1:19
  s_add_u32 m0, s58, 65536
  s_add_u32 s9, s42, 1056768
  v_mfma_f32_16x16x32_bf16 v[116:119], v[84:87], v[96:99], 0
  s_bitset0_b32 exec_lo, 11
  buffer_load_dwordx4 v212, s[20:23], s9 offen offset:0 lds
  s_mov_b32 exec_lo, -1
  v_mfma_f32_16x16x32_bf16 v[112:115], v[80:83], v[96:99], 0
  ds_read_b128 v[96:99], v140 offset:64
  ds_read_b128 v[128:131], v142
  v_mfma_f32_16x16x32_bf16 v[124:127], v[88:91], v[100:103], v[124:127]
  ds_read2_b32 v[88:89], v6 offset0:144 offset1:145
  ds_read_b128 v[8:11], v142 offset:1024
  v_mfma_f32_16x16x32_bf16 v[120:123], v[84:87], v[100:103], v[120:123]
  ds_read2_b32 v[90:91], v6 offset0:146 offset1:147
  v_mfma_f32_16x16x32_bf16 v[116:119], v[80:83], v[100:103], v[116:119]
  buffer_load_dwordx4 v213, s[20:23], s9 offen offset:1024 lds
  v_mfma_f32_16x16x32_bf16 v[124:127], v[84:87], v[104:107], v[124:127]
  ds_read2_b32 v[84:85], v7 offset0:16 offset1:17
  s_waitcnt lgkmcnt(2)
  v_add_f32 v132, v132, v128
  v_mfma_f32_16x16x32_bf16 v[120:123], v[80:83], v[104:107], v[120:123]
  ds_read2_b32 v[86:87], v7 offset0:18 offset1:19
  v_add_f32 v133, v133, v129
  v_add_f32 v134, v134, v130
  v_mfma_f32_16x16x32_bf16 v[124:127], v[80:83], v[108:111], v[124:127]
  ds_read2_b32 v[80:81], v7 offset0:144 offset1:145
  v_add_f32 v135, v135, v131
  v_add_f32 v136, v136, v8
  v_mfma_f32_16x16x32_bf16 v[112:115], v[76:79], v[100:103], v[112:115]
  ds_read2_b32 v[82:83], v7 offset0:146 offset1:147
  v_add_f32 v137, v137, v9
  v_add_f32 v138, v138, v10
  v_mfma_f32_16x16x32_bf16 v[116:119], v[76:79], v[104:107], v[116:119]
  ds_read_b128 v[100:103], v140 offset:576
  v_add_f32 v139, v139, v11
  v_cvt_pk_bf16_f32 v8, v132, v133
  v_mfma_f32_16x16x32_bf16 v[112:115], v[72:75], v[104:107], v[112:115]
  ds_read_b128 v[104:107], v140 offset:1088
  buffer_load_dwordx4 v214, s[20:23], s9 offen offset:2048 lds
  v_mfma_f32_16x16x32_bf16 v[120:123], v[76:79], v[108:111], v[120:123]
  s_add_u32 m0, s58, 68608
  s_add_u32 s9, s42, 1056768
  v_cvt_pk_bf16_f32 v10, v136, v137
  v_mfma_f32_16x16x32_bf16 v[116:119], v[72:75], v[108:111], v[116:119]
  v_cvt_pk_bf16_f32 v9, v134, v135
  v_cvt_pk_bf16_f32 v11, v138, v139
  v_mfma_f32_16x16x32_bf16 v[112:115], v[68:71], v[108:111], v[112:115]
  ds_read_b128 v[108:111], v140 offset:1600
  v_permlane16_swap_b32 v8, v10
  s_waitcnt lgkmcnt(7)
  v_mfma_f32_16x16x32_bf16 v[124:127], v[92:95], v[96:99], v[124:127]
  ds_read2_b32 v[92:93], v6 offset0:32 offset1:33
  v_permlane16_swap_b32 v9, v11
  v_mfma_f32_16x16x32_bf16 v[120:123], v[88:91], v[96:99], v[120:123]
  ds_read2_b32 v[94:95], v6 offset0:34 offset1:35
  buffer_load_dwordx4 v194, s[16:19], s9 offen offset:0 lds
  s_waitcnt lgkmcnt(5)
  v_mfma_f32_16x16x32_bf16 v[116:119], v[84:87], v[96:99], v[116:119]
  buffer_store_dwordx4 v[8:11], v15, s[4:7], s29 offen sc1
  v_mfma_f32_16x16x32_bf16 v[112:115], v[80:83], v[96:99], v[112:115]
  ds_read_b128 v[96:99], v140 offset:128
  s_waitcnt lgkmcnt(4)
  v_mfma_f32_16x16x32_bf16 v[124:127], v[88:91], v[100:103], v[124:127]
  ds_read2_b32 v[88:89], v6 offset0:160 offset1:161
  s_mul_i32 s63, s32, 0x20400
  v_mfma_f32_16x16x32_bf16 v[120:123], v[84:87], v[100:103], v[120:123]
  ds_read2_b32 v[90:91], v6 offset0:162 offset1:163
  s_and_b32 s63, s63, 0xe2000
  v_mfma_f32_16x16x32_bf16 v[116:119], v[80:83], v[100:103], v[116:119]
  buffer_load_dwordx4 v195, s[16:19], s9 offen offset:1024 lds
  v_mfma_f32_16x16x32_bf16 v[124:127], v[84:87], v[104:107], v[124:127]
  ds_read2_b32 v[84:85], v7 offset0:32 offset1:33
  s_lshl_b32 s51, s3, 12
  v_mfma_f32_16x16x32_bf16 v[120:123], v[80:83], v[104:107], v[120:123]
  ds_read2_b32 v[86:87], v7 offset0:34 offset1:35
  s_waitcnt lgkmcnt(7)
  v_mfma_f32_16x16x32_bf16 v[124:127], v[80:83], v[108:111], v[124:127]
  ds_read2_b32 v[80:81], v7 offset0:160 offset1:161
  s_add_u32 s63, s63, s51
  v_mfma_f32_16x16x32_bf16 v[112:115], v[60:63], v[100:103], v[112:115]
  ds_read2_b32 v[82:83], v7 offset0:162 offset1:163
  s_and_b32 s51, s51, 0x2000
  v_mfma_f32_16x16x32_bf16 v[116:119], v[60:63], v[104:107], v[116:119]
  ds_read_b128 v[100:103], v140 offset:640
  buffer_load_dwordx4 v196, s[16:19], s9 offen offset:2048 lds
  v_mfma_f32_16x16x32_bf16 v[112:115], v[56:59], v[104:107], v[112:115]
  ds_read_b128 v[104:107], v140 offset:1152
  s_add_u32 s63, s63, s51
  v_mfma_f32_16x16x32_bf16 v[120:123], v[60:63], v[108:111], v[120:123]
  s_add_u32 m0, s58, 90112
  s_add_u32 s9, s42, 1232896
  v_mfma_f32_16x16x32_bf16 v[116:119], v[56:59], v[108:111], v[116:119]
  s_bitset0_b32 exec_lo, 11
  buffer_load_dwordx4 v212, s[20:23], s9 offen offset:0 lds
  s_mov_b32 exec_lo, -1
  v_mfma_f32_16x16x32_bf16 v[112:115], v[52:55], v[108:111], v[112:115]
  ds_read_b128 v[108:111], v140 offset:1664
  s_waitcnt lgkmcnt(7)
  v_mfma_f32_16x16x32_bf16 v[124:127], v[92:95], v[96:99], v[124:127]
  ds_read2_b32 v[92:93], v6 offset0:48 offset1:49
  v_and_b32 v146, 63, v0
  v_mfma_f32_16x16x32_bf16 v[120:123], v[88:91], v[96:99], v[120:123]
  ds_read2_b32 v[94:95], v6 offset0:50 offset1:51
  s_waitcnt lgkmcnt(5)
  v_mfma_f32_16x16x32_bf16 v[116:119], v[84:87], v[96:99], v[116:119]
  buffer_load_dwordx4 v213, s[20:23], s9 offen offset:1024 lds
  v_mfma_f32_16x16x32_bf16 v[112:115], v[80:83], v[96:99], v[112:115]
  ds_read_b128 v[96:99], v140 offset:192
  s_waitcnt lgkmcnt(4)
  v_mfma_f32_16x16x32_bf16 v[124:127], v[88:91], v[100:103], v[124:127]
  ds_read2_b32 v[88:89], v6 offset0:176 offset1:177
  v_mov_b32 v147, 0x80000000
  v_mfma_f32_16x16x32_bf16 v[120:123], v[84:87], v[100:103], v[120:123]
  ds_read2_b32 v[90:91], v6 offset0:178 offset1:179
  v_and_b32 v148, 15, v0
  v_mfma_f32_16x16x32_bf16 v[116:119], v[80:83], v[100:103], v[116:119]
  v_bfe_u32 v149, v0, 4, 2
  v_and_b32 v150, 3, v0
  v_mfma_f32_16x16x32_bf16 v[124:127], v[84:87], v[104:107], v[124:127]
  ds_read2_b32 v[84:85], v7 offset0:48 offset1:49
  s_lshl_b32 s51, s32, 10
  v_mfma_f32_16x16x32_bf16 v[120:123], v[80:83], v[104:107], v[120:123]
  ds_read2_b32 v[86:87], v7 offset0:50 offset1:51
  s_waitcnt lgkmcnt(7)
  v_mfma_f32_16x16x32_bf16 v[124:127], v[80:83], v[108:111], v[124:127]
  ds_read2_b32 v[80:81], v7 offset0:176 offset1:177
  buffer_load_dwordx4 v214, s[20:23], s9 offen offset:2048 lds
  v_mfma_f32_16x16x32_bf16 v[112:115], v[44:47], v[100:103], v[112:115]
  ds_read2_b32 v[82:83], v7 offset0:178 offset1:179
  v_mov_b32 v2, s51
  v_mfma_f32_16x16x32_bf16 v[116:119], v[44:47], v[104:107], v[116:119]
  ds_read_b128 v[100:103], v140 offset:704
  s_add_u32 m0, s58, 93184
  s_add_u32 s9, s42, 1232896
  v_mfma_f32_16x16x32_bf16 v[112:115], v[40:43], v[104:107], v[112:115]
  ds_read_b128 v[104:107], v140 offset:1216
  s_waitcnt vmcnt(5)
  s_barrier
  v_mfma_f32_16x16x32_bf16 v[120:123], v[44:47], v[108:111], v[120:123]
  buffer_load_dwordx4 v194, s[16:19], s9 offen offset:0 lds
  v_mfma_f32_16x16x32_bf16 v[116:119], v[40:43], v[108:111], v[116:119]
  buffer_atomic_sub v4, v1, s[4:7], s40 offen sc1
  v_mfma_f32_16x16x32_bf16 v[112:115], v[36:39], v[108:111], v[112:115]
  ds_read_b128 v[108:111], v140 offset:1728
  ds_read_b64_tr_b16 a[32:33], v215 offset:0
  s_waitcnt lgkmcnt(8)
  v_mfma_f32_16x16x32_bf16 v[124:127], v[92:95], v[96:99], v[124:127]
  buffer_load_dwordx4 v195, s[16:19], s9 offen offset:1024 lds
  v_mfma_f32_16x16x32_bf16 v[120:123], v[88:91], v[96:99], v[120:123]
  ds_read_b64_tr_b16 a[96:97], v197 offset:3072
  ds_read_b64_tr_b16 a[160:161], v216 offset:0
  s_waitcnt lgkmcnt(6)
  v_mfma_f32_16x16x32_bf16 v[116:119], v[84:87], v[96:99], v[116:119]
  ds_read_b64_tr_b16 a[34:35], v215 offset:6144
  ds_read_b64_tr_b16 a[98:99], v197 offset:9216
  v_mfma_f32_16x16x32_bf16 v[112:115], v[80:83], v[96:99], v[112:115]
  ds_read_b64_tr_b16 a[162:163], v216 offset:6144
  ds_read_b64_tr_b16 a[36:37], v215 offset:12288
  s_waitcnt lgkmcnt(8)
  v_mfma_f32_16x16x32_bf16 v[124:127], v[88:91], v[100:103], v[124:127]
  buffer_load_dwordx4 v196, s[16:19], s9 offen offset:2048 lds
  v_mfma_f32_16x16x32_bf16 v[120:123], v[84:87], v[100:103], v[120:123]
  ds_read_b64_tr_b16 a[100:101], v197 offset:15360
  ds_read_b64_tr_b16 a[164:165], v216 offset:12288
  v_mfma_f32_16x16x32_bf16 v[116:119], v[80:83], v[100:103], v[116:119]
  ds_read_b64_tr_b16 a[38:39], v215 offset:18432
  ds_read_b64_tr_b16 a[102:103], v197 offset:21504
  v_mfma_f32_16x16x32_bf16 v[124:127], v[84:87], v[104:107], v[124:127]
  ds_read_b64_tr_b16 a[166:167], v216 offset:18432
  ds_read_b64_tr_b16 a[40:41], v215 offset:24576
  v_mfma_f32_16x16x32_bf16 v[120:123], v[80:83], v[104:107], v[120:123]
  s_lshl2_add_u32 s8, s2, s3
  v_and_b32 v204, 63, v0
  s_mul_i32 s8, s8, 1408
  v_lshlrev_b32 v204, 7, v204
  s_mov_b64 exec, 0x7ff
  buffer_load_dword v204, v204, s[24:27], s8 offen
  s_mov_b64 exec, -1
  s_waitcnt lgkmcnt(13)
  v_mfma_f32_16x16x32_bf16 v[124:127], v[80:83], v[108:111], v[124:127]
  s_lshr_b32 s8, s2, 3
  v_and_b32 v205, 63, v0
  s_lshl2_add_u32 s8, s8, s3
  s_mul_i32 s8, s8, 11264
  v_lshl_add_u32 v205, v205, 10, s8
  s_sub_u32 s8, 384, s24
  s_and_b32 s8, s8, 0x380
  s_mov_b64 exec, 0x7ff
  buffer_load_dword v205, v205, s[24:27], s8 offen
  s_mov_b64 exec, -1
  v_mfma_f32_16x16x32_bf16 v[112:115], v[28:31], v[100:103], v[112:115]
  ds_read_b64_tr_b16 a[104:105], v197 offset:27648
  ds_read_b64_tr_b16 a[168:169], v216 offset:24576
  v_mfma_f32_16x16x32_bf16 v[116:119], v[28:31], v[104:107], v[116:119]
  ds_read_b64_tr_b16 a[42:43], v215 offset:30720
  ds_read_b64_tr_b16 a[106:107], v197 offset:33792
  v_mfma_f32_16x16x32_bf16 v[112:115], v[24:27], v[104:107], v[112:115]
  ds_read_b64_tr_b16 a[170:171], v216 offset:30720
  ds_read_b64_tr_b16 a[44:45], v215 offset:36864
  v_mfma_f32_16x16x32_bf16 v[120:123], v[28:31], v[108:111], v[120:123]
  ds_read_b64_tr_b16 a[108:109], v197 offset:39936
  ds_read_b64_tr_b16 a[172:173], v216 offset:36864
  v_mfma_f32_16x16x32_bf16 v[116:119], v[24:27], v[108:111], v[116:119]
  s_or_b32 s11, s11, s3
  s_cselect_b32 s10, 0x80000000, s10
  s_mov_b64 exec, 0xff0000
  buffer_load_dword v206, v207, s[4:7], s10 offen sc1
  s_mov_b64 exec, -1
  v_mfma_f32_16x16x32_bf16 v[112:115], v[20:23], v[108:111], v[112:115]
  ds_read_b64_tr_b16 a[46:47], v215 offset:43008
  ds_read_b64_tr_b16 a[110:111], v197 offset:46080
  v_cmp_eq_u32 vcc, 0, v0
  s_nop 1
  v_cndmask_b32 v2, v147, v2, vcc
  ds_read_b64_tr_b16 a[174:175], v216 offset:43008
  v_mfma_f32_16x16x32_bf16 v[244:247], a[16:19], v[228:231], v[244:247]
  v_mfma_f32_16x16x32_bf16 v[248:251], a[80:83], v[228:231], v[248:251]
  v_pk_mul_f32 v[232:233], v[232:233], s[46:47]
  v_pk_mul_f32 v[236:237], v[236:237], s[46:47]
  v_pk_mul_f32 v[234:235], v[234:235], s[46:47]
  v_pk_mul_f32 v[238:239], v[238:239], s[46:47]
  v_fma_f32 v233, -v232, v232, v233
  v_fma_f32 v237, -v236, v236, v237
  v_mfma_f32_16x16x32_bf16 v[252:255], a[144:147], v[228:231], v[252:255]
  v_mfma_f32_16x16x32_bf16 v[244:247], a[20:23], v[228:231], v[244:247]
  v_fma_f32 v235, -v234, v234, v235
  v_fma_f32 v239, -v238, v238, v239
  v_cvt_pk_bf16_f32 v233, v233, v235
  v_cvt_pk_bf16_f32 v237, v237, v239
  v_cvt_pk_bf16_f32 v232, v232, v234
  v_mfma_f32_16x16x32_bf16 v[248:251], a[84:87], v[228:231], v[248:251]
  v_mfma_f32_16x16x32_bf16 v[252:255], a[148:151], v[228:231], v[252:255]
  v_cvt_pk_bf16_f32 v236, v236, v238
  v_pk_max_i16 v233, v233, 0
  v_pk_max_i16 v237, v237, 0
  v_lshlrev_b32 v96, 16, v232
  v_lshlrev_b32 v98, 16, v236
  v_mfma_f32_16x16x32_bf16 v[244:247], a[24:27], v[228:231], v[244:247]
  v_mfma_f32_16x16x32_bf16 v[248:251], a[88:91], v[228:231], v[248:251]
  v_and_b32 v97, 0xffff0000, v232
  v_and_b32 v99, 0xffff0000, v236
  v_lshlrev_b32 v100, 16, v233
  v_lshlrev_b32 v102, 16, v237
  v_and_b32 v101, 0xffff0000, v233
  v_mfma_f32_16x16x32_bf16 v[252:255], a[152:155], v[228:231], v[252:255]
  v_mfma_f32_16x16x32_bf16 v[244:247], a[28:31], v[228:231], v[244:247]
  v_and_b32 v103, 0xffff0000, v237
  v_pk_add_f32 v[100:101], v[100:101], s[48:49]
  v_pk_add_f32 v[102:103], v[102:103], s[48:49]
  v_lshlrev_b32 v80, 16, v240
  v_lshlrev_b32 v84, 16, v242
  v_cvt_pk_bf16_f32 v233, v100, v101
  v_mfma_f32_16x16x32_bf16 v[248:251], a[92:95], v[228:231], v[248:251]
  v_mfma_f32_16x16x32_bf16 v[252:255], a[156:159], v[228:231], v[252:255]
  v_cvt_pk_bf16_f32 v237, v102, v103
  v_lshlrev_b32 v82, 16, v241
  v_lshlrev_b32 v86, 16, v243
  v_lshlrev_b32 v100, 16, v233
  v_lshlrev_b32 v102, 16, v237
  s_waitcnt lgkmcnt(0)
  v_mfma_f32_16x16x32_bf16 v[244:247], a[32:35], v[228:231], v[244:247]
  v_and_b32 v81, 0xffff0000, v240
  v_and_b32 v85, 0xffff0000, v242
  v_and_b32 v101, 0xffff0000, v233
  v_and_b32 v103, 0xffff0000, v237
  v_and_b32 v83, 0xffff0000, v241
  v_mfma_f32_16x16x32_bf16 v[248:251], a[96:99], v[228:231], v[248:251]
  v_mfma_f32_16x16x32_bf16 v[252:255], a[160:163], v[228:231], v[252:255]
  v_and_b32 v87, 0xffff0000, v243
  v_sqrt_f32 v100, v100
  v_sqrt_f32 v102, v102
  v_pk_add_f32 v[88:89], v[80:81], v[96:97] op_sel:[0,0] op_sel_hi:[1,0] neg_lo:[0,1] neg_hi:[0,1]
  v_pk_add_f32 v[92:93], v[84:85], v[98:99] op_sel:[0,0] op_sel_hi:[1,0] neg_lo:[0,1] neg_hi:[0,1]
  v_mfma_f32_16x16x32_bf16 v[244:247], a[36:39], v[228:231], v[244:247]
  v_mfma_f32_16x16x32_bf16 v[248:251], a[100:103], v[228:231], v[248:251]
  v_sqrt_f32 v101, v101
  v_sqrt_f32 v103, v103
  v_pk_add_f32 v[90:91], v[82:83], v[96:97] op_sel:[0,1] op_sel_hi:[1,1] neg_lo:[0,1] neg_hi:[0,1]
  v_pk_add_f32 v[94:95], v[86:87], v[98:99] op_sel:[0,1] op_sel_hi:[1,1] neg_lo:[0,1] neg_hi:[0,1]
  v_cvt_pk_bf16_f32 v233, v100, v101
  v_cvt_pk_bf16_f32 v237, v102, v103
  v_mfma_f32_16x16x32_bf16 v[252:255], a[164:167], v[228:231], v[252:255]
  v_mfma_f32_16x16x32_bf16 v[244:247], a[40:43], v[228:231], v[244:247]
  v_cvt_pk_bf16_f32 v240, v88, v89
  v_cvt_pk_bf16_f32 v242, v92, v93
  v_lshlrev_b32 v100, 16, v233
  v_lshlrev_b32 v102, 16, v237
  v_cvt_pk_bf16_f32 v241, v90, v91
  v_mfma_f32_16x16x32_bf16 v[248:251], a[104:107], v[228:231], v[248:251]
  v_mfma_f32_16x16x32_bf16 v[252:255], a[168:171], v[228:231], v[252:255]
  v_cvt_pk_bf16_f32 v243, v94, v95
  v_and_b32 v101, 0xffff0000, v233
  v_and_b32 v103, 0xffff0000, v237
  v_lshlrev_b32 v88, 16, v240
  v_lshlrev_b32 v92, 16, v242
  v_mfma_f32_16x16x32_bf16 v[244:247], a[44:47], v[228:231], v[244:247]
  v_mfma_f32_16x16x32_bf16 v[248:251], a[108:111], v[228:231], v[248:251]
  v_rcp_f32 v100, v100
  v_rcp_f32 v102, v102
  v_lshlrev_b32 v90, 16, v241
  v_lshlrev_b32 v94, 16, v243
  v_rcp_f32 v101, v101
  v_mfma_f32_16x16x32_bf16 v[252:255], a[172:175], v[228:231], v[252:255]
  v_rcp_f32 v103, v103
  v_and_b32 v89, 0xffff0000, v240
  v_and_b32 v93, 0xffff0000, v242
  v_and_b32 v91, 0xffff0000, v241
  v_and_b32 v95, 0xffff0000, v243
  v_pk_mul_f32 v[88:89], v[88:89], v[100:101] op_sel:[0,0] op_sel_hi:[1,0]
  v_pk_mul_f32 v[90:91], v[90:91], v[100:101] op_sel:[0,1] op_sel_hi:[1,1]
  v_pk_mul_f32 v[92:93], v[92:93], v[102:103] op_sel:[0,0] op_sel_hi:[1,0]
  v_pk_mul_f32 v[94:95], v[94:95], v[102:103] op_sel:[0,1] op_sel_hi:[1,1]
  v_cvt_pk_bf16_f32 v240, v88, v90
  v_cvt_pk_bf16_f32 v241, v92, v94
  ds_write_b64 v141, v[240:241] offset:2048
  v_cvt_pk_bf16_f32 v242, v89, v91
  v_cvt_pk_bf16_f32 v243, v93, v95
  ds_write_b64 v141, v[242:243] offset:6656
  v_fma_f32 v232, v88, s44, v80
  v_fma_f32 v233, v90, s44, v82
  v_fma_f32 v234, v92, s44, v84
  v_fma_f32 v235, v94, s44, v86
  ds_write_b128 v12, v[232:235] offset:0
  v_fma_f32 v236, v89, s45, v81
  v_fma_f32 v237, v91, s45, v83
  v_fma_f32 v238, v93, s45, v85
  v_fma_f32 v239, v95, s45, v87
  ds_write_b128 v12, v[236:239] offset:4096
  s_mov_b64 exec, 255
  ds_write2st64_b64 v225, v[228:229], v[228:229] offset0:128 offset1:128
  s_mov_b64 exec, -1
  s_waitcnt lgkmcnt(0)
  s_barrier
  ds_read_b128 v[80:83], v140 offset:2240
  ds_read_b128 v[84:87], v140 offset:2752
  ds_read_b128 v[88:91], v140 offset:3264
  ds_read_b128 v[92:95], v140 offset:3776
  ds_read_b128 v[96:99], v140 offset:2176
  ds_read_b128 v[100:103], v140 offset:2688
  ds_read_b128 v[104:107], v140 offset:3200
  ds_read_b128 v[108:111], v140 offset:3712
  ds_read_b128 v[132:135], v13 offset:0
  ds_read_b128 v[136:139], v13 offset:1024
  s_lshl_b32 s51, s36, 1
  s_lshr_b32 s52, s3, 1
  s_add_u32 s51, s51, s52
  s_lshl_b32 s51, s51, 7
  s_and_b32 s53, s51, 0xe000
  s_add_u32 s51, s51, s53
  s_and_b32 s52, s3, 1
  s_lshl_b32 s53, s52, 13
  s_add_u32 s51, s51, s53
  s_add_u32 s29, s51, s38
  s_add_u32 s29, s29, 1048576
  v_xor_b32 v142, 2048, v14
  s_waitcnt lgkmcnt(9)
  v_mfma_f32_16x16x32_bf16 v[112:115], v[16:19], v[80:83], v[112:115]
  v_lshrrev_b32 v151, 3, v146
  v_bfe_u32 v152, v146, 1, 2
  v_mfma_f32_16x16x32_bf16 v[116:119], v[20:23], v[80:83], v[116:119]
  v_bfe_u32 v153, v146, 4, 1
  v_xor_b32 v152, v152, v153
  v_mfma_f32_16x16x32_bf16 v[120:123], v[24:27], v[80:83], v[120:123]
  v_lshlrev_b32 v151, 10, v151
  v_and_b32 v153, 1, v146
  v_mfma_f32_16x16x32_bf16 v[124:127], v[28:31], v[80:83], v[124:127]
  ds_read_b128 v[80:83], v140 offset:2112
  s_waitcnt lgkmcnt(9)
  v_mfma_f32_16x16x32_bf16 v[116:119], v[16:19], v[84:87], v[116:119]
  v_lshl_add_u32 v151, v153, 4, v151
  v_xor_b32 v153, 2, v152
  v_mfma_f32_16x16x32_bf16 v[120:123], v[20:23], v[84:87], v[120:123]
  v_lshl_add_u32 v219, v152, 5, v151
  v_lshl_add_u32 v153, v153, 5, v151
  v_mfma_f32_16x16x32_bf16 v[124:127], v[24:27], v[84:87], v[124:127]
  ds_read_b128 v[84:87], v140 offset:2624
  s_waitcnt lgkmcnt(8)
  v_mfma_f32_16x16x32_bf16 v[120:123], v[16:19], v[88:91], v[120:123]
  v_add_u32 v220, 7168, v153
  v_lshrrev_b32 v154, 2, v148
  v_mfma_f32_16x16x32_bf16 v[124:127], v[20:23], v[88:91], v[124:127]
  ds_read_b128 v[88:91], v140 offset:3136
  v_lshl_add_u32 v151, v149, 3, v154
  v_mfma_f32_16x16x32_bf16 v[124:127], v[16:19], v[92:95], v[124:127]
  ds_read_b128 v[92:95], v140 offset:3648
  s_waitcnt lgkmcnt(6)
  v_mfma_f32_16x16x32_bf16 v[112:115], v[32:35], v[96:99], v[112:115]
  v_mov_b32 v5, 0
  buffer_atomic_add v5, v3, s[4:7], s40 offen sc0 sc1
  v_mfma_f32_16x16x32_bf16 v[116:119], v[36:39], v[96:99], v[116:119]
  v_lshlrev_b32 v151, 7, v151
  v_lshl_add_u32 v151, v150, 3, v151
  v_mfma_f32_16x16x32_bf16 v[120:123], v[40:43], v[96:99], v[120:123]
  s_lshl_b32 s51, s3, 12
  v_add_u32 v151, s51, v151
  v_mfma_f32_16x16x32_bf16 v[124:127], v[44:47], v[96:99], v[124:127]
  ds_read_b128 v[96:99], v140 offset:2048
  v_lshrrev_b32 v154, 1, v154
  v_mfma_f32_16x16x32_bf16 v[116:119], v[32:35], v[100:103], v[116:119]
  v_and_b32 v152, 1, v149
  v_lshl_add_u32 v154, v152, 1, v154
  v_mfma_f32_16x16x32_bf16 v[120:123], v[36:39], v[100:103], v[120:123]
  v_xor_b32 v154, s3, v154
  v_xor_b32 v152, 0, v154
  v_mfma_f32_16x16x32_bf16 v[124:127], v[40:43], v[100:103], v[124:127]
  ds_read_b128 v[100:103], v140 offset:2560
  v_lshl_add_u32 v208, v152, 5, v151
  v_mfma_f32_16x16x32_bf16 v[120:123], v[32:35], v[104:107], v[120:123]
  v_add_u32 v221, 0x10000, v208
  v_xor_b32 v152, 1, v154
  v_mfma_f32_16x16x32_bf16 v[124:127], v[36:39], v[104:107], v[124:127]
  ds_read_b128 v[104:107], v140 offset:3072
  v_lshl_add_u32 v209, v152, 5, v151
  v_mfma_f32_16x16x32_bf16 v[124:127], v[32:35], v[108:111], v[124:127]
  ds_read_b128 v[108:111], v140 offset:3584
  s_waitcnt lgkmcnt(7)
  v_mfma_f32_16x16x32_bf16 v[112:115], v[48:51], v[80:83], v[112:115]
  v_add_u32 v222, 0x10000, v209
  v_xor_b32 v152, 2, v154
wpad_0_2:
  s_cbranch_execz wpad_0_6
  v_mfma_f32_16x16x32_bf16 v[116:119], v[52:55], v[80:83], v[116:119]
  v_lshl_add_u32 v210, v152, 5, v151
  v_add_u32 v223, 0x10000, v210
  v_mfma_f32_16x16x32_bf16 v[120:123], v[56:59], v[80:83], v[120:123]
  v_xor_b32 v152, 3, v154
  v_lshl_add_u32 v211, v152, 5, v151
  v_mfma_f32_16x16x32_bf16 v[124:127], v[60:63], v[80:83], v[124:127]
  v_add_u32 v224, 0x10000, v211
  s_waitcnt lgkmcnt(6)
  v_mfma_f32_16x16x32_bf16 v[116:119], v[48:51], v[84:87], v[116:119]
  s_lshr_b32 s10, s33, 2
  s_mul_i32 s10, s10, 49152
  v_mfma_f32_16x16x32_bf16 v[120:123], v[52:55], v[84:87], v[120:123]
  s_lshl_b32 s11, s3, 17
  s_add_u32 s10, s10, s39
  v_mfma_f32_16x16x32_bf16 v[124:127], v[56:59], v[84:87], v[124:127]
  s_and_b32 s11, s11, 0x40000
  s_waitcnt lgkmcnt(4)
  v_mfma_f32_16x16x32_bf16 v[120:123], v[48:51], v[88:91], v[120:123]
  s_add_u32 s10, s10, s11
  s_and_b32 s11, s33, 3
  v_mfma_f32_16x16x32_bf16 v[124:127], v[52:55], v[88:91], v[124:127]
  s_lshl_b32 s11, s11, 9
  v_and_b32 v207, 31, v0
  v_mfma_f32_16x16x32_bf16 v[124:127], v[48:51], v[92:95], v[124:127]
  v_bfe_u32 v6, v0, 4, 2
  s_waitcnt lgkmcnt(3)
  v_mfma_f32_16x16x32_bf16 v[112:115], v[64:67], v[96:99], v[112:115]
  v_and_b32 v7, 63, v0
  v_lshlrev_b32 v6, 5, v6
  v_mfma_f32_16x16x32_bf16 v[116:119], v[68:71], v[96:99], v[116:119]
  v_lshlrev_b32 v7, 4, v7
  v_xor_b32 v6, v7, v6
  v_mfma_f32_16x16x32_bf16 v[120:123], v[72:75], v[96:99], v[120:123]
  s_lshl_b32 s55, s3, 12
  s_add_u32 s57, s63, s38
  v_mfma_f32_16x16x32_bf16 v[124:127], v[76:79], v[96:99], v[124:127]
  s_add_u32 m0, s55, 0
  s_waitcnt lgkmcnt(2)
  v_mfma_f32_16x16x32_bf16 v[116:119], v[64:67], v[100:103], v[116:119]
  v_bfe_u32 v203, v0, 5, 2
  v_lshl_add_u32 v207, v207, 4, s11
  v_mfma_f32_16x16x32_bf16 v[120:123], v[68:71], v[100:103], v[120:123]
  v_lshl_add_u32 v207, v203, 22, v207
  v_add_u32 v207, 36864, v207
  v_mfma_f32_16x16x32_bf16 v[124:127], v[72:75], v[100:103], v[124:127]
  s_waitcnt lgkmcnt(0)
  v_mfma_f32_16x16x32_bf16 v[120:123], v[64:67], v[104:107], v[120:123]
  v_mfma_f32_16x16x32_bf16 v[124:127], v[68:71], v[104:107], v[124:127]
  v_mfma_f32_16x16x32_bf16 v[124:127], v[64:67], v[108:111], v[124:127]
  s_cmp_eq_u32 s52, 0
  s_nop 6
  s_cbranch_scc1 cx_3_0
  ds_write_b128 v14, v[112:115] offset:0
  ds_write_b128 v14, v[116:119] offset:1024
  v_pk_add_f32 v[132:133], v[132:133], v[120:121]
  v_pk_add_f32 v[134:135], v[134:135], v[122:123]
  v_pk_add_f32 v[136:137], v[136:137], v[124:125]
  v_pk_add_f32 v[138:139], v[138:139], v[126:127]
  s_branch cx_3_1
cx_3_0:
  ds_write_b128 v14, v[120:123] offset:0
  ds_write_b128 v14, v[124:127] offset:1024
  v_pk_add_f32 v[132:133], v[132:133], v[112:113]
  v_pk_add_f32 v[134:135], v[134:135], v[114:115]
  v_pk_add_f32 v[136:137], v[136:137], v[116:117]
  v_pk_add_f32 v[138:139], v[138:139], v[118:119]
cx_3_1:
  s_waitcnt vmcnt(0)
  v_cmp_ne_u32 vcc, 0, v5
  s_cbranch_vccnz poll_2_s
poll_2_ok:
  s_waitcnt lgkmcnt(0)
  s_barrier
  ds_read_b128 v[128:131], v142
  ds_read_b128 v[8:11], v142 offset:1024
  ds_read_b64_tr_b16 a[48:49], v217 offset:0
  ds_read_b64_tr_b16 a[112:113], v198 offset:3072
  ds_read_b64_tr_b16 a[176:177], v218 offset:0
  buffer_load_dwordx4 v6, s[4:7], s57 offen offset:0 sc1 lds
  ds_read_b64_tr_b16 a[50:51], v217 offset:6144
  buffer_load_dwordx4 v6, s[4:7], s57 offen offset:1024 sc1 lds
  ds_read_b64_tr_b16 a[114:115], v198 offset:9216
  buffer_load_dwordx4 v6, s[4:7], s57 offen offset:2048 sc1 lds
  ds_read_b64_tr_b16 a[178:179], v218 offset:6144
  buffer_load_dwordx4 v6, s[4:7], s57 offen offset:3072 sc1 lds
  ds_read_b64_tr_b16 a[52:53], v217 offset:12288
  ds_read_b64_tr_b16 a[116:117], v198 offset:15360
  s_add_u32 m0, m0, 16384
  ds_read_b64_tr_b16 a[180:181], v218 offset:12288
  s_xor_b32 s57, s57, 32768
  ds_read_b64_tr_b16 a[54:55], v217 offset:18432
  buffer_load_dwordx4 v6, s[4:7], s57 offen offset:0 sc1 lds
  ds_read_b64_tr_b16 a[118:119], v198 offset:21504
  buffer_load_dwordx4 v6, s[4:7], s57 offen offset:1024 sc1 lds
  ds_read_b64_tr_b16 a[182:183], v218 offset:18432
  buffer_load_dwordx4 v6, s[4:7], s57 offen offset:2048 sc1 lds
  ds_read_b64_tr_b16 a[56:57], v217 offset:24576
  buffer_load_dwordx4 v6, s[4:7], s57 offen offset:3072 sc1 lds
  ds_read_b64_tr_b16 a[120:121], v198 offset:27648
  ds_read_b64_tr_b16 a[184:185], v218 offset:24576
  s_add_u32 m0, m0, 16384
  ds_read_b64_tr_b16 a[58:59], v217 offset:30720
  s_xor_b32 s57, s57, 98304
  ds_read_b64_tr_b16 a[122:123], v198 offset:33792
  buffer_load_dwordx4 v6, s[4:7], s57 offen offset:0 sc1 lds
  ds_read_b64_tr_b16 a[186:187], v218 offset:30720
  buffer_load_dwordx4 v6, s[4:7], s57 offen offset:1024 sc1 lds
  ds_read_b64_tr_b16 a[60:61], v217 offset:36864
  buffer_load_dwordx4 v6, s[4:7], s57 offen offset:2048 sc1 lds
  ds_read_b64_tr_b16 a[124:125], v198 offset:39936
  buffer_load_dwordx4 v6, s[4:7], s57 offen offset:3072 sc1 lds
  ds_read_b64_tr_b16 a[188:189], v218 offset:36864
  ds_read_b64_tr_b16 a[62:63], v217 offset:43008
  s_add_u32 m0, m0, 16384
  ds_read_b64_tr_b16 a[126:127], v198 offset:46080
  s_xor_b32 s57, s57, 32768
  ds_read_b64_tr_b16 a[190:191], v218 offset:43008
  buffer_load_dwordx4 v6, s[4:7], s57 offen offset:0 sc1 lds
  s_waitcnt lgkmcnt(15)
  v_pk_add_f32 v[132:133], v[132:133], v[128:129]
  v_pk_add_f32 v[136:137], v[136:137], v[8:9]
  v_pk_add_f32 v[134:135], v[134:135], v[130:131]
  v_pk_add_f32 v[138:139], v[138:139], v[10:11]
  v_cvt_pk_bf16_f32 v8, v132, v133
  v_cvt_pk_bf16_f32 v10, v136, v137
  v_cvt_pk_bf16_f32 v9, v134, v135
  v_cvt_pk_bf16_f32 v11, v138, v139
  v_permlane16_swap_b32 v8, v10
  s_nop 0
  v_permlane16_swap_b32 v9, v11
  buffer_store_dwordx4 v[8:11], v15, s[4:7], s29 offen sc1
  s_waitcnt lgkmcnt(0)
  v_mfma_f32_16x16x32_bf16 v[244:247], a[48:51], v[228:231], v[244:247]
  v_and_b32 v128, 15, v0
  v_bfe_u32 v129, v0, 4, 2
  v_bfe_u32 v130, v0, 2, 4
  v_lshlrev_b32 v131, 7, v130
  v_mfma_f32_16x16x32_bf16 v[248:251], a[112:115], v[228:231], v[248:251]
  v_and_b32 v132, 3, v0
  v_lshl_add_u32 v131, v132, 3, v131
  v_bfe_u32 v130, v130, 1, 2
  v_xor_b32 v130, s3, v130
  v_mfma_f32_16x16x32_bf16 v[252:255], a[176:179], v[228:231], v[252:255]
  v_lshl_add_u32 v96, v130, 5, v131
  s_mul_i32 s51, s3, 384
  s_add_u32 s51, s51, 156928
  v_lshl_add_u32 v131, v129, 4, s51
  v_mfma_f32_16x16x32_bf16 v[244:247], a[52:55], v[228:231], v[244:247]
  v_xor_b32 v97, 32, v96
  v_xor_b32 v98, 64, v96
  v_xor_b32 v99, 96, v96
  v_mfma_f32_16x16x32_bf16 v[248:251], a[116:119], v[228:231], v[248:251]
  v_mul_u32_u24 v225, 192, v132
  s_lshl_b32 s42, s3, 12
  v_add_u32 v225, v131, v225
  s_lshl_b32 s51, s3, 7
  v_mfma_f32_16x16x32_bf16 v[252:255], a[180:183], v[228:231], v[252:255]
  s_add_u32 s51, s51, 161792
  v_xor_b32 v130, s3, v129
  v_lshl_add_u32 v100, v128, 3, s51
  v_add_u32 v132, 1, v129
  v_mfma_f32_16x16x32_bf16 v[244:247], a[56:59], v[228:231], v[244:247]
  v_lshl_add_u32 v100, v129, 7, v100
  v_lshrrev_b32 v132, 2, v132
  s_bitcmp1_b32 s3, 0
  s_cselect_b32 s51, -3584, 0
  v_mfma_f32_16x16x32_bf16 v[248:251], a[120:123], v[228:231], v[248:251]
  s_cselect_b32 s52, 31, 3
  v_lshlrev_b32 v128, 4, v128
  v_and_b32 v133, 1, v130
  v_mfma_f32_16x16x32_bf16 v[252:255], a[184:187], v[228:231], v[252:255]
  v_lshl_add_u32 v7, v129, 9, v128
  v_lshl_add_u32 v133, v133, 8, v128
  v_lshrrev_b32 v130, 1, v129
  v_lshl_add_u32 v140, v130, 9, v133
  v_mfma_f32_16x16x32_bf16 v[104:107], a[60:63], v[228:231], v[244:247]
  v_lshl_add_u32 v141, v130, s52, v133
  v_mad_i32_i24 v100, v132, s51, v100
  s_mul_i32 s18, s3, 2816
  s_add_u32 s18, s18, s35
  v_mfma_f32_16x16x32_bf16 v[108:111], a[124:127], v[228:231], v[248:251]
  s_lshl_b32 s19, s34, 13
  s_lshl_b32 s18, s18, 7
  s_add_u32 s17, s18, s19
  s_sub_u32 s20, s18, s19
  v_mfma_f32_16x16x32_bf16 v[112:115], a[188:191], v[228:231], v[252:255]
  s_lshl_b32 s19, s19, 2
  s_add_u32 s16, s18, s19
  s_sub_u32 s19, s18, s19
  s_add_u32 s28, s40, 65536
  s_waitcnt vmcnt(10)
  s_barrier
  ds_read_b64_tr_b16 v[72:73], v96 offset:0
  ds_read_b64_tr_b16 v[74:75], v96 offset:2048
  ds_read_b64_tr_b16 v[76:77], v97 offset:0
  ds_read_b64_tr_b16 v[78:79], v97 offset:2048
  ds_read_b64_tr_b16 v[80:81], v96 offset:4096
  ds_read_b64_tr_b16 v[82:83], v96 offset:6144
  ds_read_b64_tr_b16 v[84:85], v97 offset:4096
  ds_read_b64_tr_b16 v[86:87], v97 offset:6144
  s_waitcnt lgkmcnt(4)
  v_mfma_f32_16x16x32_bf16 v[16:19], a[0:3], v[72:75], 0
  ds_read_b64_tr_b16 v[88:89], v96 offset:8192
  buffer_store_dwordx4 v[228:231], v207, s[4:7], s10 offen sc1
  v_mfma_f32_16x16x32_bf16 v[20:23], a[64:67], v[72:75], 0
  ds_read_b64_tr_b16 v[90:91], v96 offset:10240
  s_and_b32 s62, s3, 1
  v_mfma_f32_16x16x32_bf16 v[24:27], a[128:131], v[72:75], 0
  ds_read_b64_tr_b16 v[92:93], v97 offset:8192
  buffer_load_dwordx4 v6, s[4:7], s57 offen offset:1024 sc1 lds
  v_mfma_f32_16x16x32_bf16 v[28:31], a[0:3], v[76:79], 0
  ds_read_b64_tr_b16 v[94:95], v97 offset:10240
  s_lshl2_add_u32 s31, s3, 2044
  v_mfma_f32_16x16x32_bf16 v[32:35], a[64:67], v[76:79], 0
  buffer_load_dwordx4 v6, s[4:7], s57 offen offset:2048 sc1 lds
  v_mfma_f32_16x16x32_bf16 v[36:39], a[128:131], v[76:79], 0
  s_mul_i32 s31, s31, s62
  s_waitcnt lgkmcnt(4)
  v_mfma_f32_16x16x32_bf16 v[16:19], a[4:7], v[80:83], v[16:19]
  ds_read_b64_tr_b16 v[72:73], v96 offset:12288
  buffer_load_dwordx4 v6, s[4:7], s57 offen offset:3072 sc1 lds
  v_mfma_f32_16x16x32_bf16 v[20:23], a[68:71], v[80:83], v[20:23]
  ds_read_b64_tr_b16 v[74:75], v96 offset:14336
  s_add_u32 m0, s42, 114688
  s_add_u32 s9, s16, 0
  v_mfma_f32_16x16x32_bf16 v[24:27], a[132:135], v[80:83], v[24:27]
  ds_read_b64_tr_b16 v[76:77], v97 offset:12288
  buffer_load_dwordx4 v219, s[24:27], s9 offen offset:0 lds
  v_mfma_f32_16x16x32_bf16 v[28:31], a[4:7], v[84:87], v[28:31]
  ds_read_b64_tr_b16 v[78:79], v97 offset:14336
  buffer_load_dwordx4 v220, s[24:27], s9 offen offset:1024 lds
  v_mfma_f32_16x16x32_bf16 v[32:35], a[68:71], v[84:87], v[32:35]
  s_waitcnt vmcnt(12)
  s_barrier
  s_add_u32 s9, s16, 14336
  v_mfma_f32_16x16x32_bf16 v[36:39], a[132:135], v[84:87], v[36:39]
  buffer_load_dwordx4 v219, s[24:27], s9 offen offset:2048 lds
  s_waitcnt lgkmcnt(4)
  v_mfma_f32_16x16x32_bf16 v[16:19], a[8:11], v[88:91], v[16:19]
  ds_read_b64_tr_b16 v[80:81], v96 offset:16384
  buffer_load_dwordx4 v220, s[24:27], s9 offen offset:3072 lds
  v_mfma_f32_16x16x32_bf16 v[20:23], a[72:75], v[88:91], v[20:23]
  ds_read_b64_tr_b16 v[82:83], v96 offset:18432
  s_add_u32 s31, s31, s11
  v_mfma_f32_16x16x32_bf16 v[24:27], a[136:139], v[88:91], v[24:27]
  ds_read_b64_tr_b16 v[84:85], v97 offset:16384
  s_add_u32 s31, s31, s10
  v_mfma_f32_16x16x32_bf16 v[28:31], a[8:11], v[92:95], v[28:31]
  ds_read_b64_tr_b16 v[86:87], v97 offset:18432
  s_mul_i32 s101, s62, 18432
  v_mfma_f32_16x16x32_bf16 v[32:35], a[72:75], v[92:95], v[32:35]
  s_add_u32 s101, s101, s31
  s_add_u32 s101, s101, 16384
  v_mfma_f32_16x16x32_bf16 v[36:39], a[136:139], v[92:95], v[36:39]
  v_and_b32 v128, 15, v0
  s_waitcnt lgkmcnt(4)
  v_mfma_f32_16x16x32_bf16 v[16:19], a[12:15], v[72:75], v[16:19]
  ds_read_b64_tr_b16 v[88:89], v96 offset:20480
  s_lshl_b32 s51, s3, 7
  v_mfma_f32_16x16x32_bf16 v[20:23], a[76:79], v[72:75], v[20:23]
  ds_read_b64_tr_b16 v[90:91], v96 offset:22528
  s_add_u32 m0, s42, 98304
  s_add_u32 s9, s16, 90112
  v_mfma_f32_16x16x32_bf16 v[24:27], a[140:143], v[72:75], v[24:27]
  ds_read_b64_tr_b16 v[92:93], v97 offset:20480
  buffer_load_dwordx4 v219, s[24:27], s9 offen offset:0 lds
  v_mfma_f32_16x16x32_bf16 v[28:31], a[12:15], v[76:79], v[28:31]
  ds_read_b64_tr_b16 v[94:95], v97 offset:22528
  buffer_load_dwordx4 v220, s[24:27], s9 offen offset:1024 lds
  v_mfma_f32_16x16x32_bf16 v[32:35], a[76:79], v[76:79], v[32:35]
  s_add_u32 s9, s16, 104448
  s_add_u32 s51, s51, 158720
  v_mfma_f32_16x16x32_bf16 v[36:39], a[140:143], v[76:79], v[36:39]
  buffer_load_dwordx4 v219, s[24:27], s9 offen offset:2048 lds
  s_waitcnt lgkmcnt(4)
  v_mfma_f32_16x16x32_bf16 v[16:19], a[16:19], v[80:83], v[16:19]
  ds_read_b64_tr_b16 v[72:73], v96 offset:24576
  v_lshl_add_u32 v128, v128, 3, s51
  v_mfma_f32_16x16x32_bf16 v[20:23], a[80:83], v[80:83], v[20:23]
  ds_read_b64_tr_b16 v[74:75], v96 offset:26624
  v_bfe_u32 v102, v0, 4, 2
  v_mfma_f32_16x16x32_bf16 v[24:27], a[144:147], v[80:83], v[24:27]
  ds_read_b64_tr_b16 v[76:77], v97 offset:24576
  s_add_u32 s31, s31, 34816
  v_mfma_f32_16x16x32_bf16 v[28:31], a[16:19], v[84:87], v[28:31]
  ds_read_b64_tr_b16 v[78:79], v97 offset:26624
  buffer_load_dwordx4 v220, s[24:27], s9 offen offset:3072 lds
  v_mfma_f32_16x16x32_bf16 v[32:35], a[80:83], v[84:87], v[32:35]
  v_mul_u32_u24 v102, 43, v102
  v_add_u32 v103, 172, v102
  v_mfma_f32_16x16x32_bf16 v[36:39], a[144:147], v[84:87], v[36:39]
  s_xor_b32 s31, s31, 0x40000
  s_waitcnt lgkmcnt(4)
  v_mfma_f32_16x16x32_bf16 v[16:19], a[20:23], v[88:91], v[16:19]
  ds_read_b64_tr_b16 v[80:81], v96 offset:28672
  s_lshl_b32 s62, s62, 10
  v_mfma_f32_16x16x32_bf16 v[20:23], a[84:87], v[88:91], v[20:23]
  ds_read_b64_tr_b16 v[82:83], v96 offset:30720
  s_add_u32 m0, s42, 81920
  s_add_u32 s9, s16, 180224
  v_mfma_f32_16x16x32_bf16 v[24:27], a[148:151], v[88:91], v[24:27]
  ds_read_b64_tr_b16 v[84:85], v97 offset:28672
  v_add_u32 v119, 344, v102
  v_mfma_f32_16x16x32_bf16 v[28:31], a[20:23], v[92:95], v[28:31]
  ds_read_b64_tr_b16 v[86:87], v97 offset:30720
  buffer_load_dwordx4 v219, s[24:27], s9 offen offset:0 lds
  v_mfma_f32_16x16x32_bf16 v[32:35], a[84:87], v[92:95], v[32:35]
  s_waitcnt vmcnt(15)
  s_waitcnt vmcnt(13)
  s_barrier
  buffer_atomic_sub v4, v1, s[4:7], s28 offen sc1
  v_mfma_f32_16x16x32_bf16 v[36:39], a[148:151], v[92:95], v[36:39]
  buffer_load_dwordx4 v220, s[24:27], s9 offen offset:1024 lds
  s_add_u32 s9, s16, 194560
  s_waitcnt lgkmcnt(4)
  v_mfma_f32_16x16x32_bf16 v[16:19], a[24:27], v[72:75], v[16:19]
  ds_read_b64_tr_b16 v[88:89], v96 offset:32768
  s_lshl2_add_u32 s62, s11, s62
  v_mfma_f32_16x16x32_bf16 v[20:23], a[88:91], v[72:75], v[20:23]
  ds_read_b64_tr_b16 v[90:91], v96 offset:34816
  v_and_b32 v102, 0x180, v102
  v_mfma_f32_16x16x32_bf16 v[24:27], a[152:155], v[72:75], v[24:27]
  ds_read_b64_tr_b16 v[92:93], v97 offset:32768
  s_add_u32 s100, s62, s10
  v_mfma_f32_16x16x32_bf16 v[28:31], a[24:27], v[76:79], v[28:31]
  ds_read_b64_tr_b16 v[94:95], v97 offset:34816
  v_and_b32 v103, 0x180, v103
  v_mfma_f32_16x16x32_bf16 v[32:35], a[88:91], v[76:79], v[32:35]
  buffer_load_dwordx4 v219, s[24:27], s9 offen offset:2048 lds
  v_mfma_f32_16x16x32_bf16 v[36:39], a[152:155], v[76:79], v[36:39]
  s_add_u32 s62, s62, 10240
  s_waitcnt lgkmcnt(4)
  v_mfma_f32_16x16x32_bf16 v[16:19], a[28:31], v[80:83], v[16:19]
  ds_read_b64_tr_b16 v[72:73], v96 offset:36864
  v_and_b32 v119, 0x180, v119
  v_mfma_f32_16x16x32_bf16 v[20:23], a[92:95], v[80:83], v[20:23]
  ds_read_b64_tr_b16 v[74:75], v96 offset:38912
  s_and_b32 s11, s62, 0x6000
  v_mfma_f32_16x16x32_bf16 v[24:27], a[156:159], v[80:83], v[24:27]
  ds_read_b64_tr_b16 v[76:77], v97 offset:36864
  v_xor_b32 v102, v128, v102
  v_mfma_f32_16x16x32_bf16 v[28:31], a[28:31], v[84:87], v[28:31]
  ds_read_b64_tr_b16 v[78:79], v97 offset:38912
  s_add_u32 s62, s62, s11
  v_mfma_f32_16x16x32_bf16 v[32:35], a[92:95], v[84:87], v[32:35]
  buffer_load_dwordx4 v220, s[24:27], s9 offen offset:3072 lds
  s_add_u32 m0, s42, 65536
  v_mfma_f32_16x16x32_bf16 v[36:39], a[156:159], v[84:87], v[36:39]
  s_add_u32 s9, s16, 270336
  s_waitcnt lgkmcnt(4)
  v_mfma_f32_16x16x32_bf16 v[16:19], a[32:35], v[88:91], v[16:19]
  ds_read_b64_tr_b16 v[80:81], v96 offset:40960
  v_xor_b32 v103, v128, v103
  v_mfma_f32_16x16x32_bf16 v[20:23], a[96:99], v[88:91], v[20:23]
  ds_read_b64_tr_b16 v[82:83], v96 offset:43008
  s_add_u32 s62, s62, s10
  v_mfma_f32_16x16x32_bf16 v[24:27], a[160:163], v[88:91], v[24:27]
  ds_read_b64_tr_b16 v[84:85], v97 offset:40960
  v_xor_b32 v119, v128, v119
  v_mfma_f32_16x16x32_bf16 v[28:31], a[32:35], v[92:95], v[28:31]
  ds_read_b64_tr_b16 v[86:87], v97 offset:43008
  v_and_b32 v70, 63, v0
  v_mfma_f32_16x16x32_bf16 v[32:35], a[96:99], v[92:95], v[32:35]
  buffer_load_dwordx4 v219, s[24:27], s9 offen offset:0 lds
  v_mfma_f32_16x16x32_bf16 v[36:39], a[160:163], v[92:95], v[36:39]
  s_xor_b32 s62, s62, 0x40000
  s_waitcnt lgkmcnt(4)
  v_mfma_f32_16x16x32_bf16 v[16:19], a[36:39], v[72:75], v[16:19]
  ds_read_b64_tr_b16 v[88:89], v96 offset:45056
  v_bfe_u32 v133, v0, 2, 4
  v_mfma_f32_16x16x32_bf16 v[20:23], a[100:103], v[72:75], v[20:23]
  ds_read_b64_tr_b16 v[90:91], v96 offset:47104
  v_lshrrev_b32 v71, 5, v0
  v_mfma_f32_16x16x32_bf16 v[24:27], a[164:167], v[72:75], v[24:27]
  ds_read_b64_tr_b16 v[92:93], v97 offset:45056
  s_lshl_b32 s51, s35, 13
  v_mfma_f32_16x16x32_bf16 v[28:31], a[36:39], v[76:79], v[28:31]
  ds_read_b64_tr_b16 v[94:95], v97 offset:47104
  buffer_load_dwordx4 v220, s[24:27], s9 offen offset:1024 lds
  v_mfma_f32_16x16x32_bf16 v[32:35], a[100:103], v[76:79], v[32:35]
  s_waitcnt vmcnt(15)
  s_barrier
  s_add_u32 s9, s16, 284672
  v_mfma_f32_16x16x32_bf16 v[36:39], a[164:167], v[76:79], v[36:39]
  buffer_load_dwordx4 v219, s[24:27], s9 offen offset:2048 lds
  s_waitcnt lgkmcnt(4)
  v_mfma_f32_16x16x32_bf16 v[16:19], a[40:43], v[80:83], v[16:19]
  ds_read_b64_tr_b16 v[72:73], v96 offset:49152
  s_waitcnt vmcnt(12)
  v_mfma_f32_16x16x32_bf16 v[20:23], a[104:107], v[80:83], v[20:23]
  ds_read_b64_tr_b16 v[74:75], v96 offset:51200
  ds_read_b64_tr_b16 a[206:207], v224 offset:49664
  v_mfma_f32_16x16x32_bf16 v[24:27], a[168:171], v[80:83], v[24:27]
  ds_read_b64_tr_b16 v[76:77], v97 offset:49152
  ds_read_b64_tr_b16 a[204:205], v224 offset:49152
  v_lshlrev_b32 v70, 4, v70
  v_mfma_f32_16x16x32_bf16 v[28:31], a[40:43], v[84:87], v[28:31]
  ds_read_b64_tr_b16 v[78:79], v97 offset:51200
  ds_read_b64_tr_b16 a[202:203], v223 offset:49664
  s_lshl_b32 s52, s3, 11
  v_mfma_f32_16x16x32_bf16 v[32:35], a[104:107], v[84:87], v[32:35]
  ds_read_b64_tr_b16 a[200:201], v223 offset:49152
  v_min_u32 v71, 1, v71
  v_add_u32 v70, 159744, v70
  v_mfma_f32_16x16x32_bf16 v[36:39], a[168:171], v[84:87], v[36:39]
  ds_read_b64_tr_b16 a[198:199], v222 offset:49664
  s_add_u32 s51, s51, s52
  s_waitcnt lgkmcnt(9)
  v_mfma_f32_16x16x32_bf16 v[16:19], a[44:47], v[88:91], v[16:19]
  ds_read_b64_tr_b16 v[80:81], v96 offset:53248
  ds_read_b64_tr_b16 a[196:197], v222 offset:49152
  s_add_u32 s51, s51, 0
  v_mfma_f32_16x16x32_bf16 v[20:23], a[108:111], v[88:91], v[20:23]
  ds_read_b64_tr_b16 v[82:83], v96 offset:55296
  ds_read_b64_tr_b16 a[194:195], v221 offset:49664
  s_mul_i32 s54, s35, 132
  v_mfma_f32_16x16x32_bf16 v[24:27], a[172:175], v[88:91], v[24:27]
  ds_read_b64_tr_b16 v[84:85], v97 offset:53248
  ds_read_b64_tr_b16 a[192:193], v221 offset:49152
  s_lshl_b32 s52, s34, 1
  v_mfma_f32_16x16x32_bf16 v[28:31], a[44:47], v[92:95], v[28:31]
  ds_read_b64_tr_b16 v[86:87], v97 offset:55296
  buffer_load_dwordx4 v220, s[24:27], s9 offen offset:3072 lds
  v_mfma_f32_16x16x32_bf16 v[32:35], a[108:111], v[92:95], v[32:35]
  s_mov_b32 exec_lo, 0x30003
  s_mov_b32 exec_hi, exec_lo
  ds_write_b128 v225, v[104:107] offset:0
  ds_write_b128 v225, v[108:111] offset:64
  ds_write_b128 v225, v[112:115] offset:128
  s_mov_b64 exec, -1
  v_mfma_f32_16x16x32_bf16 v[36:39], a[172:175], v[92:95], v[36:39]
  v_mov_b32 v124, -1
  v_mov_b32 v125, -1
  s_waitcnt lgkmcnt(13)
  v_mfma_f32_16x16x32_bf16 v[16:19], a[48:51], v[72:75], v[16:19]
  ds_read_b64_tr_b16 v[88:89], v96 offset:57344
  s_waitcnt vmcnt(9)
  v_lshl_add_u32 v71, v71, 31, v70
  v_mfma_f32_16x16x32_bf16 v[20:23], a[112:115], v[72:75], v[20:23]
  ds_read_b64_tr_b16 v[90:91], v96 offset:59392
  ds_read_b64_tr_b16 a[222:223], v224 offset:33280
  v_lshl_add_u32 v134, v133, 7, s51
  v_mfma_f32_16x16x32_bf16 v[24:27], a[176:179], v[72:75], v[24:27]
  ds_read_b64_tr_b16 v[92:93], v97 offset:57344
  ds_read_b64_tr_b16 a[220:221], v224 offset:32768
  s_and_b32 s54, s54, 0x20c
  v_mfma_f32_16x16x32_bf16 v[28:31], a[48:51], v[76:79], v[28:31]
  ds_read_b64_tr_b16 v[94:95], v97 offset:59392
  ds_read_b64_tr_b16 a[218:219], v223 offset:33280
  v_bfe_u32 v133, v133, 1, 2
  v_mfma_f32_16x16x32_bf16 v[32:35], a[112:115], v[76:79], v[32:35]
  ds_read_b64_tr_b16 a[216:217], v223 offset:32768
  v_mov_b32 v126, -1
  v_mov_b32 v127, -1
  v_mfma_f32_16x16x32_bf16 v[36:39], a[176:179], v[76:79], v[36:39]
  ds_read_b64_tr_b16 a[214:215], v222 offset:33280
  v_lshl_add_u32 v101, s3, 2, v70
  s_waitcnt lgkmcnt(12)
  v_mfma_f32_16x16x32_bf16 v[16:19], a[52:55], v[80:83], v[16:19]
  ds_read_b64_tr_b16 v[72:73], v96 offset:61440
  ds_read_b64_tr_b16 a[212:213], v222 offset:32768
  v_and_b32 v135, 3, v0
  v_mfma_f32_16x16x32_bf16 v[20:23], a[116:119], v[80:83], v[20:23]
  ds_read_b64_tr_b16 v[74:75], v96 offset:63488
  ds_read_b64_tr_b16 a[210:211], v221 offset:33280
  v_add_u32 v71, s54, v71
  v_mfma_f32_16x16x32_bf16 v[24:27], a[180:183], v[80:83], v[24:27]
  ds_read_b64_tr_b16 v[76:77], v97 offset:61440
  ds_read_b64_tr_b16 a[208:209], v221 offset:32768
  v_mfma_f32_16x16x32_bf16 v[28:31], a[52:55], v[84:87], v[28:31]
  ds_read_b64_tr_b16 v[78:79], v97 offset:63488
  s_lshl_b32 s8, s3, 7
  s_add_u32 s8, s8, 156928
  v_lshl_add_u32 v225, v0, 2, s8
  v_mfma_f32_16x16x32_bf16 v[32:35], a[116:119], v[84:87], v[32:35]
  ds_read2_b32 v[104:105], v225 offset1:16
  v_xor_b32 v133, s52, v133
  v_lshl_add_u32 v134, v135, 3, v134
  v_mfma_f32_16x16x32_bf16 v[36:39], a[180:183], v[84:87], v[36:39]
  ds_read_b32 v106, v225 offset:128
  s_add_u32 s53, s100, 4194304
  s_waitcnt lgkmcnt(12)
  v_mfma_f32_16x16x32_bf16 v[16:19], a[56:59], v[88:91], v[16:19]
  ds_read_b64_tr_b16 v[80:81], v98 offset:0
  buffer_store_dwordx4 v[124:127], v140, s[4:7], s53 offen sc1
  v_mfma_f32_16x16x32_bf16 v[20:23], a[120:123], v[88:91], v[20:23]
  ds_read_b64_tr_b16 v[82:83], v98 offset:2048
  s_add_u32 m0, s42, 114688
  s_add_u32 s9, s17, 65536
  v_mfma_f32_16x16x32_bf16 v[24:27], a[184:187], v[88:91], v[24:27]
  ds_read_b64_tr_b16 v[84:85], v99 offset:0
  buffer_load_dwordx4 v219, s[24:27], s9 offen offset:0 lds
  v_mfma_f32_16x16x32_bf16 v[28:31], a[56:59], v[92:95], v[28:31]
  ds_read_b64_tr_b16 v[86:87], v99 offset:2048
  v_lshl_add_u32 v134, v133, 5, v134
  v_xor_b32 v133, 32, v134
  v_mfma_f32_16x16x32_bf16 v[32:35], a[120:123], v[92:95], v[32:35]
  ds_read_b64_tr_b16 v[8:9], v134
  s_add_u32 s53, s62, 4194304
  s_add_u32 s9, s17, 147456
  v_mfma_f32_16x16x32_bf16 v[36:39], a[184:187], v[92:95], v[36:39]
  buffer_store_dwordx4 v[124:127], v140, s[4:7], s53 offen sc1
  s_add_u32 s53, s101, 4194304
  s_waitcnt lgkmcnt(7)
  v_mfma_f32_16x16x32_bf16 v[24:27], a[188:191], v[72:75], v[24:27]
  ds_read_b64_tr_b16 v[88:89], v98 offset:4096
  ds_read_b64_tr_b16 v[10:11], v133
  s_waitcnt vmcnt(7)
  s_waitcnt lgkmcnt(0)
  v_mfma_f32_16x16x32_bf16 v[36:39], a[188:191], v[76:79], v[36:39]
  ds_read_b64_tr_b16 v[90:91], v98 offset:6144
  buffer_load_dwordx4 v220, s[24:27], s9 offen offset:1024 lds
  v_mfma_f32_16x16x32_bf16 v[16:19], a[60:63], v[72:75], v[16:19]
  ds_read_b64_tr_b16 v[92:93], v99 offset:4096
  ds_read_b64_tr_b16 a[238:239], v224 offset:16896
  v_dot2_f32_bf16 v68, v8, v8, 0
  v_mfma_f32_16x16x32_bf16 v[20:23], a[124:127], v[72:75], v[20:23]
  ds_read_b64_tr_b16 v[94:95], v99 offset:6144
  ds_read_b64_tr_b16 a[236:237], v224 offset:16384
  v_dot2_f32_bf16 v69, v10, v10, 0
  v_mfma_f32_16x16x32_bf16 v[28:31], a[60:63], v[76:79], v[28:31]
  buffer_store_dwordx2 v[124:125], v141, s[4:7], s53 offen sc1
  s_add_u32 s53, s31, 4194304
  v_mfma_f32_16x16x32_bf16 v[32:35], a[124:127], v[76:79], v[32:35]
  ds_read_b64_tr_b16 a[234:235], v223 offset:16896
  s_add_u32 s9, s17, 243712
  v_mfma_f32_16x16x32_bf16 v[40:43], a[0:3], v[80:83], 0
  ds_read_b64_tr_b16 v[72:73], v98 offset:8192
  buffer_load_dwordx4 v219, s[24:27], s9 offen offset:2048 lds
  v_mfma_f32_16x16x32_bf16 v[44:47], a[64:67], v[80:83], 0
  ds_read_b64_tr_b16 v[74:75], v98 offset:10240
  buffer_store_dwordx2 v[124:125], v141, s[4:7], s53 offen sc1
  v_mfma_f32_16x16x32_bf16 v[48:51], a[128:131], v[80:83], 0
  ds_read_b64_tr_b16 v[76:77], v99 offset:8192
  ds_read_b64_tr_b16 a[232:233], v223 offset:16384
  v_dot2_f32_bf16 v68, v9, v9, v68
  v_mfma_f32_16x16x32_bf16 v[52:55], a[0:3], v[84:87], 0
  ds_read_b64_tr_b16 v[78:79], v99 offset:10240
  ds_read_b64_tr_b16 a[230:231], v222 offset:16896
  v_dot2_f32_bf16 v69, v11, v11, v69
  v_mfma_f32_16x16x32_bf16 v[56:59], a[64:67], v[84:87], 0
  s_nop 1
  v_permlane16_swap_b32 v68, v69
  v_add_f32 v68, v68, v69
  v_mfma_f32_16x16x32_bf16 v[60:63], a[128:131], v[84:87], 0
  ds_write_b32 v101, v68
  s_add_u32 s9, s17, 325632
  s_waitcnt lgkmcnt(9)
  v_mfma_f32_16x16x32_bf16 v[40:43], a[4:7], v[88:91], v[40:43]
  ds_read_b64_tr_b16 v[80:81], v98 offset:12288
  buffer_load_dwordx4 v220, s[24:27], s9 offen offset:3072 lds
  v_mfma_f32_16x16x32_bf16 v[44:47], a[68:71], v[88:91], v[44:47]
  ds_read_b64_tr_b16 v[82:83], v98 offset:14336
  ds_read_b64_tr_b16 a[228:229], v222 offset:16384
  v_mfma_f32_16x16x32_bf16 v[48:51], a[132:135], v[88:91], v[48:51]
  ds_read_b64_tr_b16 v[84:85], v99 offset:12288
  ds_read_b64_tr_b16 a[226:227], v221 offset:16896
  s_add_u32 m0, s42, 98304
  v_mfma_f32_16x16x32_bf16 v[52:55], a[4:7], v[92:95], v[52:55]
  ds_read_b64_tr_b16 v[86:87], v99 offset:14336
  ds_read_b64_tr_b16 a[224:225], v221 offset:16384
  v_mul_f32 v65, s46, v24
  v_mfma_f32_16x16x32_bf16 v[56:59], a[68:71], v[92:95], v[56:59]
  s_add_u32 s9, s19, 32768
  v_mul_f32 v67, s46, v36
  v_cvt_pk_bf16_f32 v64, 0, -v65
  v_mfma_f32_16x16x32_bf16 v[60:63], a[132:135], v[92:95], v[60:63]
  buffer_load_dwordx4 v219, s[24:27], s9 offen offset:0 lds
  v_cvt_pk_bf16_f32 v66, 0, -v67
  s_waitcnt lgkmcnt(9)
  v_mfma_f32_16x16x32_bf16 v[40:43], a[8:11], v[72:75], v[40:43]
  ds_read_b64_tr_b16 v[88:89], v98 offset:16384
  ds_write2_b64 v100, v[66:67], v[64:65] offset0:0 offset1:16
  s_waitcnt vmcnt(9)
  v_mfma_f32_16x16x32_bf16 v[44:47], a[72:75], v[72:75], v[44:47]
  ds_read_b64_tr_b16 v[90:91], v98 offset:18432
  s_waitcnt lgkmcnt(1)
  s_barrier
  v_mfma_f32_16x16x32_bf16 v[48:51], a[136:139], v[72:75], v[48:51]
  ds_read_b64_tr_b16 v[92:93], v99 offset:16384
  ds_read_b32 v118, v119 offset:0
wpad_0_3:
  s_cbranch_execz wpad_0_7
  v_mfma_f32_16x16x32_bf16 v[52:55], a[8:11], v[76:79], v[52:55]
  ds_read_b64_tr_b16 v[94:95], v99 offset:18432
  buffer_load_dwordx4 v220, s[24:27], s9 offen offset:1024 lds
  v_mfma_f32_16x16x32_bf16 v[56:59], a[72:75], v[76:79], v[56:59]
  ds_read_b32 v116, v102 offset:0
  s_add_u32 s9, s19, 47104
  v_mfma_f32_16x16x32_bf16 v[60:63], a[136:139], v[76:79], v[60:63]
  ds_read_b32 v117, v103 offset:0
  v_mfma_f32_16x16x32_bf16 v[40:43], a[12:15], v[80:83], v[40:43]
  ds_read_b64_tr_b16 v[72:73], v98 offset:20480
  buffer_load_dwordx4 v219, s[24:27], s9 offen offset:2048 lds
  v_mfma_f32_16x16x32_bf16 v[44:47], a[76:79], v[80:83], v[44:47]
  ds_read_b64_tr_b16 v[74:75], v98 offset:22528
  ds_read_b128 v[64:67], v70
  s_waitcnt lgkmcnt(0)
  v_add_f32 v64, v64, v65
  v_mfma_f32_16x16x1_4b_f32 v[16:31], v104, v116, v[16:31]
  ds_read_b64_tr_b16 a[254:255], v224 offset:512
  v_add_f32 v66, v66, v67
  v_add_f32 v65, v64, v66
  ds_read_b64_tr_b16 a[252:253], v224 offset:0
  v_add_f32 v64, v64, v66
  v_mfma_f32_16x16x32_bf16 v[48:51], a[140:143], v[80:83], v[48:51]
  ds_read_b64_tr_b16 v[76:77], v99 offset:20480
  buffer_load_dwordx4 v220, s[24:27], s9 offen offset:3072 lds
  v_mfma_f32_16x16x32_bf16 v[52:55], a[12:15], v[84:87], v[52:55]
  ds_read_b64_tr_b16 v[78:79], v99 offset:22528
  v_mov_b32 v5, 0
  buffer_atomic_add v5, v3, s[4:7], s28 offen sc0 sc1
  v_mfma_f32_16x16x1_4b_f32 v[32:47], v105, v117, v[32:47]
  ds_read_b64_tr_b16 a[250:251], v223 offset:512
  s_lshl_b32 s55, s3, 12
  s_add_u32 s57, s63, s38
  v_permlane32_swap_b32 v64, v65
  v_add_f32 v68, v64, v65
  v_mfma_f32_16x16x32_bf16 v[56:59], a[76:79], v[84:87], v[56:59]
  ds_read_b64_tr_b16 a[248:249], v223 offset:0
  s_add_u32 s57, s57, 1048576
  s_add_u32 m0, s55, 65536
  v_mfma_f32_16x16x32_bf16 v[60:63], a[140:143], v[84:87], v[60:63]
  ds_read_b64_tr_b16 a[246:247], v222 offset:512
  v_mfma_f32_16x16x32_bf16 v[40:43], a[16:19], v[88:91], v[40:43]
  ds_read_b64_tr_b16 v[80:81], v98 offset:24576
  buffer_store_dword v68, v71, s[4:7], s30 offen offset:0 sc1
  v_mfma_f32_16x16x32_bf16 v[44:47], a[80:83], v[88:91], v[44:47]
  ds_read_b64_tr_b16 v[82:83], v98 offset:26624
  ds_read_b64_tr_b16 a[244:245], v222 offset:0
  v_mul_f32 v16, v16, v20
  v_mfma_f32_16x16x32_bf16 v[48:51], a[144:147], v[88:91], v[48:51]
  ds_read_b64_tr_b16 v[84:85], v99 offset:24576
  v_mul_f32 v17, v17, v21
  v_mul_f32 v18, v18, v22
  v_mfma_f32_16x16x32_bf16 v[52:55], a[16:19], v[92:95], v[52:55]
  ds_read_b64_tr_b16 v[86:87], v99 offset:26624
  ds_read_b64_tr_b16 a[242:243], v221 offset:512
  v_mul_f32 v19, v19, v23
  v_mfma_f32_16x16x32_bf16 v[56:59], a[80:83], v[92:95], v[56:59]
  ds_read_b64_tr_b16 a[240:241], v221 offset:0
  v_mul_f32 v28, v28, v32
  v_mul_f32 v29, v29, v33
  v_mfma_f32_16x16x32_bf16 v[60:63], a[144:147], v[92:95], v[60:63]
  v_mul_f32 v30, v30, v34
  v_mul_f32 v31, v31, v35
  s_waitcnt lgkmcnt(10)
  v_mfma_f32_16x16x32_bf16 v[40:43], a[20:23], v[72:75], v[40:43]
  ds_read_b64_tr_b16 v[88:89], v98 offset:28672
  v_cvt_pk_bf16_f32 v124, v16, v17
  v_cvt_pk_bf16_f32 v125, v18, v19
  v_mfma_f32_16x16x32_bf16 v[44:47], a[84:87], v[72:75], v[44:47]
  ds_read_b64_tr_b16 v[90:91], v98 offset:30720
  v_cvt_pk_bf16_f32 v126, v28, v29
  v_cvt_pk_bf16_f32 v127, v30, v31
  v_mfma_f32_16x16x32_bf16 v[48:51], a[148:151], v[72:75], v[48:51]
  ds_read_b64_tr_b16 v[92:93], v99 offset:28672
  v_permlane16_swap_b32 v124, v126
  v_mfma_f32_16x16x32_bf16 v[52:55], a[20:23], v[76:79], v[52:55]
  ds_read_b64_tr_b16 v[94:95], v99 offset:30720
  v_permlane16_swap_b32 v125, v127
  v_mfma_f32_16x16x32_bf16 v[56:59], a[84:87], v[76:79], v[56:59]
  buffer_store_dwordx4 v[124:127], v140, s[4:7], s100 offen sc1
  s_waitcnt vmcnt(7)
  v_mfma_f32_16x16x32_bf16 v[60:63], a[148:151], v[76:79], v[60:63]
  ds_read_b64_tr_b16 v[158:159], v224 offset:49664
  s_waitcnt lgkmcnt(7)
  v_mfma_f32_16x16x32_bf16 v[40:43], a[24:27], v[80:83], v[40:43]
  ds_read_b64_tr_b16 v[72:73], v98 offset:32768
  ds_read_b64_tr_b16 v[156:157], v224 offset:49152
  v_mfma_f32_16x16x32_bf16 v[44:47], a[88:91], v[80:83], v[44:47]
  ds_read_b64_tr_b16 v[74:75], v98 offset:34816
  v_xor_b32 v96, 0x10000, v96
  v_mfma_f32_16x16x32_bf16 v[48:51], a[152:155], v[80:83], v[48:51]
  ds_read_b64_tr_b16 v[76:77], v99 offset:32768
  v_xor_b32 v97, 0x10000, v97
  v_mfma_f32_16x16x32_bf16 v[52:55], a[24:27], v[84:87], v[52:55]
  ds_read_b64_tr_b16 v[78:79], v99 offset:34816
  ds_read_b64_tr_b16 v[154:155], v223 offset:49664
  v_mfma_f32_16x16x32_bf16 v[56:59], a[88:91], v[84:87], v[56:59]
  v_permlane16_swap_b32 v24, v36
  v_mfma_f32_16x16x32_bf16 v[60:63], a[152:155], v[84:87], v[60:63]
  ds_read_b64_tr_b16 v[152:153], v223 offset:49152
  s_waitcnt lgkmcnt(8)
  v_mfma_f32_16x16x32_bf16 v[40:43], a[28:31], v[88:91], v[40:43]
  ds_read_b64_tr_b16 v[80:81], v98 offset:36864
  v_mfma_f32_16x16x32_bf16 v[44:47], a[92:95], v[88:91], v[44:47]
  ds_read_b64_tr_b16 v[82:83], v98 offset:38912
  v_mfma_f32_16x16x32_bf16 v[48:51], a[156:159], v[88:91], v[48:51]
  ds_read_b64_tr_b16 v[84:85], v99 offset:36864
  v_permlane16_swap_b32 v25, v37
  v_mfma_f32_16x16x32_bf16 v[52:55], a[28:31], v[92:95], v[52:55]
  ds_read_b64_tr_b16 v[86:87], v99 offset:38912
  ds_read_b64_tr_b16 v[150:151], v222 offset:49664
  v_mfma_f32_16x16x32_bf16 v[56:59], a[92:95], v[92:95], v[56:59]
  ds_read_b64_tr_b16 v[148:149], v222 offset:49152
  v_mfma_f32_16x16x32_bf16 v[60:63], a[156:159], v[92:95], v[60:63]
  ds_read_b64_tr_b16 v[146:147], v221 offset:49664
  s_waitcnt lgkmcnt(9)
  v_mfma_f32_16x16x32_bf16 v[40:43], a[32:35], v[72:75], v[40:43]
  ds_read_b64_tr_b16 v[88:89], v98 offset:40960
  v_permlane16_swap_b32 v26, v38
  v_mfma_f32_16x16x32_bf16 v[44:47], a[96:99], v[72:75], v[44:47]
  ds_read_b64_tr_b16 v[90:91], v98 offset:43008
  s_waitcnt vmcnt(2)
  v_cmp_ne_u32 vcc, 0, v5
  v_mfma_f32_16x16x32_bf16 v[48:51], a[160:163], v[72:75], v[48:51]
  ds_read_b64_tr_b16 v[92:93], v99 offset:40960
  s_cbranch_vccnz poll_4_s
poll_4_ok:
  s_barrier
  v_mfma_f32_16x16x32_bf16 v[52:55], a[32:35], v[76:79], v[52:55]
  ds_read_b64_tr_b16 v[94:95], v99 offset:43008
  v_mfma_f32_16x16x32_bf16 v[56:59], a[96:99], v[76:79], v[56:59]
  buffer_load_dwordx4 v6, s[4:7], s57 offen offset:0 sc1 lds
  v_mfma_f32_16x16x32_bf16 v[60:63], a[160:163], v[76:79], v[60:63]
  v_permlane16_swap_b32 v27, v39
  s_waitcnt lgkmcnt(7)
  v_mfma_f32_16x16x32_bf16 v[40:43], a[36:39], v[80:83], v[40:43]
  ds_read_b64_tr_b16 v[72:73], v98 offset:45056
  buffer_load_dwordx4 v6, s[4:7], s57 offen offset:1024 sc1 lds
  v_mfma_f32_16x16x32_bf16 v[44:47], a[100:103], v[80:83], v[44:47]
  ds_read_b64_tr_b16 v[74:75], v98 offset:47104
  buffer_load_dwordx4 v6, s[4:7], s57 offen offset:2048 sc1 lds
  v_mfma_f32_16x16x1_4b_f32 v[48:63], v106, v118, v[48:63]
  ds_read_b64_tr_b16 v[144:145], v221 offset:49152
  ds_read_b64_tr_b16 v[174:175], v224 offset:33280
  v_mul_f32 v24, v24, v36
  v_mfma_f32_16x16x32_bf16 v[48:51], a[164:167], v[80:83], v[48:51]
  ds_read_b64_tr_b16 v[76:77], v99 offset:45056
  buffer_load_dwordx4 v6, s[4:7], s57 offen offset:3072 sc1 lds
  v_mfma_f32_16x16x32_bf16 v[52:55], a[36:39], v[84:87], v[52:55]
  ds_read_b64_tr_b16 v[78:79], v99 offset:47104
  s_add_u32 m0, m0, 16384
  s_xor_b32 s57, s57, 32768
  v_mfma_f32_16x16x32_bf16 v[56:59], a[100:103], v[84:87], v[56:59]
  ds_read_b64_tr_b16 v[172:173], v224 offset:32768
  v_mul_f32 v25, v25, v37
  v_mfma_f32_16x16x32_bf16 v[60:63], a[164:167], v[84:87], v[60:63]
  buffer_load_dwordx4 v6, s[4:7], s57 offen offset:0 sc1 lds
  v_mul_f32 v26, v26, v38
  s_waitcnt lgkmcnt(7)
  v_mfma_f32_16x16x32_bf16 v[40:43], a[40:43], v[88:91], v[40:43]
  ds_read_b64_tr_b16 v[80:81], v98 offset:49152
  buffer_load_dwordx4 v6, s[4:7], s57 offen offset:1024 sc1 lds
  v_mfma_f32_16x16x32_bf16 v[44:47], a[104:107], v[88:91], v[44:47]
  ds_read_b64_tr_b16 v[82:83], v98 offset:51200
  buffer_load_dwordx4 v6, s[4:7], s57 offen offset:2048 sc1 lds
  v_mfma_f32_16x16x32_bf16 v[48:51], a[168:171], v[88:91], v[48:51]
  ds_read_b64_tr_b16 v[84:85], v99 offset:49152
  buffer_load_dwordx4 v6, s[4:7], s57 offen offset:3072 sc1 lds
  v_mfma_f32_16x16x32_bf16 v[52:55], a[40:43], v[92:95], v[52:55]
  ds_read_b64_tr_b16 v[86:87], v99 offset:51200
  ds_read_b64_tr_b16 v[170:171], v223 offset:33280
  v_mul_f32 v27, v27, v39
  v_mfma_f32_16x16x32_bf16 v[56:59], a[104:107], v[92:95], v[56:59]
  ds_read_b64_tr_b16 v[168:169], v223 offset:32768
  s_add_u32 m0, m0, 16384
  s_xor_b32 s57, s57, 98304
  v_mfma_f32_16x16x32_bf16 v[60:63], a[168:171], v[92:95], v[60:63]
  ds_read_b64_tr_b16 v[166:167], v222 offset:33280
  v_cvt_pk_bf16_f32 v120, v24, v25
  s_waitcnt lgkmcnt(8)
  v_mfma_f32_16x16x32_bf16 v[40:43], a[44:47], v[72:75], v[40:43]
  ds_read_b64_tr_b16 v[88:89], v98 offset:53248
  v_cvt_pk_bf16_f32 v121, v26, v27
  v_mfma_f32_16x16x32_bf16 v[44:47], a[108:111], v[72:75], v[44:47]
  ds_read_b64_tr_b16 v[90:91], v98 offset:55296
  buffer_store_dwordx2 v[120:121], v141, s[4:7], s101 offen sc1
  v_mfma_f32_16x16x32_bf16 v[48:51], a[172:175], v[72:75], v[48:51]
  ds_read_b64_tr_b16 v[92:93], v99 offset:53248
  v_mfma_f32_16x16x32_bf16 v[52:55], a[44:47], v[76:79], v[52:55]
  ds_read_b64_tr_b16 v[94:95], v99 offset:55296
  v_mfma_f32_16x16x32_bf16 v[56:59], a[108:111], v[76:79], v[56:59]
  ds_read_b64_tr_b16 v[164:165], v222 offset:32768
  v_mfma_f32_16x16x32_bf16 v[60:63], a[172:175], v[76:79], v[60:63]
  ds_read_b64_tr_b16 v[162:163], v221 offset:33280
  s_waitcnt lgkmcnt(9)
  v_mfma_f32_16x16x32_bf16 v[40:43], a[48:51], v[80:83], v[40:43]
  ds_read_b64_tr_b16 v[72:73], v98 offset:57344
  v_mfma_f32_16x16x32_bf16 v[44:47], a[112:115], v[80:83], v[44:47]
  ds_read_b64_tr_b16 v[74:75], v98 offset:59392
  v_mfma_f32_16x16x32_bf16 v[48:51], a[176:179], v[80:83], v[48:51]
  ds_read_b64_tr_b16 v[76:77], v99 offset:57344
  v_mfma_f32_16x16x32_bf16 v[52:55], a[48:51], v[84:87], v[52:55]
  ds_read_b64_tr_b16 v[78:79], v99 offset:59392
  v_mfma_f32_16x16x32_bf16 v[56:59], a[112:115], v[84:87], v[56:59]
  ds_read_b64_tr_b16 v[160:161], v221 offset:32768
  v_mfma_f32_16x16x32_bf16 v[60:63], a[176:179], v[84:87], v[60:63]
  s_waitcnt lgkmcnt(0)
  v_mfma_f32_16x16x32_bf16 v[40:43], a[52:55], v[88:91], v[40:43]
  ds_read_b64_tr_b16 v[80:81], v98 offset:61440
  buffer_load_dwordx4 v6, s[4:7], s57 offen offset:0 sc1 lds
  v_mfma_f32_16x16x32_bf16 v[44:47], a[116:119], v[88:91], v[44:47]
  ds_read_b64_tr_b16 v[82:83], v98 offset:63488
  v_mfma_f32_16x16x32_bf16 v[48:51], a[180:183], v[88:91], v[48:51]
  ds_read_b64_tr_b16 v[84:85], v99 offset:61440
  v_mfma_f32_16x16x32_bf16 v[52:55], a[52:55], v[92:95], v[52:55]
  ds_read_b64_tr_b16 v[86:87], v99 offset:63488
  buffer_load_dwordx4 v6, s[4:7], s57 offen offset:1024 sc1 lds
  v_mfma_f32_16x16x32_bf16 v[56:59], a[116:119], v[92:95], v[56:59]
  s_waitcnt vmcnt(7)
  s_barrier
  v_mfma_f32_16x16x32_bf16 v[60:63], a[180:183], v[92:95], v[60:63]
  buffer_load_dwordx4 v6, s[4:7], s57 offen offset:2048 sc1 lds
  v_mfma_f32_16x16x32_bf16 v[40:43], a[56:59], v[72:75], v[40:43]
  ds_read_b64_tr_b16 v[88:89], v96 offset:0
  v_mfma_f32_16x16x32_bf16 v[44:47], a[120:123], v[72:75], v[44:47]
  ds_read_b64_tr_b16 v[90:91], v96 offset:2048
  v_mfma_f32_16x16x32_bf16 v[48:51], a[184:187], v[72:75], v[48:51]
  ds_read_b64_tr_b16 v[92:93], v97 offset:0
  v_mfma_f32_16x16x32_bf16 v[52:55], a[56:59], v[76:79], v[52:55]
  ds_read_b64_tr_b16 v[94:95], v97 offset:2048
  buffer_load_dwordx4 v6, s[4:7], s57 offen offset:3072 sc1 lds
  v_mfma_f32_16x16x32_bf16 v[56:59], a[120:123], v[76:79], v[56:59]
  s_add_u32 m0, m0, 16384
  s_xor_b32 s57, s57, 32768
  v_mfma_f32_16x16x32_bf16 v[60:63], a[184:187], v[76:79], v[60:63]
  buffer_load_dwordx4 v6, s[4:7], s57 offen offset:0 sc1 lds
  s_waitcnt lgkmcnt(4)
  v_mfma_f32_16x16x32_bf16 v[40:43], a[60:63], v[80:83], v[40:43]
  ds_read_b64_tr_b16 v[72:73], v96 offset:4096
  v_mfma_f32_16x16x32_bf16 v[44:47], a[124:127], v[80:83], v[44:47]
  ds_read_b64_tr_b16 v[74:75], v96 offset:6144
  v_mfma_f32_16x16x32_bf16 v[48:51], a[188:191], v[80:83], v[48:51]
  ds_read_b64_tr_b16 v[76:77], v97 offset:4096
  v_mfma_f32_16x16x32_bf16 v[52:55], a[60:63], v[84:87], v[52:55]
  ds_read_b64_tr_b16 v[78:79], v97 offset:6144
  v_mfma_f32_16x16x32_bf16 v[56:59], a[124:127], v[84:87], v[56:59]
  buffer_load_dwordx4 v6, s[4:7], s57 offen offset:1024 sc1 lds
  v_mfma_f32_16x16x32_bf16 v[60:63], a[188:191], v[84:87], v[60:63]
  s_waitcnt lgkmcnt(4)
  v_mfma_f32_16x16x32_bf16 v[16:19], a[0:3], v[88:91], 0
  ds_read_b64_tr_b16 v[80:81], v96 offset:8192
  buffer_load_dwordx4 v6, s[4:7], s57 offen offset:2048 sc1 lds
  v_mfma_f32_16x16x32_bf16 v[20:23], a[64:67], v[88:91], 0
  ds_read_b64_tr_b16 v[82:83], v96 offset:10240
  v_mul_f32 v40, v40, v44
  v_mul_f32 v41, v41, v45
  v_mfma_f32_16x16x32_bf16 v[24:27], a[128:131], v[88:91], 0
  ds_read_b64_tr_b16 v[84:85], v97 offset:8192
  v_mul_f32 v42, v42, v46
  v_mul_f32 v43, v43, v47
  v_mfma_f32_16x16x32_bf16 v[28:31], a[0:3], v[92:95], 0
  ds_read_b64_tr_b16 v[86:87], v97 offset:10240
  v_mul_f32 v52, v52, v56
  v_mul_f32 v53, v53, v57
  v_mfma_f32_16x16x32_bf16 v[32:35], a[64:67], v[92:95], 0
  buffer_load_dwordx4 v6, s[4:7], s57 offen offset:3072 sc1 lds
  v_mul_f32 v54, v54, v58
  v_mfma_f32_16x16x32_bf16 v[36:39], a[128:131], v[92:95], 0
  v_mul_f32 v55, v55, v59
  v_cvt_pk_bf16_f32 v124, v40, v41
  s_waitcnt lgkmcnt(4)
  v_mfma_f32_16x16x32_bf16 v[16:19], a[4:7], v[72:75], v[16:19]
  ds_read_b64_tr_b16 v[88:89], v96 offset:12288
  v_cvt_pk_bf16_f32 v125, v42, v43
  v_cvt_pk_bf16_f32 v126, v52, v53
  v_mfma_f32_16x16x32_bf16 v[20:23], a[68:71], v[72:75], v[20:23]
  ds_read_b64_tr_b16 v[90:91], v96 offset:14336
  v_cvt_pk_bf16_f32 v127, v54, v55
  v_mfma_f32_16x16x32_bf16 v[24:27], a[132:135], v[72:75], v[24:27]
  ds_read_b64_tr_b16 v[92:93], v97 offset:12288
  v_permlane16_swap_b32 v124, v126
  v_mfma_f32_16x16x32_bf16 v[28:31], a[4:7], v[76:79], v[28:31]
  ds_read_b64_tr_b16 v[94:95], v97 offset:14336
  v_permlane16_swap_b32 v125, v127
  v_mfma_f32_16x16x32_bf16 v[32:35], a[68:71], v[76:79], v[32:35]
  s_waitcnt vmcnt(9)
  s_barrier
  s_add_u32 m0, s42, 0
  v_mfma_f32_16x16x32_bf16 v[36:39], a[132:135], v[76:79], v[36:39]
  buffer_store_dwordx4 v[124:127], v140, s[4:7], s62 offen sc1
  s_add_u32 s9, s19, 122880
  s_waitcnt lgkmcnt(4)
  v_mfma_f32_16x16x32_bf16 v[16:19], a[8:11], v[80:83], v[16:19]
  ds_read_b64_tr_b16 v[72:73], v96 offset:16384
  v_permlane16_swap_b32 v48, v60
  v_mfma_f32_16x16x32_bf16 v[20:23], a[72:75], v[80:83], v[20:23]
  ds_read_b64_tr_b16 v[74:75], v96 offset:18432
  v_permlane16_swap_b32 v49, v61
  v_mfma_f32_16x16x32_bf16 v[24:27], a[136:139], v[80:83], v[24:27]
  ds_read_b64_tr_b16 v[76:77], v97 offset:16384
  v_xor_b32 v98, 0x10000, v98
  v_mfma_f32_16x16x32_bf16 v[28:31], a[8:11], v[84:87], v[28:31]
  ds_read_b64_tr_b16 v[78:79], v97 offset:18432
  buffer_load_dwordx4 v219, s[24:27], s9 offen offset:0 lds
  v_mfma_f32_16x16x32_bf16 v[32:35], a[72:75], v[84:87], v[32:35]
  buffer_load_dwordx4 v220, s[24:27], s9 offen offset:1024 lds
  s_add_u32 s9, s19, 137216
  v_mfma_f32_16x16x32_bf16 v[36:39], a[136:139], v[84:87], v[36:39]
  v_permlane16_swap_b32 v50, v62
  s_waitcnt lgkmcnt(4)
  v_mfma_f32_16x16x32_bf16 v[16:19], a[12:15], v[88:91], v[16:19]
  ds_read_b64_tr_b16 v[80:81], v96 offset:20480
  v_bfe_u32 v133, v0, 2, 4
  v_mfma_f32_16x16x32_bf16 v[20:23], a[76:79], v[88:91], v[20:23]
  ds_read_b64_tr_b16 v[82:83], v96 offset:22528
  s_lshl_b32 s51, s35, 13
  v_mfma_f32_16x16x32_bf16 v[24:27], a[140:143], v[88:91], v[24:27]
  ds_read_b64_tr_b16 v[84:85], v97 offset:20480
  s_lshl_b32 s52, s3, 11
  v_mfma_f32_16x16x32_bf16 v[28:31], a[12:15], v[92:95], v[28:31]
  ds_read_b64_tr_b16 v[86:87], v97 offset:22528
  s_add_u32 s51, s51, s52
  v_mfma_f32_16x16x32_bf16 v[32:35], a[76:79], v[92:95], v[32:35]
  buffer_load_dwordx4 v219, s[24:27], s9 offen offset:2048 lds
  v_mfma_f32_16x16x32_bf16 v[36:39], a[140:143], v[92:95], v[36:39]
  v_permlane16_swap_b32 v51, v63
  s_waitcnt lgkmcnt(4)
  v_mfma_f32_16x16x32_bf16 v[16:19], a[16:19], v[72:75], v[16:19]
  ds_read_b64_tr_b16 v[88:89], v96 offset:24576
  v_mul_f32 v48, v48, v60
  v_mfma_f32_16x16x32_bf16 v[20:23], a[80:83], v[72:75], v[20:23]
  ds_read_b64_tr_b16 v[90:91], v96 offset:26624
  v_mul_f32 v49, v49, v61
  v_mfma_f32_16x16x32_bf16 v[24:27], a[144:147], v[72:75], v[24:27]
  ds_read_b64_tr_b16 v[92:93], v97 offset:24576
  v_mul_f32 v50, v50, v62
  v_mfma_f32_16x16x32_bf16 v[28:31], a[16:19], v[76:79], v[28:31]
  ds_read_b64_tr_b16 v[94:95], v97 offset:26624
  v_mul_f32 v51, v51, v63
  v_mfma_f32_16x16x32_bf16 v[32:35], a[80:83], v[76:79], v[32:35]
  buffer_load_dwordx4 v220, s[24:27], s9 offen offset:3072 lds
  s_add_u32 m0, s42, 16384
  v_mfma_f32_16x16x32_bf16 v[36:39], a[144:147], v[76:79], v[36:39]
  v_cvt_pk_bf16_f32 v120, v48, v49
  s_waitcnt lgkmcnt(4)
  v_mfma_f32_16x16x32_bf16 v[16:19], a[20:23], v[80:83], v[16:19]
  ds_read_b64_tr_b16 v[72:73], v96 offset:28672
  s_add_u32 s9, s19, 212992
  v_mfma_f32_16x16x32_bf16 v[20:23], a[84:87], v[80:83], v[20:23]
  ds_read_b64_tr_b16 v[74:75], v96 offset:30720
  v_cvt_pk_bf16_f32 v121, v50, v51
  v_mfma_f32_16x16x32_bf16 v[24:27], a[148:151], v[80:83], v[24:27]
  ds_read_b64_tr_b16 v[76:77], v97 offset:28672
  s_add_u32 s51, s51, 65536
  v_mfma_f32_16x16x32_bf16 v[28:31], a[20:23], v[84:87], v[28:31]
  ds_read_b64_tr_b16 v[78:79], v97 offset:30720
  s_lshl_b32 s52, s34, 1
  v_mfma_f32_16x16x32_bf16 v[32:35], a[84:87], v[84:87], v[32:35]
  s_waitcnt vmcnt(9)
  s_barrier
  v_mfma_f32_16x16x32_bf16 v[36:39], a[148:151], v[84:87], v[36:39]
  buffer_load_dwordx4 v219, s[24:27], s9 offen offset:0 lds
  s_waitcnt lgkmcnt(4)
  v_mfma_f32_16x16x32_bf16 v[16:19], a[24:27], v[88:91], v[16:19]
  ds_read_b64_tr_b16 v[80:81], v96 offset:32768
  buffer_store_dwordx2 v[120:121], v141, s[4:7], s31 offen sc1
  v_mfma_f32_16x16x32_bf16 v[20:23], a[88:91], v[88:91], v[20:23]
  ds_read_b64_tr_b16 v[82:83], v96 offset:34816
  v_add_u32 v140, 4194304, v140
  v_add_u32 v141, 4194304, v141
  v_mfma_f32_16x16x32_bf16 v[24:27], a[152:155], v[88:91], v[24:27]
  ds_read_b64_tr_b16 v[84:85], v97 offset:32768
  v_lshl_add_u32 v134, v133, 7, s51
  v_mfma_f32_16x16x32_bf16 v[28:31], a[24:27], v[92:95], v[28:31]
  ds_read_b64_tr_b16 v[86:87], v97 offset:34816
  buffer_load_dwordx4 v220, s[24:27], s9 offen offset:1024 lds
  v_mfma_f32_16x16x32_bf16 v[32:35], a[88:91], v[92:95], v[32:35]
  s_add_u32 s9, s19, 227328
  v_bfe_u32 v133, v133, 1, 2
  v_mfma_f32_16x16x32_bf16 v[36:39], a[152:155], v[92:95], v[36:39]
  buffer_load_dwordx4 v219, s[24:27], s9 offen offset:2048 lds
  s_waitcnt lgkmcnt(4)
  v_mfma_f32_16x16x32_bf16 v[16:19], a[28:31], v[72:75], v[16:19]
  ds_read_b64_tr_b16 v[88:89], v96 offset:36864
  v_and_b32 v135, 3, v0
  v_mfma_f32_16x16x32_bf16 v[20:23], a[92:95], v[72:75], v[20:23]
  ds_read_b64_tr_b16 v[90:91], v96 offset:38912
  v_xor_b32 v133, s52, v133
  v_mfma_f32_16x16x32_bf16 v[24:27], a[156:159], v[72:75], v[24:27]
  ds_read_b64_tr_b16 v[92:93], v97 offset:36864
  v_lshl_add_u32 v134, v135, 3, v134
  v_mfma_f32_16x16x32_bf16 v[28:31], a[28:31], v[76:79], v[28:31]
  ds_read_b64_tr_b16 v[94:95], v97 offset:38912
  v_lshl_add_u32 v134, v133, 5, v134
  v_mfma_f32_16x16x32_bf16 v[32:35], a[92:95], v[76:79], v[32:35]
  buffer_load_dwordx4 v220, s[24:27], s9 offen offset:3072 lds
  v_mfma_f32_16x16x32_bf16 v[36:39], a[156:159], v[76:79], v[36:39]
  v_xor_b32 v133, 32, v134
  s_waitcnt lgkmcnt(4)
  v_mfma_f32_16x16x32_bf16 v[16:19], a[32:35], v[80:83], v[16:19]
  ds_read_b64_tr_b16 v[72:73], v96 offset:40960
  s_add_u32 m0, s42, 32768
  v_mfma_f32_16x16x32_bf16 v[20:23], a[96:99], v[80:83], v[20:23]
  ds_read_b64_tr_b16 v[74:75], v96 offset:43008
  s_add_u32 s9, s18, 81920
  v_mfma_f32_16x16x32_bf16 v[24:27], a[160:163], v[80:83], v[24:27]
  ds_read_b64_tr_b16 v[76:77], v97 offset:40960
  v_xor_b32 v99, 0x10000, v99
  v_mfma_f32_16x16x32_bf16 v[28:31], a[32:35], v[84:87], v[28:31]
  ds_read_b64_tr_b16 v[78:79], v97 offset:43008
  v_mfma_f32_16x16x32_bf16 v[32:35], a[96:99], v[84:87], v[32:35]
  buffer_load_dwordx4 v219, s[24:27], s9 offen offset:0 lds
  s_add_u32 s9, s18, 163840
  v_mfma_f32_16x16x32_bf16 v[36:39], a[160:163], v[84:87], v[36:39]
  s_lshl_b32 s28, s32, 10
  s_waitcnt lgkmcnt(4)
  v_mfma_f32_16x16x32_bf16 v[16:19], a[36:39], v[88:91], v[16:19]
  ds_read_b64_tr_b16 v[80:81], v96 offset:45056
  v_lshrrev_b32 v6, 2, v0
  v_mfma_f32_16x16x32_bf16 v[20:23], a[100:103], v[88:91], v[20:23]
  ds_read_b64_tr_b16 v[82:83], v96 offset:47104
  s_add_u32 s28, s28, 36061184
  v_mfma_f32_16x16x32_bf16 v[24:27], a[164:167], v[88:91], v[24:27]
  ds_read_b64_tr_b16 v[84:85], v97 offset:45056
  v_lshlrev_b32 v123, 8, v0
  v_mfma_f32_16x16x32_bf16 v[28:31], a[36:39], v[92:95], v[28:31]
  ds_read_b64_tr_b16 v[86:87], v97 offset:47104
  v_min_u32 v6, 1, v6
  v_mfma_f32_16x16x32_bf16 v[32:35], a[100:103], v[92:95], v[32:35]
  s_waitcnt vmcnt(11)
  s_barrier
  v_mfma_f32_16x16x32_bf16 v[36:39], a[164:167], v[92:95], v[36:39]
  buffer_load_dwordx4 v220, s[24:27], s9 offen offset:1024 lds
  s_add_u32 s9, s18, 260096
  s_waitcnt lgkmcnt(4)
  v_mfma_f32_16x16x32_bf16 v[16:19], a[40:43], v[72:75], v[16:19]
  ds_read_b64_tr_b16 v[88:89], v96 offset:49152
  s_and_b32 s53, s35, 3
  v_mfma_f32_16x16x32_bf16 v[20:23], a[104:107], v[72:75], v[20:23]
  ds_read_b64_tr_b16 v[90:91], v96 offset:51200
  v_lshl_add_u32 v123, v6, 31, v123
  v_mfma_f32_16x16x32_bf16 v[24:27], a[168:171], v[72:75], v[24:27]
  ds_read_b64_tr_b16 v[92:93], v97 offset:49152
  s_lshl_b32 s53, s53, 8
  v_mfma_f32_16x16x32_bf16 v[28:31], a[40:43], v[76:79], v[28:31]
  ds_read_b64_tr_b16 v[94:95], v97 offset:51200
  v_and_b32 v6, 63, v0
  v_mfma_f32_16x16x32_bf16 v[32:35], a[104:107], v[76:79], v[32:35]
  buffer_load_dwordx4 v219, s[24:27], s9 offen offset:2048 lds
  s_add_u32 s9, s18, 342016
  v_mfma_f32_16x16x32_bf16 v[36:39], a[168:171], v[76:79], v[36:39]
  ds_read_b64_tr_b16 v[12:13], v134
  s_waitcnt lgkmcnt(5)
  v_mfma_f32_16x16x32_bf16 v[16:19], a[44:47], v[80:83], v[16:19]
  ds_read_b64_tr_b16 v[72:73], v96 offset:53248
  v_lshl_add_u32 v6, v6, 26, s53
  v_mfma_f32_16x16x32_bf16 v[20:23], a[108:111], v[80:83], v[20:23]
  ds_read_b64_tr_b16 v[74:75], v96 offset:55296
  v_mov_b32 v122, 0x10000000
  v_mfma_f32_16x16x32_bf16 v[24:27], a[172:175], v[80:83], v[24:27]
  ds_read_b64_tr_b16 v[76:77], v97 offset:53248
  v_mfma_f32_16x16x32_bf16 v[28:31], a[44:47], v[84:87], v[28:31]
  ds_read_b64_tr_b16 v[78:79], v97 offset:55296
  v_mfma_f32_16x16x32_bf16 v[32:35], a[108:111], v[84:87], v[32:35]
  buffer_load_dwordx4 v220, s[24:27], s9 offen offset:3072 lds
  s_add_u32 m0, s42, 49152
  v_mfma_f32_16x16x32_bf16 v[36:39], a[172:175], v[84:87], v[36:39]
  ds_read_b64_tr_b16 v[14:15], v133
  s_add_u32 s9, s20, 73728
  s_waitcnt lgkmcnt(6)
  v_mfma_f32_16x16x32_bf16 v[16:19], a[48:51], v[88:91], v[16:19]
  ds_read_b64_tr_b16 v[80:81], v96 offset:57344
  s_waitcnt lgkmcnt(1)
  s_waitcnt vmcnt(7)
  s_barrier
  v_mfma_f32_16x16x32_bf16 v[20:23], a[112:115], v[88:91], v[20:23]
  ds_read_b64_tr_b16 v[82:83], v96 offset:59392
  v_dot2_f32_bf16 v68, v12, v12, 0
  v_mfma_f32_16x16x32_bf16 v[24:27], a[176:179], v[88:91], v[24:27]
  ds_read_b64_tr_b16 v[84:85], v97 offset:57344
  v_dot2_f32_bf16 v69, v14, v14, 0
  v_mfma_f32_16x16x32_bf16 v[28:31], a[48:51], v[92:95], v[28:31]
  ds_read_b64_tr_b16 v[86:87], v97 offset:59392
  v_dot2_f32_bf16 v68, v13, v13, v68
  v_mfma_f32_16x16x32_bf16 v[32:35], a[112:115], v[92:95], v[32:35]
  buffer_load_dwordx4 v219, s[24:27], s9 offen offset:0 lds
  s_add_u32 s9, s20, 155648
  v_mfma_f32_16x16x32_bf16 v[36:39], a[176:179], v[92:95], v[36:39]
  v_dot2_f32_bf16 v69, v15, v15, v69
  v_mfma_f32_16x16x32_bf16 v[16:19], a[52:55], v[72:75], v[16:19]
  ds_read_b64_tr_b16 v[88:89], v96 offset:61440
  buffer_atomic_sub v4, v2, s[4:7], s41 offen sc1
  v_mfma_f32_16x16x32_bf16 v[20:23], a[116:119], v[72:75], v[20:23]
  ds_read_b64_tr_b16 v[90:91], v96 offset:63488
  v_mfma_f32_16x16x32_bf16 v[24:27], a[180:183], v[72:75], v[24:27]
  ds_read_b64_tr_b16 v[92:93], v97 offset:61440
  v_mfma_f32_16x16x32_bf16 v[28:31], a[52:55], v[76:79], v[28:31]
  ds_read_b64_tr_b16 v[94:95], v97 offset:63488
  v_mfma_f32_16x16x32_bf16 v[32:35], a[116:119], v[76:79], v[32:35]
  buffer_load_dwordx4 v220, s[24:27], s9 offen offset:1024 lds
  s_add_u32 s9, s20, 251904
  v_mfma_f32_16x16x32_bf16 v[36:39], a[180:183], v[76:79], v[36:39]
  v_permlane16_swap_b32 v68, v69
  s_waitcnt lgkmcnt(4)
  v_mfma_f32_16x16x32_bf16 v[16:19], a[56:59], v[80:83], v[16:19]
  ds_read_b64_tr_b16 v[72:73], v98 offset:0
  v_add_f32 v68, v68, v69
  v_mfma_f32_16x16x32_bf16 v[20:23], a[120:123], v[80:83], v[20:23]
  ds_read_b64_tr_b16 v[74:75], v98 offset:2048
  v_mfma_f32_16x16x32_bf16 v[24:27], a[184:187], v[80:83], v[24:27]
  ds_read_b64_tr_b16 v[76:77], v99 offset:0
  v_mfma_f32_16x16x32_bf16 v[28:31], a[56:59], v[84:87], v[28:31]
  ds_read_b64_tr_b16 v[78:79], v99 offset:2048
  ds_read_b64_tr_b16 v[190:191], v211 offset:512
  v_mfma_f32_16x16x32_bf16 v[32:35], a[120:123], v[84:87], v[32:35]
  ds_read_b64_tr_b16 v[188:189], v211 offset:0
  v_mfma_f32_16x16x32_bf16 v[36:39], a[184:187], v[84:87], v[36:39]
  ds_read_b64_tr_b16 v[186:187], v210 offset:512
  s_waitcnt lgkmcnt(7)
  v_mfma_f32_16x16x32_bf16 v[24:27], a[188:191], v[88:91], v[24:27]
  ds_read_b64_tr_b16 v[80:81], v98 offset:4096
  ds_read_b64_tr_b16 v[184:185], v210 offset:0
  v_mfma_f32_16x16x32_bf16 v[36:39], a[188:191], v[92:95], v[36:39]
  ds_read_b64_tr_b16 v[82:83], v98 offset:6144
  ds_read_b64_tr_b16 v[182:183], v209 offset:512
  v_mfma_f32_16x16x32_bf16 v[16:19], a[60:63], v[88:91], v[16:19]
  ds_read_b64_tr_b16 v[84:85], v99 offset:4096
  ds_read_b64_tr_b16 v[180:181], v209 offset:0
  v_mfma_f32_16x16x32_bf16 v[20:23], a[124:127], v[88:91], v[20:23]
  ds_read_b64_tr_b16 v[86:87], v99 offset:6144
  ds_read_b64_tr_b16 v[178:179], v208 offset:512
  v_mul_f32 v65, s46, v24
  v_mfma_f32_16x16x32_bf16 v[28:31], a[60:63], v[92:95], v[28:31]
  ds_read_b64_tr_b16 v[176:177], v208 offset:0
  v_mul_f32 v67, s46, v36
  v_cvt_pk_bf16_f32 v64, 0, -v65
  v_mfma_f32_16x16x32_bf16 v[32:35], a[124:127], v[92:95], v[32:35]
  buffer_load_dwordx4 v219, s[24:27], s9 offen offset:2048 lds
  s_add_u32 s9, s20, 333824
  s_waitcnt lgkmcnt(12)
  v_mfma_f32_16x16x32_bf16 v[40:43], a[0:3], v[72:75], 0
  ds_read_b64_tr_b16 v[88:89], v98 offset:8192
  ds_write_b32 v101, v68
  v_cvt_pk_bf16_f32 v66, 0, -v67
  v_mfma_f32_16x16x32_bf16 v[44:47], a[64:67], v[72:75], 0
  ds_read_b64_tr_b16 v[90:91], v98 offset:10240
  buffer_load_dwordx4 v220, s[24:27], s9 offen offset:3072 lds
  v_mfma_f32_16x16x32_bf16 v[48:51], a[128:131], v[72:75], 0
  ds_read_b64_tr_b16 v[92:93], v99 offset:8192
  ds_write2_b64 v100, v[66:67], v[64:65] offset0:64 offset1:80
  s_waitcnt vmcnt(9)
  v_mfma_f32_16x16x32_bf16 v[52:55], a[0:3], v[76:79], 0
  ds_read_b64_tr_b16 v[94:95], v99 offset:10240
  ds_read_b64_tr_b16 v[206:207], v211 offset:16896
  v_mfma_f32_16x16x32_bf16 v[56:59], a[64:67], v[76:79], 0
  ds_read_b64_tr_b16 v[204:205], v211 offset:16384
  v_mfma_f32_16x16x32_bf16 v[60:63], a[128:131], v[76:79], 0
  ds_read_b64_tr_b16 v[202:203], v210 offset:16896
  s_waitcnt lgkmcnt(11)
  v_mfma_f32_16x16x32_bf16 v[40:43], a[4:7], v[80:83], v[40:43]
  ds_read_b64_tr_b16 v[72:73], v98 offset:12288
  ds_read_b64_tr_b16 v[200:201], v210 offset:16384
  v_mfma_f32_16x16x32_bf16 v[44:47], a[68:71], v[80:83], v[44:47]
  ds_read_b64_tr_b16 v[74:75], v98 offset:14336
  ds_read_b64_tr_b16 v[198:199], v209 offset:16896
  v_mfma_f32_16x16x32_bf16 v[48:51], a[132:135], v[80:83], v[48:51]
  ds_read_b64_tr_b16 v[76:77], v99 offset:12288
wpad_0_4:
  s_cbranch_execz wpad_0_8
  ds_read_b64_tr_b16 v[196:197], v209 offset:16384
  v_mfma_f32_16x16x32_bf16 v[52:55], a[4:7], v[84:87], v[52:55]
  ds_read_b64_tr_b16 v[78:79], v99 offset:14336
  s_waitcnt lgkmcnt(11)
  s_barrier
  v_mfma_f32_16x16x32_bf16 v[56:59], a[68:71], v[84:87], v[56:59]
  ds_read_b64_tr_b16 v[194:195], v208 offset:16896
  v_mfma_f32_16x16x32_bf16 v[60:63], a[132:135], v[84:87], v[60:63]
  ds_read_b64_tr_b16 v[192:193], v208 offset:16384
  s_waitcnt lgkmcnt(12)
  v_mfma_f32_16x16x32_bf16 v[40:43], a[8:11], v[88:91], v[40:43]
  ds_read_b64_tr_b16 v[80:81], v98 offset:16384
  ds_read_b32 v118, v119 offset:512
  v_mfma_f32_16x16x32_bf16 v[44:47], a[72:75], v[88:91], v[44:47]
  ds_read_b64_tr_b16 v[82:83], v98 offset:18432
  ds_read_b32 v116, v102 offset:512
  v_mfma_f32_16x16x32_bf16 v[48:51], a[136:139], v[88:91], v[48:51]
  ds_read_b64_tr_b16 v[84:85], v99 offset:16384
  ds_read_b32 v117, v103 offset:512
  s_waitcnt vmcnt(5)
  v_mfma_f32_16x16x32_bf16 v[52:55], a[8:11], v[92:95], v[52:55]
  ds_read_b64_tr_b16 v[86:87], v99 offset:18432
  ds_read_b64_tr_b16 v[254:255], v211 offset:33280
  s_add_u32 m0, s42, 0
  v_mfma_f32_16x16x32_bf16 v[56:59], a[72:75], v[92:95], v[56:59]
  ds_read_b64_tr_b16 v[252:253], v211 offset:32768
  s_add_u32 s9, s19, 303104
  v_mfma_f32_16x16x32_bf16 v[60:63], a[136:139], v[92:95], v[60:63]
  ds_read_b128 v[64:67], v70
  s_waitcnt lgkmcnt(0)
  v_add_f32 v64, v64, v65
  v_mfma_f32_16x16x32_bf16 v[40:43], a[12:15], v[72:75], v[40:43]
  ds_read_b64_tr_b16 v[88:89], v98 offset:20480
  ds_read_b64_tr_b16 v[250:251], v210 offset:33280
  v_add_f32 v66, v66, v67
  v_mfma_f32_16x16x32_bf16 v[44:47], a[76:79], v[72:75], v[44:47]
  ds_read_b64_tr_b16 v[90:91], v98 offset:22528
  ds_read_b64_tr_b16 v[248:249], v210 offset:32768
  v_add_f32 v65, v64, v66
  v_mfma_f32_16x16x1_4b_f32 v[16:31], v104, v116, v[16:31]
  ds_read_b64_tr_b16 v[246:247], v209 offset:33280
  v_add_f32 v64, v64, v66
  buffer_load_dwordx4 v219, s[24:27], s9 offen offset:0 lds
  v_mfma_f32_16x16x32_bf16 v[48:51], a[140:143], v[72:75], v[48:51]
  ds_read_b64_tr_b16 v[92:93], v99 offset:20480
  v_permlane32_swap_b32 v64, v65
  v_mfma_f32_16x16x32_bf16 v[52:55], a[12:15], v[76:79], v[52:55]
  ds_read_b64_tr_b16 v[94:95], v99 offset:22528
  ds_read_b64_tr_b16 v[244:245], v209 offset:32768
  v_add_f32 v68, v64, v65
  v_mfma_f32_16x16x1_4b_f32 v[32:47], v105, v117, v[32:47]
  buffer_load_dwordx4 v220, s[24:27], s9 offen offset:1024 lds
  s_add_u32 s9, s19, 317440
  ds_read_b64_tr_b16 v[242:243], v208 offset:33280
  v_mfma_f32_16x16x32_bf16 v[56:59], a[76:79], v[76:79], v[56:59]
  ds_read_b64_tr_b16 v[240:241], v208 offset:32768
  v_mfma_f32_16x16x32_bf16 v[60:63], a[140:143], v[76:79], v[60:63]
  v_mov_b32 v5, 0
  buffer_atomic_add v5, v2, s[4:7], s41 offen sc0 sc1
  v_mfma_f32_16x16x32_bf16 v[40:43], a[16:19], v[80:83], v[40:43]
  ds_read_b64_tr_b16 v[72:73], v98 offset:24576
  s_lshl_b32 s57, s34, 18
  v_mfma_f32_16x16x32_bf16 v[44:47], a[80:83], v[80:83], v[44:47]
  ds_read_b64_tr_b16 v[74:75], v98 offset:26624
  v_mul_f32 v16, v16, v20
  v_mul_f32 v17, v17, v21
  v_mfma_f32_16x16x32_bf16 v[48:51], a[144:147], v[80:83], v[48:51]
  ds_read_b64_tr_b16 v[76:77], v99 offset:24576
  buffer_store_dword v68, v71, s[4:7], s30 offen offset:1024 sc1
  v_mfma_f32_16x16x32_bf16 v[52:55], a[16:19], v[84:87], v[52:55]
  ds_read_b64_tr_b16 v[78:79], v99 offset:26624
  v_mul_f32 v18, v18, v22
  v_mul_f32 v19, v19, v23
  v_mfma_f32_16x16x32_bf16 v[56:59], a[80:83], v[84:87], v[56:59]
  buffer_load_dwordx4 v219, s[24:27], s9 offen offset:2048 lds
  v_mul_f32 v28, v28, v32
  v_mfma_f32_16x16x32_bf16 v[60:63], a[144:147], v[84:87], v[60:63]
  v_mul_f32 v29, v29, v33
  v_mul_f32 v30, v30, v34
  s_waitcnt lgkmcnt(7)
  v_mfma_f32_16x16x32_bf16 v[40:43], a[20:23], v[88:91], v[40:43]
  ds_read_b64_tr_b16 v[80:81], v98 offset:28672
  v_mul_f32 v31, v31, v35
  v_cvt_pk_bf16_f32 v124, v16, v17
  v_mfma_f32_16x16x32_bf16 v[44:47], a[84:87], v[88:91], v[44:47]
  ds_read_b64_tr_b16 v[82:83], v98 offset:30720
  v_cvt_pk_bf16_f32 v125, v18, v19
  v_cvt_pk_bf16_f32 v126, v28, v29
  v_mfma_f32_16x16x32_bf16 v[48:51], a[148:151], v[88:91], v[48:51]
  ds_read_b64_tr_b16 v[84:85], v99 offset:28672
  v_cvt_pk_bf16_f32 v127, v30, v31
  s_waitcnt vmcnt(5)
  v_mfma_f32_16x16x32_bf16 v[52:55], a[20:23], v[92:95], v[52:55]
  ds_read_b64_tr_b16 v[86:87], v99 offset:30720
  v_permlane16_swap_b32 v124, v126
  v_mfma_f32_16x16x32_bf16 v[56:59], a[84:87], v[92:95], v[56:59]
  v_permlane16_swap_b32 v125, v127
  s_add_u32 s57, s57, s39
  v_mfma_f32_16x16x32_bf16 v[60:63], a[148:151], v[92:95], v[60:63]
  buffer_store_dwordx4 v[124:127], v140, s[4:7], s100 offen sc1
  s_mul_i32 s55, s3, 49152
  s_waitcnt lgkmcnt(4)
  v_mfma_f32_16x16x32_bf16 v[40:43], a[24:27], v[72:75], v[40:43]
  ds_read_b64_tr_b16 v[88:89], v98 offset:32768
  ds_read_b64_tr_b16 v[238:239], v211 offset:49664
  s_add_u32 s57, s57, s55
  v_mfma_f32_16x16x32_bf16 v[44:47], a[88:91], v[72:75], v[44:47]
  ds_read_b64_tr_b16 v[90:91], v98 offset:34816
  v_permlane16_swap_b32 v24, v36
  v_mfma_f32_16x16x32_bf16 v[48:51], a[152:155], v[72:75], v[48:51]
  ds_read_b64_tr_b16 v[92:93], v99 offset:32768
  buffer_load_dwordx4 v220, s[24:27], s9 offen offset:3072 lds
  v_mfma_f32_16x16x32_bf16 v[52:55], a[24:27], v[76:79], v[52:55]
  ds_read_b64_tr_b16 v[94:95], v99 offset:34816
  ds_read_b64_tr_b16 v[236:237], v211 offset:49152
  v_mfma_f32_16x16x32_bf16 v[56:59], a[88:91], v[76:79], v[56:59]
  v_permlane16_swap_b32 v25, v37
  v_mfma_f32_16x16x32_bf16 v[60:63], a[152:155], v[76:79], v[60:63]
  ds_read_b64_tr_b16 v[234:235], v210 offset:49664
  s_waitcnt lgkmcnt(7)
  v_mfma_f32_16x16x32_bf16 v[40:43], a[28:31], v[80:83], v[40:43]
  ds_read_b64_tr_b16 v[72:73], v98 offset:36864
  ds_read_b64_tr_b16 v[232:233], v210 offset:49152
  v_mfma_f32_16x16x32_bf16 v[44:47], a[92:95], v[80:83], v[44:47]
  ds_read_b64_tr_b16 v[74:75], v98 offset:38912
  v_permlane16_swap_b32 v26, v38
  v_mfma_f32_16x16x32_bf16 v[48:51], a[156:159], v[80:83], v[48:51]
  ds_read_b64_tr_b16 v[76:77], v99 offset:36864
  ds_read_b64_tr_b16 v[230:231], v209 offset:49664
  v_mfma_f32_16x16x32_bf16 v[52:55], a[28:31], v[84:87], v[52:55]
  ds_read_b64_tr_b16 v[78:79], v99 offset:38912
  v_permlane16_swap_b32 v27, v39
  v_mfma_f32_16x16x32_bf16 v[56:59], a[92:95], v[84:87], v[56:59]
  ds_read_b64_tr_b16 v[228:229], v209 offset:49152
  v_mul_f32 v24, v24, v36
  v_mul_f32 v25, v25, v37
  v_mfma_f32_16x16x32_bf16 v[60:63], a[156:159], v[84:87], v[60:63]
  ds_read_b64_tr_b16 v[226:227], v208 offset:49664
  v_mul_f32 v26, v26, v38
  s_waitcnt lgkmcnt(10)
  v_mfma_f32_16x16x32_bf16 v[40:43], a[32:35], v[88:91], v[40:43]
  ds_read_b64_tr_b16 v[80:81], v98 offset:40960
  ds_read_b64_tr_b16 v[224:225], v208 offset:49152
  v_mul_f32 v27, v27, v39
  v_mfma_f32_16x16x32_bf16 v[44:47], a[96:99], v[88:91], v[44:47]
  ds_read_b64_tr_b16 v[82:83], v98 offset:43008
  v_cvt_pk_bf16_f32 v120, v24, v25
  v_cvt_pk_bf16_f32 v121, v26, v27
  v_mfma_f32_16x16x32_bf16 v[48:51], a[160:163], v[88:91], v[48:51]
  ds_read_b64_tr_b16 v[84:85], v99 offset:40960
  v_mfma_f32_16x16x32_bf16 v[52:55], a[32:35], v[92:95], v[52:55]
  ds_read_b64_tr_b16 v[86:87], v99 offset:43008
  v_mfma_f32_16x16x32_bf16 v[56:59], a[96:99], v[92:95], v[56:59]
  buffer_store_dwordx2 v[120:121], v141, s[4:7], s101 offen sc1
  s_lshl_b32 s51, s34, 8
  v_mfma_f32_16x16x32_bf16 v[60:63], a[160:163], v[92:95], v[60:63]
  s_barrier
  s_waitcnt lgkmcnt(7)
  v_mfma_f32_16x16x32_bf16 v[40:43], a[36:39], v[72:75], v[40:43]
  ds_read_b64_tr_b16 v[88:89], v98 offset:45056
  buffer_atomic_sub v122, v123, s[4:7], s28 offen sc1
  v_mfma_f32_16x16x32_bf16 v[44:47], a[100:103], v[72:75], v[44:47]
  ds_read_b64_tr_b16 v[90:91], v98 offset:47104
  s_add_u32 s51, s51, 158724
  v_mfma_f32_16x16x1_4b_f32 v[48:63], v106, v118, v[48:63]
  v_and_b32 v117, 31, v0
  v_lshl_add_u32 v117, v117, 3, s51
  ds_read_b32 v117, v117
  v_mfma_f32_16x16x32_bf16 v[48:51], a[164:167], v[72:75], v[48:51]
  ds_read_b64_tr_b16 v[92:93], v99 offset:45056
  v_mfma_f32_16x16x32_bf16 v[52:55], a[36:39], v[76:79], v[52:55]
  ds_read_b64_tr_b16 v[94:95], v99 offset:47104
  v_mfma_f32_16x16x32_bf16 v[56:59], a[100:103], v[76:79], v[56:59]
  s_waitcnt vmcnt(6)
  v_cmp_ne_u32 vcc, 0, v5
  s_cbranch_vccnz poll_5_s
poll_5_ok:
  v_mfma_f32_16x16x32_bf16 v[60:63], a[164:167], v[76:79], v[60:63]
  s_barrier
  s_waitcnt lgkmcnt(5)
  v_mfma_f32_16x16x32_bf16 v[40:43], a[40:43], v[80:83], v[40:43]
  ds_read_b64_tr_b16 v[72:73], v98 offset:49152
  buffer_load_dwordx4 v[64:67], v7, s[4:7], s57 offen offset:0 sc1
  v_mfma_f32_16x16x32_bf16 v[44:47], a[104:107], v[80:83], v[44:47]
  ds_read_b64_tr_b16 v[74:75], v98 offset:51200
  v_mfma_f32_16x16x32_bf16 v[48:51], a[168:171], v[80:83], v[48:51]
  ds_read_b64_tr_b16 v[76:77], v99 offset:49152
  buffer_load_dwordx4 v[128:131], v7, s[4:7], s57 offen offset:256 sc1
  v_mfma_f32_16x16x32_bf16 v[52:55], a[40:43], v[84:87], v[52:55]
  ds_read_b64_tr_b16 v[78:79], v99 offset:51200
  s_waitcnt vmcnt(4)
  v_mfma_f32_16x16x32_bf16 v[56:59], a[104:107], v[84:87], v[56:59]
  ds_read_b64_tr_b16 v[222:223], v211 offset:512
  v_mfma_f32_16x16x32_bf16 v[60:63], a[168:171], v[84:87], v[60:63]
  buffer_load_dwordx4 v[132:135], v7, s[4:7], s57 offen offset:2048 sc1
  s_waitcnt lgkmcnt(5)
  v_mfma_f32_16x16x32_bf16 v[40:43], a[44:47], v[88:91], v[40:43]
  ds_read_b64_tr_b16 v[80:81], v98 offset:53248
  ds_read_b64_tr_b16 v[220:221], v211 offset:0
  v_mfma_f32_16x16x32_bf16 v[44:47], a[108:111], v[88:91], v[44:47]
  ds_read_b64_tr_b16 v[82:83], v98 offset:55296
  ds_read_b64_tr_b16 v[218:219], v210 offset:512
  v_mfma_f32_16x16x32_bf16 v[48:51], a[172:175], v[88:91], v[48:51]
  ds_read_b64_tr_b16 v[84:85], v99 offset:53248
  ds_read_b64_tr_b16 v[216:217], v210 offset:0
  v_mfma_f32_16x16x32_bf16 v[52:55], a[44:47], v[92:95], v[52:55]
  ds_read_b64_tr_b16 v[86:87], v99 offset:55296
  buffer_load_dwordx4 v[136:139], v7, s[4:7], s57 offen offset:2304 sc1
  v_mfma_f32_16x16x32_bf16 v[56:59], a[108:111], v[92:95], v[56:59]
  ds_read_b64_tr_b16 v[214:215], v209 offset:512
  s_add_u32 s57, s57, 4096
  v_mfma_f32_16x16x32_bf16 v[60:63], a[172:175], v[92:95], v[60:63]
  ds_read_b64_tr_b16 v[212:213], v209 offset:0
  s_waitcnt lgkmcnt(10)
  v_mfma_f32_16x16x32_bf16 v[40:43], a[48:51], v[72:75], v[40:43]
  ds_read_b64_tr_b16 v[88:89], v98 offset:57344
  buffer_load_dwordx4 v[16:19], v7, s[4:7], s57 offen offset:0 sc1
  v_mfma_f32_16x16x32_bf16 v[44:47], a[112:115], v[72:75], v[44:47]
  ds_read_b64_tr_b16 v[90:91], v98 offset:59392
  v_mfma_f32_16x16x32_bf16 v[48:51], a[176:179], v[72:75], v[48:51]
  ds_read_b64_tr_b16 v[92:93], v99 offset:57344
  ds_read_b64_tr_b16 v[210:211], v208 offset:512
  v_mfma_f32_16x16x32_bf16 v[52:55], a[48:51], v[76:79], v[52:55]
  ds_read_b64_tr_b16 v[94:95], v99 offset:59392
  v_mfma_f32_16x16x32_bf16 v[56:59], a[112:115], v[76:79], v[56:59]
  buffer_load_dwordx4 v[20:23], v7, s[4:7], s57 offen offset:256 sc1
  v_mfma_f32_16x16x32_bf16 v[60:63], a[176:179], v[76:79], v[60:63]
  ds_read_b64_tr_b16 v[208:209], v208 offset:0
  s_waitcnt lgkmcnt(8)
  v_mfma_f32_16x16x32_bf16 v[40:43], a[52:55], v[80:83], v[40:43]
  ds_read_b64_tr_b16 v[72:73], v98 offset:61440
  v_mfma_f32_16x16x32_bf16 v[44:47], a[116:119], v[80:83], v[44:47]
  ds_read_b64_tr_b16 v[74:75], v98 offset:63488
  v_mfma_f32_16x16x32_bf16 v[48:51], a[180:183], v[80:83], v[48:51]
  ds_read_b64_tr_b16 v[76:77], v99 offset:61440
  v_mfma_f32_16x16x32_bf16 v[52:55], a[52:55], v[84:87], v[52:55]
  ds_read_b64_tr_b16 v[78:79], v99 offset:63488
  v_mfma_f32_16x16x32_bf16 v[56:59], a[116:119], v[84:87], v[56:59]
  buffer_load_dwordx4 v[24:27], v7, s[4:7], s57 offen offset:2048 sc1
  v_mfma_f32_16x16x32_bf16 v[60:63], a[180:183], v[84:87], v[60:63]
  s_waitcnt lgkmcnt(5)
  v_mfma_f32_16x16x32_bf16 v[40:43], a[56:59], v[88:91], v[40:43]
  buffer_load_dwordx4 v[28:31], v7, s[4:7], s57 offen offset:2304 sc1
  s_add_u32 s57, s57, 12288
  v_mfma_f32_16x16x32_bf16 v[44:47], a[120:123], v[88:91], v[44:47]
  v_mfma_f32_16x16x32_bf16 v[48:51], a[184:187], v[88:91], v[48:51]
  buffer_load_dwordx4 v[32:35], v7, s[4:7], s57 offen offset:0 sc1
  v_mfma_f32_16x16x32_bf16 v[52:55], a[56:59], v[92:95], v[52:55]
  v_mfma_f32_16x16x32_bf16 v[56:59], a[120:123], v[92:95], v[56:59]
  v_mfma_f32_16x16x32_bf16 v[60:63], a[184:187], v[92:95], v[60:63]
  buffer_load_dwordx4 v[36:39], v7, s[4:7], s57 offen offset:2048 sc1
  s_add_u32 s57, s57, 4096
  s_waitcnt lgkmcnt(0)
  v_mfma_f32_16x16x32_bf16 v[40:43], a[60:63], v[72:75], v[40:43]
  v_mfma_f32_16x16x32_bf16 v[44:47], a[124:127], v[72:75], v[44:47]
  v_mfma_f32_16x16x32_bf16 v[48:51], a[188:191], v[72:75], v[48:51]
  v_mfma_f32_16x16x32_bf16 v[52:55], a[60:63], v[76:79], v[52:55]
  buffer_load_dwordx4 v[68:71], v70, s[4:7], s30 offen offset:0 sc1
  v_mfma_f32_16x16x32_bf16 v[56:59], a[124:127], v[76:79], v[56:59]
  v_mfma_f32_16x16x32_bf16 v[60:63], a[188:191], v[76:79], v[60:63]
  s_waitcnt vmcnt(10)
  v_mfma_f32_16x16x32_bf16 v[80:83], a[196:199], v[64:67], 0
  s_nop 0
  v_mul_f32 v40, v40, v44
  v_mul_f32 v41, v41, v45
  v_mul_f32 v42, v42, v46
  v_mfma_f32_16x16x32_bf16 v[88:91], a[200:203], v[64:67], 0
  v_mul_f32 v43, v43, v47
  v_mul_f32 v52, v52, v56
  v_mul_f32 v53, v53, v57
  v_mfma_f32_16x16x32_bf16 v[96:99], a[204:207], v[64:67], 0
  v_mul_f32 v54, v54, v58
  v_mul_f32 v55, v55, v59
  v_cvt_pk_bf16_f32 v124, v40, v41
  v_mfma_f32_16x16x32_bf16 v[72:75], a[192:195], v[64:67], 0
  buffer_load_dwordx4 v[64:67], v7, s[4:7], s57 offen offset:0 sc1
  v_cvt_pk_bf16_f32 v125, v42, v43
  s_waitcnt vmcnt(10)
  v_mfma_f32_16x16x32_bf16 v[84:87], a[196:199], v[128:131], 0
  v_cvt_pk_bf16_f32 v126, v52, v53
  v_cvt_pk_bf16_f32 v127, v54, v55
  s_nop 0
  v_permlane16_swap_b32 v124, v126
  v_mfma_f32_16x16x32_bf16 v[92:95], a[200:203], v[128:131], 0
  v_permlane16_swap_b32 v125, v127
  v_permlane16_swap_b32 v48, v60
  v_mfma_f32_16x16x32_bf16 v[100:103], a[204:207], v[128:131], 0
  v_permlane16_swap_b32 v49, v61
  v_permlane16_swap_b32 v50, v62
  v_mfma_f32_16x16x32_bf16 v[76:79], a[192:195], v[128:131], 0
  buffer_load_dwordx4 v[40:43], v7, s[4:7], s57 offen offset:2048 sc1
  s_add_u32 s57, s57, 12288
  s_waitcnt vmcnt(10)
  v_mfma_f32_16x16x32_bf16 v[80:83], a[212:215], v[132:135], v[80:83]
  v_permlane16_swap_b32 v51, v63
  v_mul_f32 v48, v48, v60
  v_mfma_f32_16x16x32_bf16 v[88:91], a[216:219], v[132:135], v[88:91]
  v_mul_f32 v49, v49, v61
  v_mul_f32 v50, v50, v62
  v_mul_f32 v51, v51, v63
  v_mfma_f32_16x16x32_bf16 v[96:99], a[220:223], v[132:135], v[96:99]
  v_cvt_pk_bf16_f32 v120, v48, v49
  v_cvt_pk_bf16_f32 v121, v50, v51
  v_mov_b32 v5, 0
  buffer_atomic_add v5, v6, s[4:7], s28 offen sc0 sc1
  v_mfma_f32_16x16x32_bf16 v[72:75], a[208:211], v[132:135], v[72:75]
  buffer_load_dwordx4 v[44:47], v7, s[4:7], s57 offen offset:0 sc1
  buffer_store_dwordx4 v[124:127], v140, s[4:7], s62 offen sc1
  s_waitcnt vmcnt(12)
  v_mfma_f32_16x16x32_bf16 v[84:87], a[212:215], v[136:139], v[84:87]
  buffer_store_dwordx2 v[120:121], v141, s[4:7], s31 offen sc1
  v_mfma_f32_16x16x32_bf16 v[92:95], a[216:219], v[136:139], v[92:95]
  s_barrier
  v_mfma_f32_16x16x32_bf16 v[100:103], a[220:223], v[136:139], v[100:103]
  buffer_atomic_sub v4, v123, s[4:7], s28 offen sc1
  v_and_b32 v104, 63, v0
  v_mfma_f32_16x16x32_bf16 v[76:79], a[208:211], v[136:139], v[76:79]
  buffer_load_dwordx4 v[52:55], v7, s[4:7], s57 offen offset:2048 sc1
  s_add_u32 s57, s57, 4096
  s_waitcnt vmcnt(14)
  v_mfma_f32_16x16x32_bf16 v[80:83], a[228:231], v[16:19], v[80:83]
  s_lshl_b32 s51, s3, 13
  s_add_u32 s51, s51, 0
  v_lshl_add_u32 v104, v104, 4, s51
  v_mfma_f32_16x16x32_bf16 v[88:91], a[232:235], v[16:19], v[88:91]
  v_xor_b32 v105, 8192, v104
  v_xor_b32 v106, 16384, v104
  v_xor_b32 v107, 24576, v104
  v_mfma_f32_16x16x32_bf16 v[96:99], a[236:239], v[16:19], v[96:99]
  v_lshlrev_b32 v108, 16, v8
  v_and_b32 v109, 0xffff0000, v8
  v_lshlrev_b32 v110, 16, v9
  v_mfma_f32_16x16x32_bf16 v[72:75], a[224:227], v[16:19], v[72:75]
  buffer_load_dwordx4 v[56:59], v7, s[4:7], s57 offen offset:0 sc1
  s_add_u32 s57, s57, -20480
  s_waitcnt vmcnt(14)
  v_mfma_f32_16x16x32_bf16 v[84:87], a[228:231], v[20:23], v[84:87]
  v_and_b32 v111, 0xffff0000, v9
  v_lshlrev_b32 v112, 16, v10
  v_and_b32 v113, 0xffff0000, v10
  v_mfma_f32_16x16x32_bf16 v[92:95], a[232:235], v[20:23], v[92:95]
  v_lshlrev_b32 v114, 16, v11
  v_and_b32 v115, 0xffff0000, v11
  v_and_b32 v120, 15, v0
  v_mfma_f32_16x16x32_bf16 v[100:103], a[236:239], v[20:23], v[100:103]
  v_bfe_u32 v121, v0, 4, 2
  s_lshl1_add_u32 s58, s32, s34
  v_mfma_f32_16x16x32_bf16 v[76:79], a[224:227], v[20:23], v[76:79]
  buffer_load_dwordx4 v[128:131], v7, s[4:7], s57 offen offset:256 sc1
  s_waitcnt vmcnt(14)
  v_mfma_f32_16x16x32_bf16 v[80:83], a[244:247], v[24:27], v[80:83]
  s_lshl2_add_u32 s52, s35, s3
  v_mul_u32_u24 v142, 0x804, v120
  v_mfma_f32_16x16x32_bf16 v[88:91], a[248:251], v[24:27], v[88:91]
  v_and_b32 v122, 1, v120
  v_and_b32 v142, 0x1030, v142
  v_mfma_f32_16x16x32_bf16 v[96:99], a[252:255], v[24:27], v[96:99]
  v_lshl_add_u32 v142, v122, 3, v142
  v_lshl_add_u32 v10, v121, 1, v122
  v_mfma_f32_16x16x32_bf16 v[72:75], a[240:243], v[24:27], v[72:75]
  buffer_load_dwordx4 v[132:135], v7, s[4:7], s57 offen offset:2304 sc1
  s_add_u32 s57, s57, 4096
  s_waitcnt vmcnt(14)
  v_mfma_f32_16x16x32_bf16 v[84:87], a[244:247], v[28:31], v[84:87]
  v_lshrrev_b32 v122, 1, v121
  v_lshl_add_u32 v142, v122, 6, v142
  v_mfma_f32_16x16x32_bf16 v[92:95], a[248:251], v[28:31], v[92:95]
  v_and_b32 v122, 1, v121
  v_lshl_add_u32 v142, v122, 2, v142
  v_mfma_f32_16x16x32_bf16 v[100:103], a[252:255], v[28:31], v[100:103]
  s_mul_i32 s8, s3, 0x20002000
  s_and_b32 s8, s8, 0x40002000
  v_mfma_f32_16x16x32_bf16 v[76:79], a[240:243], v[28:31], v[76:79]
  buffer_load_dwordx4 v[136:139], v7, s[4:7], s57 offen offset:256 sc1
  s_waitcnt vmcnt(14)
  v_mfma_f32_16x16x32_bf16 v[80:83], v[148:151], v[32:35], v[80:83]
  v_or_b32 v142, s8, v142
  v_lshlrev_b32 v11, 2, v0
  v_mfma_f32_16x16x32_bf16 v[88:91], v[152:155], v[32:35], v[88:91]
  v_add_u32 v11, 159744, v11
  v_lshlrev_b32 v10, 14, v10
  v_mfma_f32_16x16x32_bf16 v[96:99], v[156:159], v[32:35], v[96:99]
  v_bfe_u32 v122, v120, 1, 1
  v_lshl_add_u32 v10, v122, 6, v10
  v_mfma_f32_16x16x32_bf16 v[72:75], v[144:147], v[32:35], v[72:75]
  buffer_load_dwordx4 v[16:19], v7, s[4:7], s57 offen offset:2304 sc1
  s_add_u32 s57, s57, 12288
  s_waitcnt vmcnt(14)
  v_mfma_f32_16x16x32_bf16 v[80:83], v[164:167], v[36:39], v[80:83]
  v_lshrrev_b32 v122, 2, v120
  v_lshl_add_u32 v10, v122, 4, v10
  v_mfma_f32_16x16x32_bf16 v[88:91], v[168:171], v[36:39], v[88:91]
  s_lshl_b32 s58, s58, 7
  s_add_u32 s59, s58, 19955712
  v_mfma_f32_16x16x32_bf16 v[96:99], v[172:175], v[36:39], v[96:99]
  s_mul_i32 s52, s52, 0x20200
  s_and_b32 s52, s52, 0x1e2000
  v_mfma_f32_16x16x32_bf16 v[72:75], v[160:163], v[36:39], v[72:75]
  buffer_load_dwordx4 v[20:23], v7, s[4:7], s57 offen offset:256 sc1
  s_waitcnt vmcnt(13)
  v_mfma_f32_16x16x32_bf16 v[80:83], v[180:183], v[64:67], v[80:83]
  s_add_u32 s58, s58, s52
  s_add_u32 s58, s58, 10485760
  v_mfma_f32_16x16x32_bf16 v[88:91], v[184:187], v[64:67], v[88:91]
  s_mov_b32 s16, 0x55555555
  s_mov_b32 s17, s16
  v_mfma_f32_16x16x32_bf16 v[96:99], v[188:191], v[64:67], v[96:99]
  s_mov_b32 s18, 0x33333333
  s_mov_b32 s19, s18
  v_mfma_f32_16x16x32_bf16 v[72:75], v[176:179], v[64:67], v[72:75]
  buffer_load_dwordx4 v[24:27], v7, s[4:7], s57 offen offset:2304 sc1
  s_add_u32 s57, s57, 4096
  s_waitcnt vmcnt(13)
  v_mfma_f32_16x16x32_bf16 v[80:83], v[196:199], v[40:43], v[80:83]
  v_mfma_f32_16x16x32_bf16 v[88:91], v[200:203], v[40:43], v[88:91]
  v_mfma_f32_16x16x32_bf16 v[96:99], v[204:207], v[40:43], v[96:99]
  v_mul_f32 v117, v117, v117
  v_add_f32 v68, v68, v69
  v_mfma_f32_16x16x32_bf16 v[72:75], v[192:195], v[40:43], v[72:75]
  buffer_load_dwordx4 v[28:31], v7, s[4:7], s57 offen offset:256 sc1
  s_waitcnt vmcnt(12)
  v_mfma_f32_16x16x32_bf16 v[80:83], v[212:215], v[44:47], v[80:83]
  s_lshl_b32 s57, s34, 18
  s_add_u32 s57, s57, s39
  s_add_u32 s57, s57, 4194304
  v_mfma_f32_16x16x32_bf16 v[88:91], v[216:219], v[44:47], v[88:91]
  s_mul_i32 s55, s3, 49152
  s_add_u32 s57, s57, s55
  v_mfma_f32_16x16x32_bf16 v[96:99], v[220:223], v[44:47], v[96:99]
  v_add_f32 v70, v70, v71
  v_add_f32 v69, v68, v70
  v_mfma_f32_16x16x32_bf16 v[72:75], v[208:211], v[44:47], v[72:75]
  v_add_f32 v68, v68, v70
  s_waitcnt vmcnt(8)
  v_mfma_f32_16x16x32_bf16 v[80:83], v[228:231], v[52:55], v[80:83]
  v_permlane32_swap_b32 v68, v69
  v_mfma_f32_16x16x32_bf16 v[88:91], v[232:235], v[52:55], v[88:91]
  v_add_f32 v116, v68, v69
  v_fma_f32 v116, v116, s46, -v117
  v_mfma_f32_16x16x32_bf16 v[96:99], v[236:239], v[52:55], v[96:99]
  v_cmp_lt_u32 vcc, 16, v5
  s_cbranch_vccnz prb_7_s
prb_7_ok:
  v_mfma_f32_16x16x32_bf16 v[72:75], v[224:227], v[52:55], v[72:75]
  buffer_load_dwordx4 v[48:51], v7, s[4:7], s57 offen offset:0 sc1
  s_waitcnt vmcnt(8)
  v_mfma_f32_16x16x32_bf16 v[80:83], v[244:247], v[56:59], v[80:83]
  v_max_f32 v116, 0, v116
  v_cvt_pk_bf16_f32 v116, 0, v116
  v_mfma_f32_16x16x32_bf16 v[88:91], v[248:251], v[56:59], v[88:91]
  v_add_f32 v116, s48, v116
  v_cvt_pk_bf16_f32 v116, 0, v116
  v_mfma_f32_16x16x32_bf16 v[96:99], v[252:255], v[56:59], v[96:99]
  buffer_load_dwordx4 v[60:63], v7, s[4:7], s57 offen offset:256 sc1
  v_mfma_f32_16x16x32_bf16 v[72:75], v[240:243], v[56:59], v[72:75]
  s_waitcnt vmcnt(8)
  v_mfma_f32_16x16x32_bf16 v[84:87], v[148:151], v[128:131], v[84:87]
  v_sqrt_f32 v116, v116
  v_mfma_f32_16x16x32_bf16 v[92:95], v[152:155], v[128:131], v[92:95]
  ds_write_b128 v105, v[80:83] offset:0
  v_cvt_pk_bf16_f32 v116, 0, v116
  v_mfma_f32_16x16x32_bf16 v[100:103], v[156:159], v[128:131], v[100:103]
  buffer_load_dwordx4 v[124:127], v7, s[4:7], s57 offen offset:2048 sc1
  s_waitcnt vmcnt(8)
  v_mfma_f32_16x16x32_bf16 v[84:87], v[164:167], v[132:135], v[84:87]
  ds_write_b128 v106, v[88:91] offset:2048
  v_mul_f32 v116, v116, v116
  v_mfma_f32_16x16x32_bf16 v[92:95], v[168:171], v[132:135], v[92:95]
  v_rcp_f32 v116, v116
  v_mfma_f32_16x16x32_bf16 v[100:103], v[172:175], v[132:135], v[100:103]
  ds_write_b128 v107, v[96:99] offset:4096
  s_waitcnt vmcnt(7)
  v_mfma_f32_16x16x32_bf16 v[84:87], v[180:183], v[136:139], v[84:87]
  buffer_load_dwordx4 v[68:71], v7, s[4:7], s57 offen offset:2304 sc1
  s_add_u32 s57, s57, 4096
  v_mfma_f32_16x16x32_bf16 v[92:95], v[184:187], v[136:139], v[92:95]
  v_mov_b32 v123, 0
  v_mov_b32 v117, v116
  v_mfma_f32_16x16x32_bf16 v[100:103], v[188:191], v[136:139], v[100:103]
  buffer_atomic_add v123, v6, s[4:7], s28 offen sc0 sc1
  s_waitcnt vmcnt(8)
  v_mfma_f32_16x16x32_bf16 v[84:87], v[196:199], v[16:19], v[84:87]
  s_waitcnt lgkmcnt(0)
  s_barrier
  v_mfma_f32_16x16x32_bf16 v[92:95], v[200:203], v[16:19], v[92:95]
  buffer_load_dwordx4 v[32:35], v7, s[4:7], s57 offen offset:0 sc1
  v_mfma_f32_16x16x32_bf16 v[100:103], v[204:207], v[16:19], v[100:103]
  ds_read_b128 v[80:83], v104 offset:0
  s_waitcnt vmcnt(8)
  v_mfma_f32_16x16x32_bf16 v[84:87], v[212:215], v[20:23], v[84:87]
  ds_read_b128 v[88:91], v104 offset:2048
  v_mfma_f32_16x16x32_bf16 v[92:95], v[216:219], v[20:23], v[92:95]
  ds_read_b128 v[96:99], v104 offset:4096
  v_mfma_f32_16x16x32_bf16 v[100:103], v[220:223], v[20:23], v[100:103]
  buffer_load_dwordx4 v[36:39], v7, s[4:7], s57 offen offset:256 sc1
  s_waitcnt vmcnt(8)
  v_mfma_f32_16x16x32_bf16 v[84:87], v[228:231], v[24:27], v[84:87]
  v_permlane16_swap_b32 v116, v117
  v_mfma_f32_16x16x32_bf16 v[92:95], v[232:235], v[24:27], v[92:95]
  v_mfma_f32_16x16x32_bf16 v[100:103], v[236:239], v[24:27], v[100:103]
  s_waitcnt lgkmcnt(1)
  v_add_f32 v80, v80, v88
  s_waitcnt vmcnt(7)
  v_mfma_f32_16x16x32_bf16 v[84:87], v[244:247], v[28:31], v[84:87]
  buffer_load_dwordx4 v[64:67], v7, s[4:7], s57 offen offset:2048 sc1
  v_add_f32 v81, v81, v89
  v_mfma_f32_16x16x32_bf16 v[92:95], v[248:251], v[28:31], v[92:95]
  v_add_f32 v82, v82, v90
  v_add_f32 v83, v83, v91
  s_waitcnt lgkmcnt(0)
  v_mfma_f32_16x16x32_bf16 v[100:103], v[252:255], v[28:31], v[100:103]
  v_add_f32 v80, v80, v96
  v_add_f32 v81, v81, v97
  v_mfma_f32_16x16x32_bf16 v[76:79], v[144:147], v[128:131], v[76:79]
  v_add_f32 v82, v82, v98
  v_add_f32 v83, v83, v99
  v_mfma_f32_16x16x32_bf16 v[76:79], v[160:163], v[132:135], v[76:79]
  buffer_load_dwordx4 v[40:43], v7, s[4:7], s57 offen offset:2304 sc1
  s_add_u32 s57, s57, 12288
  v_mfma_f32_16x16x32_bf16 v[76:79], v[176:179], v[136:139], v[76:79]
  ds_write_b128 v105, v[84:87] offset:1024
  v_fma_f32 v80, v80, v116, v108
  v_fma_f32 v81, v81, v116, v109
  v_mfma_f32_16x16x32_bf16 v[76:79], v[192:195], v[16:19], v[76:79]
  v_mov_b32 v5, 0
  buffer_atomic_add v5, v6, s[4:7], s28 offen sc0 sc1
  v_fma_f32 v82, v82, v116, v110
  v_mfma_f32_16x16x32_bf16 v[76:79], v[208:211], v[20:23], v[76:79]
  ds_write_b128 v106, v[92:95] offset:3072
  v_fma_f32 v83, v83, v116, v111
  v_fma_f32 v72, v72, v116, v80
  v_mfma_f32_16x16x32_bf16 v[76:79], v[224:227], v[24:27], v[76:79]
  v_fma_f32 v73, v73, v116, v81
  v_fma_f32 v74, v74, v116, v82
  v_mfma_f32_16x16x32_bf16 v[76:79], v[240:243], v[28:31], v[76:79]
  ds_write_b128 v107, v[100:103] offset:5120
  v_fma_f32 v75, v75, v116, v83
  v_cvt_pk_bf16_f32 v80, v72, v73
  s_waitcnt lgkmcnt(0)
  s_barrier
  ds_read_b128 v[84:87], v104 offset:1024
  ds_read_b128 v[92:95], v104 offset:3072
  ds_read_b128 v[100:103], v104 offset:5120
  v_cvt_pk_bf16_f32 v81, v74, v75
  s_mov_b64 vcc, s[16:17]
  v_dot2_f32_bf16 v96, v80, s50, 0
  v_dot2_f32_bf16 v97, v80, v80, 0
  v_dot2_f32_bf16 v96, v81, s50, v96
  v_dot2_f32_bf16 v97, v81, v81, v97
  v_cndmask_b32_dpp v88, v81, v80, vcc quad_perm:[1,0,3,2] row_mask:0xf bank_mask:0xf
  s_not_b64 vcc, vcc
  v_cndmask_b32_dpp v89, v80, v81, vcc quad_perm:[1,0,3,2] row_mask:0xf bank_mask:0xf
  buffer_load_dwordx4 v[44:47], v7, s[4:7], s57 offen offset:0 sc1
  s_waitcnt lgkmcnt(1)
  v_pk_add_f32 v[84:85], v[84:85], v[92:93]
  v_pk_add_f32 v[86:87], v[86:87], v[94:95]
  s_waitcnt lgkmcnt(0)
  v_pk_add_f32 v[84:85], v[84:85], v[100:101]
  v_pk_add_f32 v[86:87], v[86:87], v[102:103]
  buffer_load_dwordx4 v[52:55], v7, s[4:7], s57 offen offset:256 sc1
  v_pk_fma_f32 v[84:85], v[84:85], v[116:117], v[112:113] op_sel:[0,1,0] op_sel_hi:[1,1,1]
  v_pk_fma_f32 v[86:87], v[86:87], v[116:117], v[114:115] op_sel:[0,1,0] op_sel_hi:[1,1,1]
  v_pk_fma_f32 v[76:77], v[76:77], v[116:117], v[84:85] op_sel:[0,1,0] op_sel_hi:[1,1,1]
  v_pk_fma_f32 v[78:79], v[78:79], v[116:117], v[86:87] op_sel:[0,1,0] op_sel_hi:[1,1,1]
  v_cvt_pk_bf16_f32 v82, v76, v77
  v_cvt_pk_bf16_f32 v83, v78, v79
  v_dot2_f32_bf16 v98, v82, s50, 0
  v_dot2_f32_bf16 v99, v82, v82, 0
  v_dot2_f32_bf16 v98, v83, s50, v98
  v_dot2_f32_bf16 v99, v83, v83, v99
  v_cndmask_b32_dpp v91, v82, v83, vcc quad_perm:[1,0,3,2] row_mask:0xf bank_mask:0xf
  s_not_b64 vcc, vcc
  v_cndmask_b32_dpp v90, v83, v82, vcc quad_perm:[1,0,3,2] row_mask:0xf bank_mask:0xf
  v_permlane32_swap_b32 v96, v98
  v_permlane32_swap_b32 v97, v99
  s_mov_b64 vcc, s[18:19]
  v_add_f32 v96, v96, v98
  v_add_f32 v97, v97, v99
  v_cndmask_b32_dpp v93, v91, v89, vcc quad_perm:[2,3,0,1] row_mask:0xf bank_mask:0xf
  v_cndmask_b32_dpp v92, v90, v88, vcc quad_perm:[2,3,0,1] row_mask:0xf bank_mask:0xf
  v_permlane16_swap_b32 v96, v97
  s_not_b64 vcc, vcc
  v_add_f32 v96, v96, v97
  ds_write_b32 v11, v96 offset:0
  v_cndmask_b32_dpp v94, v88, v90, vcc quad_perm:[2,3,0,1] row_mask:0xf bank_mask:0xf
  v_cndmask_b32_dpp v95, v89, v91, vcc quad_perm:[2,3,0,1] row_mask:0xf bank_mask:0xf
  buffer_store_dwordx4 v[92:95], v10, s[4:7], s58 offen sc1
  s_waitcnt vmcnt(8)
  v_cmp_ne_u32 vcc, 0, v123
  s_cbranch_vccnz prb_6_b
prb_6_ok:
  buffer_load_dwordx4 v[56:59], v7, s[4:7], s57 offen offset:2048 sc1
  s_add_u32 s57, s57, 4096
  v_and_b32 v118, 0xfc, v11
  v_add_u32 v118, 159744, v118
  s_waitcnt lgkmcnt(0)
  s_barrier
  ds_read2_b32 v[140:141], v118 offset0:128 offset1:192
  ds_read2_b32 v[118:119], v118 offset1:64
  buffer_load_dwordx4 v[128:131], v7, s[4:7], s57 offen offset:0 sc1
  v_and_b32 v116, 63, v0
wpad_0_5:
  s_cbranch_execz wpad_0_9
  v_lshlrev_b32 v116, 4, v116
  v_add_u32 v116, 159744, v116
  s_waitcnt lgkmcnt(0)
  buffer_load_dwordx4 v[132:135], v7, s[4:7], s57 offen offset:2048 sc1
  s_add_u32 s57, s57, 12288
  v_add_f32 v118, v118, v119
  v_add_f32 v140, v140, v141
  v_add_f32 v118, v118, v140
  buffer_atomic_add_f32 v118, v142, s[4:7], s59 offen sc1
  s_mov_b32 s29, 35913728
  v_mfma_f32_16x16x32_bf16 v[80:83], a[196:199], v[48:51], 0
  buffer_load_dwordx4 v[136:139], v7, s[4:7], s57 offen offset:0 sc1
  v_mfma_f32_16x16x32_bf16 v[88:91], a[200:203], v[48:51], 0
  v_and_b32 v104, 63, v0
  s_lshl_b32 s51, s3, 13
  v_mfma_f32_16x16x32_bf16 v[96:99], a[204:207], v[48:51], 0
  s_add_u32 s51, s51, 65536
  v_lshl_add_u32 v104, v104, 4, s51
  v_mfma_f32_16x16x32_bf16 v[72:75], a[192:195], v[48:51], 0
  v_xor_b32 v105, 8192, v104
  v_mfma_f32_16x16x32_bf16 v[84:87], a[196:199], v[60:63], 0
  buffer_load_dwordx4 v[16:19], v7, s[4:7], s57 offen offset:2048 sc1
  s_add_u32 s57, s57, 4096
  v_mfma_f32_16x16x32_bf16 v[92:95], a[200:203], v[60:63], 0
  v_xor_b32 v106, 16384, v104
  v_xor_b32 v107, 24576, v104
  v_mfma_f32_16x16x32_bf16 v[100:103], a[204:207], v[60:63], 0
  v_lshlrev_b32 v108, 16, v12
  v_and_b32 v109, 0xffff0000, v12
  v_mfma_f32_16x16x32_bf16 v[76:79], a[192:195], v[60:63], 0
  v_lshlrev_b32 v110, 16, v13
  v_mfma_f32_16x16x32_bf16 v[80:83], a[212:215], v[124:127], v[80:83]
  buffer_load_dwordx4 v[20:23], v7, s[4:7], s57 offen offset:0 sc1
  s_add_u32 s57, s57, -20480
  v_mfma_f32_16x16x32_bf16 v[88:91], a[216:219], v[124:127], v[88:91]
  v_and_b32 v111, 0xffff0000, v13
  v_lshlrev_b32 v112, 16, v14
  v_mfma_f32_16x16x32_bf16 v[96:99], a[220:223], v[124:127], v[96:99]
  v_and_b32 v113, 0xffff0000, v14
  v_lshlrev_b32 v114, 16, v15
  v_mfma_f32_16x16x32_bf16 v[72:75], a[208:211], v[124:127], v[72:75]
  v_and_b32 v115, 0xffff0000, v15
  v_mfma_f32_16x16x32_bf16 v[84:87], a[212:215], v[68:71], v[84:87]
  buffer_load_dwordx4 v[24:27], v7, s[4:7], s57 offen offset:2304 sc1
  s_add_u32 s57, s57, 4096
  v_mfma_f32_16x16x32_bf16 v[92:95], a[216:219], v[68:71], v[92:95]
  s_lshl_b32 s51, s34, 8
  s_add_u32 s51, s51, 159236
  v_mfma_f32_16x16x32_bf16 v[100:103], a[220:223], v[68:71], v[100:103]
  v_and_b32 v117, 31, v0
  v_lshl_add_u32 v117, v117, 3, s51
  v_mfma_f32_16x16x32_bf16 v[76:79], a[208:211], v[68:71], v[76:79]
  ds_read_b32 v117, v117
  s_waitcnt vmcnt(15)
  v_mfma_f32_16x16x32_bf16 v[80:83], a[228:231], v[32:35], v[80:83]
  s_add_u32 s58, s58, 4096
  s_add_u32 s59, s59, 16384
  v_mfma_f32_16x16x32_bf16 v[88:91], a[232:235], v[32:35], v[88:91]
  s_lshr_b32 s51, s3, 1
  s_and_b32 s52, s3, 1
  v_mfma_f32_16x16x32_bf16 v[96:99], a[236:239], v[32:35], v[96:99]
  v_and_b32 v118, 15, v0
  v_bfe_u32 v119, v0, 4, 2
  v_mfma_f32_16x16x32_bf16 v[72:75], a[224:227], v[32:35], v[72:75]
  buffer_load_dwordx4 v[32:35], v116, s[4:7], s30 offen offset:1024 sc1
  s_waitcnt vmcnt(15)
  v_mfma_f32_16x16x32_bf16 v[84:87], a[228:231], v[36:39], v[84:87]
  v_or_b32 v120, 1, v118
  v_lshlrev_b32 v120, 1, v120
  v_mfma_f32_16x16x32_bf16 v[92:95], a[232:235], v[36:39], v[92:95]
  buffer_load_dwordx4 v[28:31], v7, s[4:7], s57 offen offset:256 sc1
  v_mfma_f32_16x16x32_bf16 v[100:103], a[236:239], v[36:39], v[100:103]
  v_lshlrev_b32 v121, 4, v119
  v_sub_u32 v120, v121, v120
  v_mfma_f32_16x16x32_bf16 v[76:79], a[224:227], v[36:39], v[76:79]
  v_and_b32 v122, 1, v118
  s_waitcnt vmcnt(15)
  v_mfma_f32_16x16x32_bf16 v[80:83], a[244:247], v[64:67], v[80:83]
  buffer_load_dwordx4 v[48:51], v7, s[4:7], s57 offen offset:2304 sc1
  s_add_u32 s57, s57, 12288
  v_mfma_f32_16x16x32_bf16 v[88:91], a[248:251], v[64:67], v[88:91]
  v_mul_u32_u24 v122, 4160, v122
  v_sub_u32 v120, v120, v122
  v_mfma_f32_16x16x32_bf16 v[96:99], a[252:255], v[64:67], v[96:99]
  s_mul_i32 s53, s51, 8320
  s_lshl_b32 s54, s52, 8
  v_mfma_f32_16x16x32_bf16 v[72:75], a[240:243], v[64:67], v[72:75]
  s_sub_u32 s53, s53, s54
  s_waitcnt vmcnt(15)
  v_mfma_f32_16x16x32_bf16 v[84:87], a[244:247], v[40:43], v[84:87]
  buffer_load_dwordx4 v[60:63], v7, s[4:7], s57 offen offset:256 sc1
  v_mfma_f32_16x16x32_bf16 v[92:95], a[248:251], v[40:43], v[92:95]
  s_add_u32 s53, s53, 137566
  v_add_u32 v8, s53, v120
  v_mfma_f32_16x16x32_bf16 v[100:103], a[252:255], v[40:43], v[100:103]
  v_add_u32 v9, 1024, v8
  v_lshl_add_u32 v120, v118, 5, v121
  v_mfma_f32_16x16x32_bf16 v[76:79], a[240:243], v[40:43], v[76:79]
  s_mul_i32 s53, s51, 4608
  s_waitcnt vmcnt(14)
  v_mfma_f32_16x16x32_bf16 v[80:83], v[148:151], v[44:47], v[80:83]
  buffer_load_dwordx4 v[124:127], v7, s[4:7], s57 offen offset:2304 sc1
  s_add_u32 s57, s57, 4096
  v_mfma_f32_16x16x32_bf16 v[88:91], v[152:155], v[44:47], v[88:91]
  s_sub_u32 s53, s53, s54
  s_add_u32 s53, s53, 148000
  v_mfma_f32_16x16x32_bf16 v[96:99], v[156:159], v[44:47], v[96:99]
  v_add_u32 v140, s53, v120
  v_mov_b32 v122, 148224
  v_mfma_f32_16x16x32_bf16 v[72:75], v[144:147], v[44:47], v[72:75]
  v_lshl_add_u32 v141, v0, 3, v122
  s_waitcnt vmcnt(14)
  v_mfma_f32_16x16x32_bf16 v[84:87], v[148:151], v[52:55], v[84:87]
  buffer_load_dwordx4 v[68:71], v7, s[4:7], s57 offen offset:256 sc1
  v_mfma_f32_16x16x32_bf16 v[92:95], v[152:155], v[52:55], v[92:95]
  v_lshl_add_u32 v120, v118, 6, v121
  s_lshl_b32 s53, s3, 11
  v_mfma_f32_16x16x32_bf16 v[100:103], v[156:159], v[52:55], v[100:103]
  s_add_u32 s53, s53, 114688
  v_add_u32 v13, s53, v120
  v_mfma_f32_16x16x32_bf16 v[76:79], v[144:147], v[52:55], v[76:79]
  v_and_b32 v120, 63, v0
  s_waitcnt vmcnt(13)
  v_mfma_f32_16x16x32_bf16 v[80:83], v[164:167], v[56:59], v[80:83]
  s_add_u32 s53, s53, 8192
  v_lshl_add_u32 v14, v120, 4, s53
  v_mfma_f32_16x16x32_bf16 v[88:91], v[168:171], v[56:59], v[88:91]
  v_and_b32 v120, 1, v119
  v_lshrrev_b32 v121, 2, v118
  v_mfma_f32_16x16x32_bf16 v[96:99], v[172:175], v[56:59], v[96:99]
  v_lshl_add_u32 v120, v120, 2, v121
  s_waitcnt vmcnt(12)
  v_mfma_f32_16x16x32_bf16 v[80:83], v[180:183], v[128:131], v[80:83]
  v_lshlrev_b32 v120, 17, v120
  v_and_b32 v121, 3, v118
  v_mfma_f32_16x16x32_bf16 v[88:91], v[184:187], v[128:131], v[88:91]
  v_lshl_add_u32 v120, v121, 5, v120
  v_lshrrev_b32 v121, 1, v119
  v_mfma_f32_16x16x32_bf16 v[96:99], v[188:191], v[128:131], v[96:99]
  v_lshl_add_u32 v15, v121, 4, v120
  s_waitcnt vmcnt(11)
  v_mfma_f32_16x16x32_bf16 v[80:83], v[196:199], v[132:135], v[80:83]
  v_mov_b32 v12, 114688
  v_lshl_add_u32 v12, v0, 4, v12
  v_mfma_f32_16x16x32_bf16 v[88:91], v[200:203], v[132:135], v[88:91]
  s_getpc_b64 s[10:11]
pc_8:
  s_and_b32 s8, s2, 0xf8
  v_mfma_f32_16x16x32_bf16 v[96:99], v[204:207], v[132:135], v[96:99]
  v_lshrrev_b32 v6, 5, v0
  s_waitcnt vmcnt(9)
  s_barrier
  buffer_atomic_sub v4, v1, s[4:7], s29 offen sc1
  v_mfma_f32_16x16x32_bf16 v[80:83], v[212:215], v[136:139], v[80:83]
  v_add_u32 v6, s8, v6
  v_lshl_add_u32 v6, v6, 7, 0
  v_mfma_f32_16x16x32_bf16 v[88:91], v[216:219], v[136:139], v[88:91]
  v_min_u32 v6, mega_cend-pc_8-4, v6
  v_mfma_f32_16x16x32_bf16 v[96:99], v[220:223], v[136:139], v[96:99]
  global_load_dword v6, v6, s[10:11]
  s_waitcnt vmcnt(10)
  v_mfma_f32_16x16x32_bf16 v[80:83], v[228:231], v[16:19], v[80:83]
  v_mfma_f32_16x16x32_bf16 v[88:91], v[232:235], v[16:19], v[88:91]
  v_mfma_f32_16x16x32_bf16 v[96:99], v[236:239], v[16:19], v[96:99]
  s_waitcnt vmcnt(9)
  v_mfma_f32_16x16x32_bf16 v[80:83], v[244:247], v[20:23], v[80:83]
  v_mfma_f32_16x16x32_bf16 v[88:91], v[248:251], v[20:23], v[88:91]
  s_waitcnt lgkmcnt(0)
  v_mul_f32 v117, v117, v117
  s_waitcnt vmcnt(7)
  v_add_f32 v32, v32, v33
  v_mfma_f32_16x16x32_bf16 v[96:99], v[252:255], v[20:23], v[96:99]
  v_add_f32 v34, v34, v35
  v_mfma_f32_16x16x32_bf16 v[84:87], v[164:167], v[24:27], v[84:87]
  v_add_f32 v33, v32, v34
  v_add_f32 v32, v32, v34
  v_mfma_f32_16x16x32_bf16 v[92:95], v[168:171], v[24:27], v[92:95]
  s_nop 0
  v_permlane32_swap_b32 v32, v33
  v_mfma_f32_16x16x32_bf16 v[100:103], v[172:175], v[24:27], v[100:103]
  v_add_f32 v116, v32, v33
  s_waitcnt vmcnt(6)
  v_mfma_f32_16x16x32_bf16 v[84:87], v[180:183], v[28:31], v[84:87]
  v_cmp_u_f32 vcc, v80, v80
  s_cbranch_vccnz redo_9_s
redo_9_ok:
  v_mfma_f32_16x16x32_bf16 v[92:95], v[184:187], v[28:31], v[92:95]
  ds_write_b128 v105, v[80:83] offset:0
  v_fma_f32 v116, v116, s46, -v117
  v_mfma_f32_16x16x32_bf16 v[100:103], v[188:191], v[28:31], v[100:103]
  ds_write_b128 v106, v[88:91] offset:2048
  s_waitcnt vmcnt(5)
  v_mfma_f32_16x16x32_bf16 v[84:87], v[196:199], v[48:51], v[84:87]
  ds_write_b128 v107, v[96:99] offset:4096
  v_max_f32 v116, 0, v116
  v_cvt_pk_bf16_f32 v116, 0, v116
  v_mfma_f32_16x16x32_bf16 v[92:95], v[200:203], v[48:51], v[92:95]
  v_add_f32 v116, s48, v116
  v_cvt_pk_bf16_f32 v116, 0, v116
  v_mfma_f32_16x16x32_bf16 v[100:103], v[204:207], v[48:51], v[100:103]
  v_sqrt_f32 v116, v116
  s_waitcnt vmcnt(4)
  v_mfma_f32_16x16x32_bf16 v[84:87], v[212:215], v[60:63], v[84:87]
  v_cvt_pk_bf16_f32 v116, 0, v116
  v_mul_f32 v116, v116, v116
  v_mfma_f32_16x16x32_bf16 v[92:95], v[216:219], v[60:63], v[92:95]
  s_waitcnt lgkmcnt(0)
  s_barrier
  v_mfma_f32_16x16x32_bf16 v[100:103], v[220:223], v[60:63], v[100:103]
  ds_read_b128 v[80:83], v104 offset:0
  s_waitcnt vmcnt(3)
  v_mfma_f32_16x16x32_bf16 v[84:87], v[228:231], v[124:127], v[84:87]
  ds_read_b128 v[88:91], v104 offset:2048
  v_mfma_f32_16x16x32_bf16 v[92:95], v[232:235], v[124:127], v[92:95]
  ds_read_b128 v[96:99], v104 offset:4096
  v_mfma_f32_16x16x32_bf16 v[100:103], v[236:239], v[124:127], v[100:103]
  v_rcp_f32 v116, v116
  s_waitcnt vmcnt(2)
  v_mfma_f32_16x16x32_bf16 v[84:87], v[244:247], v[68:71], v[84:87]
  v_mov_b32 v117, v116
  v_mfma_f32_16x16x32_bf16 v[92:95], v[248:251], v[68:71], v[92:95]
  s_nop 0
  v_permlane16_swap_b32 v116, v117
  v_mfma_f32_16x16x32_bf16 v[100:103], v[252:255], v[68:71], v[100:103]
  v_mfma_f32_16x16x32_bf16 v[72:75], v[160:163], v[56:59], v[72:75]
  s_waitcnt lgkmcnt(1)
  v_add_f32 v80, v80, v88
  v_add_f32 v81, v81, v89
  v_mfma_f32_16x16x32_bf16 v[72:75], v[176:179], v[128:131], v[72:75]
  v_add_f32 v82, v82, v90
  v_add_f32 v83, v83, v91
  s_waitcnt lgkmcnt(0)
  v_cmp_u_f32 vcc, v84, v84
  v_mfma_f32_16x16x32_bf16 v[72:75], v[192:195], v[132:135], v[72:75]
  v_add_f32 v80, v80, v96
  v_add_f32 v81, v81, v97
  s_cbranch_vccnz redo_10_s
redo_10_ok:
  v_mfma_f32_16x16x32_bf16 v[72:75], v[208:211], v[136:139], v[72:75]
  ds_write_b128 v105, v[84:87] offset:1024
  v_add_f32 v82, v82, v98
  v_add_f32 v83, v83, v99
  v_mfma_f32_16x16x32_bf16 v[72:75], v[224:227], v[16:19], v[72:75]
  v_mov_b32 v5, 0
  buffer_atomic_add v5, v3, s[4:7], s29 offen sc0 sc1
  v_fma_f32 v80, v80, v116, v108
  v_mfma_f32_16x16x32_bf16 v[72:75], v[240:243], v[20:23], v[72:75]
  ds_write_b128 v106, v[92:95] offset:3072
  v_fma_f32 v81, v81, v116, v109
  v_fma_f32 v82, v82, v116, v110
  v_mfma_f32_16x16x32_bf16 v[76:79], v[160:163], v[24:27], v[76:79]
  ds_write_b128 v107, v[100:103] offset:5120
  v_fma_f32 v83, v83, v116, v111
  v_mfma_f32_16x16x32_bf16 v[76:79], v[176:179], v[28:31], v[76:79]
  v_mfma_f32_16x16x32_bf16 v[76:79], v[192:195], v[48:51], v[76:79]
  v_mfma_f32_16x16x32_bf16 v[76:79], v[208:211], v[60:63], v[76:79]
  v_fma_f32 v72, v72, v116, v80
  v_fma_f32 v73, v73, v116, v81
  v_mfma_f32_16x16x32_bf16 v[76:79], v[224:227], v[124:127], v[76:79]
  s_waitcnt lgkmcnt(0)
  s_barrier
  v_fma_f32 v74, v74, v116, v82
  v_mfma_f32_16x16x32_bf16 v[76:79], v[240:243], v[68:71], v[76:79]
  ds_read_b128 v[84:87], v104 offset:1024
  v_fma_f32 v75, v75, v116, v83
  v_cvt_pk_bf16_f32 v80, v72, v73
  ds_read_b128 v[92:95], v104 offset:3072
  ds_read_b128 v[100:103], v104 offset:5120
  v_cvt_pk_bf16_f32 v81, v74, v75
  s_mov_b64 vcc, s[16:17]
  v_dot2_f32_bf16 v96, v80, s50, 0
  v_dot2_f32_bf16 v97, v80, v80, 0
  v_dot2_f32_bf16 v96, v81, s50, v96
  v_dot2_f32_bf16 v97, v81, v81, v97
  v_cndmask_b32_dpp v88, v81, v80, vcc quad_perm:[1,0,3,2] row_mask:0xf bank_mask:0xf
  s_not_b64 vcc, vcc
  v_cndmask_b32_dpp v89, v80, v81, vcc quad_perm:[1,0,3,2] row_mask:0xf bank_mask:0xf
  s_waitcnt lgkmcnt(1)
  v_pk_add_f32 v[84:85], v[84:85], v[92:93]
  v_pk_add_f32 v[86:87], v[86:87], v[94:95]
  s_waitcnt lgkmcnt(0)
  v_pk_add_f32 v[84:85], v[84:85], v[100:101]
  v_pk_add_f32 v[86:87], v[86:87], v[102:103]
  v_pk_fma_f32 v[84:85], v[84:85], v[116:117], v[112:113] op_sel:[0,1,0] op_sel_hi:[1,1,1]
  v_pk_fma_f32 v[86:87], v[86:87], v[116:117], v[114:115] op_sel:[0,1,0] op_sel_hi:[1,1,1]
  v_pk_fma_f32 v[76:77], v[76:77], v[116:117], v[84:85] op_sel:[0,1,0] op_sel_hi:[1,1,1]
  v_pk_fma_f32 v[78:79], v[78:79], v[116:117], v[86:87] op_sel:[0,1,0] op_sel_hi:[1,1,1]
  v_cvt_pk_bf16_f32 v82, v76, v77
  v_cvt_pk_bf16_f32 v83, v78, v79
  v_dot2_f32_bf16 v98, v82, s50, 0
  v_dot2_f32_bf16 v99, v82, v82, 0
  v_dot2_f32_bf16 v98, v83, s50, v98
  v_dot2_f32_bf16 v99, v83, v83, v99
  v_cndmask_b32_dpp v91, v82, v83, vcc quad_perm:[1,0,3,2] row_mask:0xf bank_mask:0xf
  s_not_b64 vcc, vcc
  v_cndmask_b32_dpp v90, v83, v82, vcc quad_perm:[1,0,3,2] row_mask:0xf bank_mask:0xf
  v_permlane32_swap_b32 v96, v98
  v_permlane32_swap_b32 v97, v99
  s_mov_b64 vcc, s[18:19]
  v_add_f32 v96, v96, v98
  v_add_f32 v97, v97, v99
  v_cndmask_b32_dpp v93, v91, v89, vcc quad_perm:[2,3,0,1] row_mask:0xf bank_mask:0xf
  v_cndmask_b32_dpp v92, v90, v88, vcc quad_perm:[2,3,0,1] row_mask:0xf bank_mask:0xf
  v_permlane16_swap_b32 v96, v97
  s_not_b64 vcc, vcc
  v_add_f32 v96, v96, v97
  ds_write_b32 v11, v96 offset:1024
  v_cndmask_b32_dpp v94, v88, v90, vcc quad_perm:[2,3,0,1] row_mask:0xf bank_mask:0xf
  v_cndmask_b32_dpp v95, v89, v91, vcc quad_perm:[2,3,0,1] row_mask:0xf bank_mask:0xf
  buffer_store_dwordx4 v[92:95], v10, s[4:7], s58 offen sc1
  v_and_b32 v118, 0xfc, v11
  v_add_u32 v118, 160768, v118
  s_lshl_b32 s53, s36, 6
  s_and_b32 s53, s53, 0x2000
  s_add_u32 s53, s53, 19841024
  s_mul_i32 s54, s36, 0x4040
  s_and_b32 s54, s54, 0x1fe000
  s_add_u32 s54, s54, 10371072
  s_add_u32 s8, s53, 4096
  s_waitcnt vmcnt(1)
  v_cmp_ne_u32 vcc, 0, v5
  s_cbranch_vccnz poll_11_s
poll_11_ok:
  s_waitcnt lgkmcnt(0)
  s_barrier
  ds_read2_b32 v[120:121], v118 offset0:128 offset1:192
  ds_read2_b32 v[118:119], v118 offset1:64
  buffer_load_dwordx4 v[132:135], v12, s[4:7], s53 offen sc1
  buffer_load_dwordx4 v[136:139], v12, s[4:7], s8 offen sc1
  buffer_load_dwordx4 v[128:131], v12, s[4:7], s54 offen sc1
  v_add_u32 v6, -2048, v8
  v_add_u32 v7, -1024, v8
  s_waitcnt lgkmcnt(0)
  v_add_f32 v118, v118, v119
  v_add_f32 v120, v120, v121
  v_add_f32 v118, v118, v120
  buffer_atomic_add_f32 v118, v142, s[4:7], s59 offen sc1
  ds_read2_b32 v[16:17], v9 offset0:176 offset1:177
  ds_read2_b32 v[18:19], v9 offset0:178 offset1:179
  ds_read2_b32 v[20:21], v9 offset0:48 offset1:49
  ds_read2_b32 v[22:23], v9 offset0:50 offset1:51
  ds_read2_b32 v[24:25], v8 offset0:176 offset1:177
  ds_read2_b32 v[26:27], v8 offset0:178 offset1:179
  ds_read2_b32 v[28:29], v8 offset0:48 offset1:49
  ds_read2_b32 v[30:31], v8 offset0:50 offset1:51
  s_mov_b32 s98, 35979264
  s_add_u32 s30, s30, 8388608
  s_mov_b32 s38, 6291456
  s_add_u32 s39, s39, 8388608
  s_mov_b32 s40, 35782656
  s_mov_b32 s41, 36045056
  v_mov_b32 v96, 0
  v_mov_b32 v97, s48
  s_waitcnt vmcnt(1)
  ds_read2_b32 v[32:33], v9 offset0:160 offset1:161
  ds_read2_b32 v[34:35], v9 offset0:162 offset1:163
  v_pk_fma_f32 v[132:133], v[132:133], s[46:47], v[96:97]
  v_pk_fma_f32 v[134:135], v[134:135], s[46:47], v[96:97]
  v_pk_fma_f32 v[136:137], v[136:137], s[46:47], v[96:97]
  v_pk_fma_f32 v[138:139], v[138:139], s[46:47], v[96:97]
  ds_read2_b32 v[36:37], v9 offset0:32 offset1:33
  ds_read2_b32 v[38:39], v9 offset0:34 offset1:35
  v_fma_f32 v133, -v132, v132, v133
  v_fma_f32 v135, -v134, v134, v135
  v_fma_f32 v137, -v136, v136, v137
  v_fma_f32 v139, -v138, v138, v139
  ds_read2_b32 v[40:41], v8 offset0:160 offset1:161
  ds_read2_b32 v[42:43], v8 offset0:162 offset1:163
  v_rsq_f32 v133, |v133|
  v_lshlrev_b32 v80, 16, v128
  v_and_b32 v81, 0xffff0000, v128
  v_rsq_f32 v135, |v135|
  ds_read2_b32 v[44:45], v8 offset0:32 offset1:33
  ds_read2_b32 v[46:47], v8 offset0:34 offset1:35
  v_lshlrev_b32 v82, 16, v129
  v_and_b32 v83, 0xffff0000, v129
  v_rsq_f32 v137, |v137|
  ds_read2_b32 v[48:49], v9 offset0:144 offset1:145
  ds_read2_b32 v[50:51], v9 offset0:146 offset1:147
  v_lshlrev_b32 v84, 16, v130
  v_and_b32 v85, 0xffff0000, v130
  v_rsq_f32 v139, |v139|
  v_lshlrev_b32 v86, 16, v131
  ds_read2_b32 v[52:53], v9 offset0:16 offset1:17
  ds_read2_b32 v[54:55], v9 offset0:18 offset1:19
  v_and_b32 v87, 0xffff0000, v131
  v_pk_add_f32 v[88:89], v[80:81], v[132:133] op_sel:[0,0] op_sel_hi:[1,0] neg_lo:[0,1] neg_hi:[0,1]
  v_pk_add_f32 v[90:91], v[82:83], v[134:135] op_sel:[0,0] op_sel_hi:[1,0] neg_lo:[0,1] neg_hi:[0,1]
  v_pk_add_f32 v[92:93], v[84:85], v[136:137] op_sel:[0,0] op_sel_hi:[1,0] neg_lo:[0,1] neg_hi:[0,1]
  ds_read2_b32 v[56:57], v8 offset0:144 offset1:145
  ds_read2_b32 v[58:59], v8 offset0:146 offset1:147
  v_pk_add_f32 v[94:95], v[86:87], v[138:139] op_sel:[0,0] op_sel_hi:[1,0] neg_lo:[0,1] neg_hi:[0,1]
  v_pk_mul_f32 v[88:89], v[88:89], v[132:133] op_sel:[0,1] op_sel_hi:[1,1]
  v_pk_mul_f32 v[90:91], v[90:91], v[134:135] op_sel:[0,1] op_sel_hi:[1,1]
  v_pk_mul_f32 v[92:93], v[92:93], v[136:137] op_sel:[0,1] op_sel_hi:[1,1]
  ds_read2_b32 v[60:61], v8 offset0:16 offset1:17
  ds_read2_b32 v[62:63], v8 offset0:18 offset1:19
  v_pk_mul_f32 v[94:95], v[94:95], v[138:139] op_sel:[0,1] op_sel_hi:[1,1]
  v_cvt_pk_bf16_f32 v128, v88, v90
  v_cvt_pk_bf16_f32 v129, v92, v94
  ds_read2_b32 v[64:65], v9 offset0:128 offset1:129
  ds_read2_b32 v[66:67], v9 offset0:130 offset1:131
  ds_write_b64 v141, v[128:129] offset:0
  v_cvt_pk_bf16_f32 v130, v89, v91
  v_cvt_pk_bf16_f32 v131, v93, v95
  ds_write_b64 v141, v[130:131] offset:4608
  ds_read2_b32 v[68:69], v9 offset0:0 offset1:1
  ds_read2_b32 v[70:71], v9 offset0:2 offset1:3
  v_fma_f32 v132, v88, s44, v80
  v_fma_f32 v133, v90, s44, v82
  v_fma_f32 v134, v92, s44, v84
  v_fma_f32 v135, v94, s44, v86
  ds_read2_b32 v[72:73], v8 offset0:128 offset1:129
  ds_read2_b32 v[74:75], v8 offset0:130 offset1:131
  ds_write_b128 v12, v[132:135] offset:0
  v_fma_f32 v136, v89, s45, v81
  v_fma_f32 v137, v91, s45, v83
  v_fma_f32 v138, v93, s45, v85
  ds_read2_b32 v[76:77], v8 offset0:0 offset1:1
  ds_read2_b32 v[78:79], v8 offset0:2 offset1:3
  v_fma_f32 v139, v95, s45, v87
  ds_write_b128 v12, v[136:139] offset:4096
  s_waitcnt vmcnt(0)
  s_barrier
  buffer_atomic_sub v4, v1, s[4:7], s98 offen sc1
  s_waitcnt lgkmcnt(0)
  s_barrier
  ds_read_b128 v[80:83], v140 offset:192
  ds_read_b128 v[84:87], v140 offset:704
  ds_read_b128 v[88:91], v140 offset:1216
  ds_read_b128 v[92:95], v140 offset:1728
  ds_read_b128 v[96:99], v140 offset:128
  ds_read_b128 v[100:103], v140 offset:640
  ds_read_b128 v[104:107], v140 offset:1152
  ds_read_b128 v[108:111], v140 offset:1664
  ds_read_b128 v[132:135], v13 offset:0
  ds_read_b128 v[136:139], v13 offset:1024
  s_lshl_b32 s51, s36, 1
  s_lshr_b32 s52, s3, 1
  s_add_u32 s51, s51, s52
  s_lshl_b32 s51, s51, 7
  s_and_b32 s53, s51, 0xe000
  s_add_u32 s51, s51, s53
  s_and_b32 s52, s3, 1
  s_lshl_b32 s53, s52, 13
  s_add_u32 s51, s51, s53
  s_add_u32 s29, s51, s38
  v_xor_b32 v142, 2048, v14
  s_waitcnt lgkmcnt(9)
  v_mfma_f32_16x16x32_bf16 v[112:115], v[16:19], v[80:83], 0
  v_mfma_f32_16x16x32_bf16 v[116:119], v[20:23], v[80:83], 0
  v_mfma_f32_16x16x32_bf16 v[120:123], v[24:27], v[80:83], 0
  v_mfma_f32_16x16x32_bf16 v[124:127], v[28:31], v[80:83], 0
  ds_read_b128 v[80:83], v140 offset:64
  s_waitcnt lgkmcnt(9)
  v_mfma_f32_16x16x32_bf16 v[116:119], v[16:19], v[84:87], v[116:119]
  v_mfma_f32_16x16x32_bf16 v[120:123], v[20:23], v[84:87], v[120:123]
  v_mfma_f32_16x16x32_bf16 v[124:127], v[24:27], v[84:87], v[124:127]
  ds_read_b128 v[84:87], v140 offset:576
  s_waitcnt lgkmcnt(8)
  v_mfma_f32_16x16x32_bf16 v[120:123], v[16:19], v[88:91], v[120:123]
  v_mfma_f32_16x16x32_bf16 v[124:127], v[20:23], v[88:91], v[124:127]
  ds_read_b128 v[88:91], v140 offset:1088
  v_mfma_f32_16x16x32_bf16 v[124:127], v[16:19], v[92:95], v[124:127]
  ds_read_b128 v[92:95], v140 offset:1600
  s_waitcnt lgkmcnt(6)
  v_mfma_f32_16x16x32_bf16 v[112:115], v[32:35], v[96:99], v[112:115]
  v_mfma_f32_16x16x32_bf16 v[116:119], v[36:39], v[96:99], v[116:119]
  v_mfma_f32_16x16x32_bf16 v[120:123], v[40:43], v[96:99], v[120:123]
  v_mfma_f32_16x16x32_bf16 v[124:127], v[44:47], v[96:99], v[124:127]
  ds_read_b128 v[96:99], v140 offset:0
  v_mfma_f32_16x16x32_bf16 v[116:119], v[32:35], v[100:103], v[116:119]
  v_mfma_f32_16x16x32_bf16 v[120:123], v[36:39], v[100:103], v[120:123]
  v_mfma_f32_16x16x32_bf16 v[124:127], v[40:43], v[100:103], v[124:127]
  ds_read_b128 v[100:103], v140 offset:512
  v_mfma_f32_16x16x32_bf16 v[120:123], v[32:35], v[104:107], v[120:123]
  v_mfma_f32_16x16x32_bf16 v[124:127], v[36:39], v[104:107], v[124:127]
  ds_read_b128 v[104:107], v140 offset:1024
  v_mfma_f32_16x16x32_bf16 v[124:127], v[32:35], v[108:111], v[124:127]
  ds_read_b128 v[108:111], v140 offset:1536
  s_waitcnt lgkmcnt(7)
  v_mfma_f32_16x16x32_bf16 v[112:115], v[48:51], v[80:83], v[112:115]
  v_mfma_f32_16x16x32_bf16 v[116:119], v[52:55], v[80:83], v[116:119]
  v_mfma_f32_16x16x32_bf16 v[120:123], v[56:59], v[80:83], v[120:123]
  v_mfma_f32_16x16x32_bf16 v[124:127], v[60:63], v[80:83], v[124:127]
  s_waitcnt lgkmcnt(6)
  v_mfma_f32_16x16x32_bf16 v[116:119], v[48:51], v[84:87], v[116:119]
  v_mfma_f32_16x16x32_bf16 v[120:123], v[52:55], v[84:87], v[120:123]
  v_mfma_f32_16x16x32_bf16 v[124:127], v[56:59], v[84:87], v[124:127]
  s_waitcnt lgkmcnt(4)
  v_mfma_f32_16x16x32_bf16 v[120:123], v[48:51], v[88:91], v[120:123]
  v_mfma_f32_16x16x32_bf16 v[124:127], v[52:55], v[88:91], v[124:127]
  v_mfma_f32_16x16x32_bf16 v[124:127], v[48:51], v[92:95], v[124:127]
  s_waitcnt lgkmcnt(3)
  v_mfma_f32_16x16x32_bf16 v[112:115], v[64:67], v[96:99], v[112:115]
  ds_read2_b32 v[92:93], v6 offset0:0 offset1:1
  v_mfma_f32_16x16x32_bf16 v[116:119], v[68:71], v[96:99], v[116:119]
  ds_read2_b32 v[94:95], v6 offset0:2 offset1:3
  v_mfma_f32_16x16x32_bf16 v[120:123], v[72:75], v[96:99], v[120:123]
  ds_read2_b32 v[88:89], v6 offset0:128 offset1:129
  v_mfma_f32_16x16x32_bf16 v[124:127], v[76:79], v[96:99], v[124:127]
  ds_read2_b32 v[90:91], v6 offset0:130 offset1:131
  s_waitcnt lgkmcnt(6)
  v_mfma_f32_16x16x32_bf16 v[116:119], v[64:67], v[100:103], v[116:119]
  ds_read2_b32 v[84:85], v7 offset0:0 offset1:1
  v_mfma_f32_16x16x32_bf16 v[120:123], v[68:71], v[100:103], v[120:123]
  ds_read2_b32 v[86:87], v7 offset0:2 offset1:3
  v_mfma_f32_16x16x32_bf16 v[124:127], v[72:75], v[100:103], v[124:127]
  ds_read2_b32 v[80:81], v7 offset0:128 offset1:129
  s_waitcnt lgkmcnt(7)
  v_mfma_f32_16x16x32_bf16 v[120:123], v[64:67], v[104:107], v[120:123]
  ds_read2_b32 v[82:83], v7 offset0:130 offset1:131
  v_mfma_f32_16x16x32_bf16 v[124:127], v[68:71], v[104:107], v[124:127]
  v_mfma_f32_16x16x32_bf16 v[124:127], v[64:67], v[108:111], v[124:127]
  v_mov_b32 v5, 0
  buffer_atomic_add v5, v3, s[4:7], s98 offen sc0 sc1
  s_cmp_eq_u32 s52, 0
  s_nop 6
  s_cbranch_scc1 cx_12_0
  ds_write_b128 v14, v[112:115] offset:0
  ds_write_b128 v14, v[116:119] offset:1024
  v_pk_add_f32 v[132:133], v[132:133], v[120:121]
  v_pk_add_f32 v[134:135], v[134:135], v[122:123]
  v_pk_add_f32 v[136:137], v[136:137], v[124:125]
  v_pk_add_f32 v[138:139], v[138:139], v[126:127]
  s_branch cx_12_1
cx_12_0:
  ds_write_b128 v14, v[120:123] offset:0
  ds_write_b128 v14, v[124:127] offset:1024
  v_pk_add_f32 v[132:133], v[132:133], v[112:113]
  v_pk_add_f32 v[134:135], v[134:135], v[114:115]
  v_pk_add_f32 v[136:137], v[136:137], v[116:117]
  v_pk_add_f32 v[138:139], v[138:139], v[118:119]
cx_12_1:
  s_waitcnt lgkmcnt(6)
  v_mfma_f32_16x16x32_bf16 v[124:127], v[92:95], v[96:99], 0
  ds_read2_b32 v[92:93], v6 offset0:16 offset1:17
  s_waitcnt lgkmcnt(1)
  s_barrier
  v_mfma_f32_16x16x32_bf16 v[120:123], v[88:91], v[96:99], 0
  ds_read2_b32 v[94:95], v6 offset0:18 offset1:19
  ds_read_b128 v[128:131], v142
  v_mfma_f32_16x16x32_bf16 v[116:119], v[84:87], v[96:99], 0
  ds_read_b128 v[8:11], v142 offset:1024
  s_lshl_b32 s53, s36, 6
  v_mfma_f32_16x16x32_bf16 v[112:115], v[80:83], v[96:99], 0
  ds_read_b128 v[96:99], v140 offset:64
  s_and_b32 s53, s53, 0x2000
  v_mfma_f32_16x16x32_bf16 v[124:127], v[88:91], v[100:103], v[124:127]
  ds_read2_b32 v[88:89], v6 offset0:144 offset1:145
  s_add_u32 s53, s53, 19857408
  v_mfma_f32_16x16x32_bf16 v[120:123], v[84:87], v[100:103], v[120:123]
  ds_read2_b32 v[90:91], v6 offset0:146 offset1:147
  s_mul_i32 s54, s36, 0x4040
  v_mfma_f32_16x16x32_bf16 v[116:119], v[80:83], v[100:103], v[116:119]
  s_and_b32 s54, s54, 0x1fe000
  s_add_u32 s54, s54, 10375168
  v_mfma_f32_16x16x32_bf16 v[124:127], v[84:87], v[104:107], v[124:127]
  ds_read2_b32 v[84:85], v7 offset0:16 offset1:17
  s_waitcnt lgkmcnt(4)
  v_add_f32 v132, v132, v128
  v_mfma_f32_16x16x32_bf16 v[120:123], v[80:83], v[104:107], v[120:123]
  ds_read2_b32 v[86:87], v7 offset0:18 offset1:19
  v_add_f32 v133, v133, v129
  v_add_f32 v134, v134, v130
  v_mfma_f32_16x16x32_bf16 v[124:127], v[80:83], v[108:111], v[124:127]
  ds_read2_b32 v[80:81], v7 offset0:144 offset1:145
  v_add_f32 v135, v135, v131
  v_add_f32 v136, v136, v8
  v_mfma_f32_16x16x32_bf16 v[112:115], v[76:79], v[100:103], v[112:115]
  ds_read2_b32 v[82:83], v7 offset0:146 offset1:147
  v_add_f32 v137, v137, v9
  v_add_f32 v138, v138, v10
  v_mfma_f32_16x16x32_bf16 v[116:119], v[76:79], v[104:107], v[116:119]
  ds_read_b128 v[100:103], v140 offset:576
  v_add_f32 v139, v139, v11
  v_cvt_pk_bf16_f32 v8, v132, v133
  v_mfma_f32_16x16x32_bf16 v[112:115], v[72:75], v[104:107], v[112:115]
  ds_read_b128 v[104:107], v140 offset:1088
  v_cvt_pk_bf16_f32 v10, v136, v137
  v_cvt_pk_bf16_f32 v9, v134, v135
  v_mfma_f32_16x16x32_bf16 v[120:123], v[76:79], v[108:111], v[120:123]
  v_cvt_pk_bf16_f32 v11, v138, v139
  s_add_u32 s8, s53, 4096
  v_mfma_f32_16x16x32_bf16 v[116:119], v[72:75], v[108:111], v[116:119]
  v_permlane16_swap_b32 v8, v10
  v_mfma_f32_16x16x32_bf16 v[112:115], v[68:71], v[108:111], v[112:115]
  ds_read_b128 v[108:111], v140 offset:1600
  v_permlane16_swap_b32 v9, v11
  s_waitcnt lgkmcnt(7)
  v_mfma_f32_16x16x32_bf16 v[124:127], v[92:95], v[96:99], v[124:127]
  ds_read2_b32 v[92:93], v6 offset0:32 offset1:33
  buffer_store_dwordx4 v[8:11], v15, s[4:7], s29 offen sc1
  v_mfma_f32_16x16x32_bf16 v[120:123], v[88:91], v[96:99], v[120:123]
  ds_read2_b32 v[94:95], v6 offset0:34 offset1:35
  s_waitcnt lgkmcnt(5)
  v_mfma_f32_16x16x32_bf16 v[116:119], v[84:87], v[96:99], v[116:119]
  v_mfma_f32_16x16x32_bf16 v[112:115], v[80:83], v[96:99], v[112:115]
  ds_read_b128 v[96:99], v140 offset:128
  s_waitcnt lgkmcnt(4)
  v_mfma_f32_16x16x32_bf16 v[124:127], v[88:91], v[100:103], v[124:127]
  ds_read2_b32 v[88:89], v6 offset0:160 offset1:161
wpad_0_6:
  s_cbranch_execz wret_0
  v_mfma_f32_16x16x32_bf16 v[120:123], v[84:87], v[100:103], v[120:123]
  ds_read2_b32 v[90:91], v6 offset0:162 offset1:163
  v_mfma_f32_16x16x32_bf16 v[116:119], v[80:83], v[100:103], v[116:119]
  v_mfma_f32_16x16x32_bf16 v[124:127], v[84:87], v[104:107], v[124:127]
  ds_read2_b32 v[84:85], v7 offset0:32 offset1:33
  v_mfma_f32_16x16x32_bf16 v[120:123], v[80:83], v[104:107], v[120:123]
  ds_read2_b32 v[86:87], v7 offset0:34 offset1:35
  s_waitcnt lgkmcnt(7)
  v_mfma_f32_16x16x32_bf16 v[124:127], v[80:83], v[108:111], v[124:127]
  ds_read2_b32 v[80:81], v7 offset0:160 offset1:161
  v_mfma_f32_16x16x32_bf16 v[112:115], v[60:63], v[100:103], v[112:115]
  ds_read2_b32 v[82:83], v7 offset0:162 offset1:163
  v_mfma_f32_16x16x32_bf16 v[116:119], v[60:63], v[104:107], v[116:119]
  ds_read_b128 v[100:103], v140 offset:640
  v_mfma_f32_16x16x32_bf16 v[112:115], v[56:59], v[104:107], v[112:115]
  ds_read_b128 v[104:107], v140 offset:1152
  s_waitcnt vmcnt(1)
  v_cmp_ne_u32 vcc, 0, v5
  v_mfma_f32_16x16x32_bf16 v[120:123], v[60:63], v[108:111], v[120:123]
  s_cbranch_vccnz poll_13_s
poll_13_ok:
  s_barrier
  v_mfma_f32_16x16x32_bf16 v[116:119], v[56:59], v[108:111], v[116:119]
  buffer_load_dwordx4 v[132:135], v12, s[4:7], s53 offen sc1
  buffer_load_dwordx4 v[136:139], v12, s[4:7], s8 offen sc1
  buffer_load_dwordx4 v[128:131], v12, s[4:7], s54 offen sc1
  v_mfma_f32_16x16x32_bf16 v[112:115], v[52:55], v[108:111], v[112:115]
  ds_read_b128 v[108:111], v140 offset:1664
  s_waitcnt lgkmcnt(7)
  v_mfma_f32_16x16x32_bf16 v[124:127], v[92:95], v[96:99], v[124:127]
  ds_read2_b32 v[92:93], v6 offset0:48 offset1:49
  v_mfma_f32_16x16x32_bf16 v[120:123], v[88:91], v[96:99], v[120:123]
  ds_read2_b32 v[94:95], v6 offset0:50 offset1:51
  s_waitcnt lgkmcnt(5)
  v_mfma_f32_16x16x32_bf16 v[116:119], v[84:87], v[96:99], v[116:119]
  v_mfma_f32_16x16x32_bf16 v[112:115], v[80:83], v[96:99], v[112:115]
  ds_read_b128 v[96:99], v140 offset:192
  s_waitcnt lgkmcnt(4)
  v_mfma_f32_16x16x32_bf16 v[124:127], v[88:91], v[100:103], v[124:127]
  ds_read2_b32 v[88:89], v6 offset0:176 offset1:177
  v_mfma_f32_16x16x32_bf16 v[120:123], v[84:87], v[100:103], v[120:123]
  ds_read2_b32 v[90:91], v6 offset0:178 offset1:179
  v_mfma_f32_16x16x32_bf16 v[116:119], v[80:83], v[100:103], v[116:119]
  v_mfma_f32_16x16x32_bf16 v[124:127], v[84:87], v[104:107], v[124:127]
  ds_read2_b32 v[84:85], v7 offset0:48 offset1:49
  v_mfma_f32_16x16x32_bf16 v[120:123], v[80:83], v[104:107], v[120:123]
  ds_read2_b32 v[86:87], v7 offset0:50 offset1:51
  s_waitcnt lgkmcnt(7)
  v_mfma_f32_16x16x32_bf16 v[124:127], v[80:83], v[108:111], v[124:127]
  ds_read2_b32 v[80:81], v7 offset0:176 offset1:177
  v_mfma_f32_16x16x32_bf16 v[112:115], v[44:47], v[100:103], v[112:115]
  ds_read2_b32 v[82:83], v7 offset0:178 offset1:179
  v_mfma_f32_16x16x32_bf16 v[116:119], v[44:47], v[104:107], v[116:119]
  ds_read_b128 v[100:103], v140 offset:704
  v_mfma_f32_16x16x32_bf16 v[112:115], v[40:43], v[104:107], v[112:115]
  ds_read_b128 v[104:107], v140 offset:1216
  v_mfma_f32_16x16x32_bf16 v[120:123], v[44:47], v[108:111], v[120:123]
  v_mfma_f32_16x16x32_bf16 v[116:119], v[40:43], v[108:111], v[116:119]
  v_mfma_f32_16x16x32_bf16 v[112:115], v[36:39], v[108:111], v[112:115]
  ds_read_b128 v[108:111], v140 offset:1728
  s_waitcnt lgkmcnt(7)
  v_mfma_f32_16x16x32_bf16 v[124:127], v[92:95], v[96:99], v[124:127]
  v_mfma_f32_16x16x32_bf16 v[120:123], v[88:91], v[96:99], v[120:123]
  s_waitcnt lgkmcnt(3)
  v_mfma_f32_16x16x32_bf16 v[116:119], v[84:87], v[96:99], v[116:119]
  s_waitcnt vmcnt(3)
  s_barrier
  v_mfma_f32_16x16x32_bf16 v[112:115], v[80:83], v[96:99], v[112:115]
  buffer_atomic_sub v4, v1, s[4:7], s40 offen sc1
  s_waitcnt lgkmcnt(1)
  v_mfma_f32_16x16x32_bf16 v[124:127], v[88:91], v[100:103], v[124:127]
  v_mfma_f32_16x16x32_bf16 v[120:123], v[84:87], v[100:103], v[120:123]
  v_mfma_f32_16x16x32_bf16 v[116:119], v[80:83], v[100:103], v[116:119]
  v_mfma_f32_16x16x32_bf16 v[124:127], v[84:87], v[104:107], v[124:127]
  v_mfma_f32_16x16x32_bf16 v[120:123], v[80:83], v[104:107], v[120:123]
  s_waitcnt lgkmcnt(0)
  v_mfma_f32_16x16x32_bf16 v[124:127], v[80:83], v[108:111], v[124:127]
  v_mfma_f32_16x16x32_bf16 v[112:115], v[28:31], v[100:103], v[112:115]
  v_mfma_f32_16x16x32_bf16 v[116:119], v[28:31], v[104:107], v[116:119]
  v_mfma_f32_16x16x32_bf16 v[112:115], v[24:27], v[104:107], v[112:115]
  v_mfma_f32_16x16x32_bf16 v[120:123], v[28:31], v[108:111], v[120:123]
  v_mfma_f32_16x16x32_bf16 v[116:119], v[24:27], v[108:111], v[116:119]
  v_mfma_f32_16x16x32_bf16 v[112:115], v[20:23], v[108:111], v[112:115]
  v_mov_b32 v96, 0
  v_mov_b32 v97, s48
  s_waitcnt vmcnt(1)
  v_pk_fma_f32 v[132:133], v[132:133], s[46:47], v[96:97]
  v_pk_fma_f32 v[134:135], v[134:135], s[46:47], v[96:97]
  v_pk_fma_f32 v[136:137], v[136:137], s[46:47], v[96:97]
  v_pk_fma_f32 v[138:139], v[138:139], s[46:47], v[96:97]
  v_fma_f32 v133, -v132, v132, v133
  v_fma_f32 v135, -v134, v134, v135
  v_fma_f32 v137, -v136, v136, v137
  v_fma_f32 v139, -v138, v138, v139
  v_rsq_f32 v133, |v133|
  v_lshlrev_b32 v80, 16, v128
  v_and_b32 v81, 0xffff0000, v128
  v_rsq_f32 v135, |v135|
  v_lshlrev_b32 v82, 16, v129
  v_and_b32 v83, 0xffff0000, v129
  v_rsq_f32 v137, |v137|
  v_lshlrev_b32 v84, 16, v130
  v_and_b32 v85, 0xffff0000, v130
  v_rsq_f32 v139, |v139|
  v_lshlrev_b32 v86, 16, v131
  v_and_b32 v87, 0xffff0000, v131
  v_pk_add_f32 v[88:89], v[80:81], v[132:133] op_sel:[0,0] op_sel_hi:[1,0] neg_lo:[0,1] neg_hi:[0,1]
  v_pk_add_f32 v[90:91], v[82:83], v[134:135] op_sel:[0,0] op_sel_hi:[1,0] neg_lo:[0,1] neg_hi:[0,1]
  v_pk_add_f32 v[92:93], v[84:85], v[136:137] op_sel:[0,0] op_sel_hi:[1,0] neg_lo:[0,1] neg_hi:[0,1]
  v_pk_add_f32 v[94:95], v[86:87], v[138:139] op_sel:[0,0] op_sel_hi:[1,0] neg_lo:[0,1] neg_hi:[0,1]
  v_pk_mul_f32 v[88:89], v[88:89], v[132:133] op_sel:[0,1] op_sel_hi:[1,1]
  v_pk_mul_f32 v[90:91], v[90:91], v[134:135] op_sel:[0,1] op_sel_hi:[1,1]
  v_pk_mul_f32 v[92:93], v[92:93], v[136:137] op_sel:[0,1] op_sel_hi:[1,1]
  v_pk_mul_f32 v[94:95], v[94:95], v[138:139] op_sel:[0,1] op_sel_hi:[1,1]
  v_cvt_pk_bf16_f32 v128, v88, v90
  v_cvt_pk_bf16_f32 v129, v92, v94
  ds_write_b64 v141, v[128:129] offset:2048
  v_cvt_pk_bf16_f32 v130, v89, v91
  v_cvt_pk_bf16_f32 v131, v93, v95
  ds_write_b64 v141, v[130:131] offset:6656
  v_fma_f32 v132, v88, s44, v80
  v_fma_f32 v133, v90, s44, v82
  v_fma_f32 v134, v92, s44, v84
  v_fma_f32 v135, v94, s44, v86
  ds_write_b128 v12, v[132:135] offset:0
  v_fma_f32 v136, v89, s45, v81
  v_fma_f32 v137, v91, s45, v83
  v_fma_f32 v138, v93, s45, v85
  v_fma_f32 v139, v95, s45, v87
  ds_write_b128 v12, v[136:139] offset:4096
  s_waitcnt lgkmcnt(0)
  s_barrier
  ds_read_b128 v[80:83], v140 offset:2240
  ds_read_b128 v[84:87], v140 offset:2752
  ds_read_b128 v[88:91], v140 offset:3264
  ds_read_b128 v[92:95], v140 offset:3776
  ds_read_b128 v[96:99], v140 offset:2176
  ds_read_b128 v[100:103], v140 offset:2688
  ds_read_b128 v[104:107], v140 offset:3200
  ds_read_b128 v[108:111], v140 offset:3712
  ds_read_b128 v[132:135], v13 offset:0
  ds_read_b128 v[136:139], v13 offset:1024
  s_lshl_b32 s51, s36, 1
  s_lshr_b32 s52, s3, 1
  s_add_u32 s51, s51, s52
  s_lshl_b32 s51, s51, 7
  s_and_b32 s53, s51, 0xe000
  s_add_u32 s51, s51, s53
  s_and_b32 s52, s3, 1
  s_lshl_b32 s53, s52, 13
  s_add_u32 s51, s51, s53
  s_add_u32 s29, s51, s38
  s_add_u32 s29, s29, 1048576
  v_xor_b32 v142, 2048, v14
  s_waitcnt lgkmcnt(9)
  v_mfma_f32_16x16x32_bf16 v[112:115], v[16:19], v[80:83], v[112:115]
  v_mov_b32 v5, 0
  buffer_atomic_add v5, v3, s[4:7], s40 offen sc0 sc1
  v_mfma_f32_16x16x32_bf16 v[116:119], v[20:23], v[80:83], v[116:119]
  v_bfe_u32 v6, v0, 4, 2
  v_and_b32 v7, 63, v0
  v_mfma_f32_16x16x32_bf16 v[120:123], v[24:27], v[80:83], v[120:123]
  v_lshlrev_b32 v6, 5, v6
  v_lshlrev_b32 v7, 4, v7
  v_mfma_f32_16x16x32_bf16 v[124:127], v[28:31], v[80:83], v[124:127]
  ds_read_b128 v[80:83], v140 offset:2112
  s_waitcnt lgkmcnt(9)
  v_mfma_f32_16x16x32_bf16 v[116:119], v[16:19], v[84:87], v[116:119]
  v_xor_b32 v6, v7, v6
  s_lshl_b32 s55, s3, 12
  v_mfma_f32_16x16x32_bf16 v[120:123], v[20:23], v[84:87], v[120:123]
  s_add_u32 s57, s63, s38
  s_add_u32 m0, s55, 0
  v_mfma_f32_16x16x32_bf16 v[124:127], v[24:27], v[84:87], v[124:127]
  ds_read_b128 v[84:87], v140 offset:2624
  s_waitcnt lgkmcnt(8)
  v_mfma_f32_16x16x32_bf16 v[120:123], v[16:19], v[88:91], v[120:123]
  v_mfma_f32_16x16x32_bf16 v[124:127], v[20:23], v[88:91], v[124:127]
  ds_read_b128 v[88:91], v140 offset:3136
  v_mfma_f32_16x16x32_bf16 v[124:127], v[16:19], v[92:95], v[124:127]
  ds_read_b128 v[92:95], v140 offset:3648
  s_waitcnt lgkmcnt(6)
  v_mfma_f32_16x16x32_bf16 v[112:115], v[32:35], v[96:99], v[112:115]
  v_mfma_f32_16x16x32_bf16 v[116:119], v[36:39], v[96:99], v[116:119]
  v_mfma_f32_16x16x32_bf16 v[120:123], v[40:43], v[96:99], v[120:123]
  v_bfe_u32 v18, v0, 2, 4
  v_lshlrev_b32 v19, 7, v18
  v_mfma_f32_16x16x32_bf16 v[124:127], v[44:47], v[96:99], v[124:127]
  ds_read_b128 v[96:99], v140 offset:2048
  v_and_b32 v20, 3, v0
  v_mfma_f32_16x16x32_bf16 v[116:119], v[32:35], v[100:103], v[116:119]
  v_lshl_add_u32 v19, v20, 3, v19
  v_bfe_u32 v18, v18, 1, 2
  v_mfma_f32_16x16x32_bf16 v[120:123], v[36:39], v[100:103], v[120:123]
  v_xor_b32 v18, s3, v18
  v_mfma_f32_16x16x32_bf16 v[124:127], v[40:43], v[100:103], v[124:127]
  ds_read_b128 v[100:103], v140 offset:2560
  v_mfma_f32_16x16x32_bf16 v[120:123], v[32:35], v[104:107], v[120:123]
  v_mfma_f32_16x16x32_bf16 v[124:127], v[36:39], v[104:107], v[124:127]
  ds_read_b128 v[104:107], v140 offset:3072
  v_mfma_f32_16x16x32_bf16 v[124:127], v[32:35], v[108:111], v[124:127]
  ds_read_b128 v[108:111], v140 offset:3584
  s_waitcnt lgkmcnt(7)
  v_mfma_f32_16x16x32_bf16 v[112:115], v[48:51], v[80:83], v[112:115]
  v_mfma_f32_16x16x32_bf16 v[116:119], v[52:55], v[80:83], v[116:119]
  v_mfma_f32_16x16x32_bf16 v[120:123], v[56:59], v[80:83], v[120:123]
  v_mfma_f32_16x16x32_bf16 v[124:127], v[60:63], v[80:83], v[124:127]
  s_waitcnt lgkmcnt(6)
  v_mfma_f32_16x16x32_bf16 v[116:119], v[48:51], v[84:87], v[116:119]
  v_mfma_f32_16x16x32_bf16 v[120:123], v[52:55], v[84:87], v[120:123]
  v_mfma_f32_16x16x32_bf16 v[124:127], v[56:59], v[84:87], v[124:127]
  s_waitcnt vmcnt(0)
  v_cmp_ne_u32 vcc, 0, v5
  s_waitcnt lgkmcnt(4)
  v_mfma_f32_16x16x32_bf16 v[120:123], v[48:51], v[88:91], v[120:123]
  s_cbranch_vccnz poll_14_s
poll_14_ok:
  s_barrier
  v_mfma_f32_16x16x32_bf16 v[124:127], v[52:55], v[88:91], v[124:127]
  buffer_load_dwordx4 v6, s[4:7], s57 offen offset:0 sc1 lds
  v_mfma_f32_16x16x32_bf16 v[124:127], v[48:51], v[92:95], v[124:127]
  s_waitcnt lgkmcnt(3)
  v_mfma_f32_16x16x32_bf16 v[112:115], v[64:67], v[96:99], v[112:115]
  buffer_load_dwordx4 v6, s[4:7], s57 offen offset:1024 sc1 lds
  v_mfma_f32_16x16x32_bf16 v[116:119], v[68:71], v[96:99], v[116:119]
  v_mfma_f32_16x16x32_bf16 v[120:123], v[72:75], v[96:99], v[120:123]
  buffer_load_dwordx4 v6, s[4:7], s57 offen offset:2048 sc1 lds
  v_mfma_f32_16x16x32_bf16 v[124:127], v[76:79], v[96:99], v[124:127]
  s_waitcnt lgkmcnt(2)
  v_mfma_f32_16x16x32_bf16 v[116:119], v[64:67], v[100:103], v[116:119]
  buffer_load_dwordx4 v6, s[4:7], s57 offen offset:3072 sc1 lds
  s_add_u32 m0, m0, 16384
  v_mfma_f32_16x16x32_bf16 v[120:123], v[68:71], v[100:103], v[120:123]
  s_xor_b32 s57, s57, 32768
  v_lshl_add_u32 v96, v18, 5, v19
  v_mfma_f32_16x16x32_bf16 v[124:127], v[72:75], v[100:103], v[124:127]
  buffer_load_dwordx4 v6, s[4:7], s57 offen offset:0 sc1 lds
  s_waitcnt lgkmcnt(0)
  v_mfma_f32_16x16x32_bf16 v[120:123], v[64:67], v[104:107], v[120:123]
  v_xor_b32 v97, 32, v96
  v_xor_b32 v98, 64, v96
  v_mfma_f32_16x16x32_bf16 v[124:127], v[68:71], v[104:107], v[124:127]
  buffer_load_dwordx4 v6, s[4:7], s57 offen offset:1024 sc1 lds
  v_mfma_f32_16x16x32_bf16 v[124:127], v[64:67], v[108:111], v[124:127]
  v_xor_b32 v99, 96, v96
  s_cmp_eq_u32 s52, 0
  s_nop 6
  s_cbranch_scc1 cx_15_0
  ds_write_b128 v14, v[112:115] offset:0
  ds_write_b128 v14, v[116:119] offset:1024
  v_pk_add_f32 v[132:133], v[132:133], v[120:121]
  v_pk_add_f32 v[134:135], v[134:135], v[122:123]
  v_pk_add_f32 v[136:137], v[136:137], v[124:125]
  v_pk_add_f32 v[138:139], v[138:139], v[126:127]
  s_branch cx_15_1
cx_15_0:
  ds_write_b128 v14, v[120:123] offset:0
  ds_write_b128 v14, v[124:127] offset:1024
  v_pk_add_f32 v[132:133], v[132:133], v[112:113]
  v_pk_add_f32 v[134:135], v[134:135], v[114:115]
  v_pk_add_f32 v[136:137], v[136:137], v[116:117]
  v_pk_add_f32 v[138:139], v[138:139], v[118:119]
cx_15_1:
  s_waitcnt lgkmcnt(0)
  s_barrier
  ds_read_b128 v[128:131], v142
  ds_read_b128 v[8:11], v142 offset:1024
  buffer_load_dwordx4 v6, s[4:7], s57 offen offset:2048 sc1 lds
  buffer_load_dwordx4 v6, s[4:7], s57 offen offset:3072 sc1 lds
  s_add_u32 m0, m0, 16384
  s_xor_b32 s57, s57, 98304
  buffer_load_dwordx4 v6, s[4:7], s57 offen offset:0 sc1 lds
  buffer_load_dwordx4 v6, s[4:7], s57 offen offset:1024 sc1 lds
  buffer_load_dwordx4 v6, s[4:7], s57 offen offset:2048 sc1 lds
  buffer_load_dwordx4 v6, s[4:7], s57 offen offset:3072 sc1 lds
  s_add_u32 m0, m0, 16384
  s_xor_b32 s57, s57, 32768
  s_waitcnt lgkmcnt(0)
  v_pk_add_f32 v[132:133], v[132:133], v[128:129]
  v_pk_add_f32 v[136:137], v[136:137], v[8:9]
  v_pk_add_f32 v[134:135], v[134:135], v[130:131]
  v_pk_add_f32 v[138:139], v[138:139], v[10:11]
  v_cvt_pk_bf16_f32 v8, v132, v133
  v_cvt_pk_bf16_f32 v10, v136, v137
  v_cvt_pk_bf16_f32 v9, v134, v135
  v_cvt_pk_bf16_f32 v11, v138, v139
  v_permlane16_swap_b32 v8, v10
  s_nop 0
  v_permlane16_swap_b32 v9, v11
  buffer_store_dwordx4 v[8:11], v15, s[4:7], s29 offen sc1
  s_add_u32 s28, s40, 65536
  s_waitcnt vmcnt(9)
  s_barrier
  ds_read_b64_tr_b16 v[72:73], v96 offset:0
  ds_read_b64_tr_b16 v[74:75], v96 offset:2048
  ds_read_b64_tr_b16 v[76:77], v97 offset:0
  ds_read_b64_tr_b16 v[78:79], v97 offset:2048
  ds_read_b64_tr_b16 v[80:81], v96 offset:4096
  ds_read_b64_tr_b16 v[82:83], v96 offset:6144
  ds_read_b64_tr_b16 v[84:85], v97 offset:4096
  ds_read_b64_tr_b16 v[86:87], v97 offset:6144
  s_waitcnt lgkmcnt(4)
  v_mfma_f32_16x16x32_bf16 v[16:19], a[0:3], v[72:75], 0
  ds_read_b64_tr_b16 v[88:89], v96 offset:8192
  v_and_b32 v128, 15, v0
  v_mfma_f32_16x16x32_bf16 v[20:23], a[64:67], v[72:75], 0
  ds_read_b64_tr_b16 v[90:91], v96 offset:10240
  buffer_load_dwordx4 v6, s[4:7], s57 offen offset:0 sc1 lds
  v_mfma_f32_16x16x32_bf16 v[24:27], a[128:131], v[72:75], 0
  ds_read_b64_tr_b16 v[92:93], v97 offset:8192
  v_bfe_u32 v129, v0, 4, 2
  v_mfma_f32_16x16x32_bf16 v[28:31], a[0:3], v[76:79], 0
  ds_read_b64_tr_b16 v[94:95], v97 offset:10240
  s_mul_i32 s51, s3, 128
  v_mfma_f32_16x16x32_bf16 v[32:35], a[64:67], v[76:79], 0
  buffer_load_dwordx4 v6, s[4:7], s57 offen offset:1024 sc1 lds
  v_mfma_f32_16x16x32_bf16 v[36:39], a[128:131], v[76:79], 0
  s_add_u32 s51, s51, 156928
  s_waitcnt lgkmcnt(4)
  v_mfma_f32_16x16x32_bf16 v[16:19], a[4:7], v[80:83], v[16:19]
  ds_read_b64_tr_b16 v[72:73], v96 offset:12288
  v_lshl_add_u32 v131, v0, 2, s51
  v_mfma_f32_16x16x32_bf16 v[20:23], a[68:71], v[80:83], v[20:23]
  ds_read_b64_tr_b16 v[74:75], v96 offset:14336
  v_mfma_f32_16x16x32_bf16 v[24:27], a[132:135], v[80:83], v[24:27]
  ds_read_b64_tr_b16 v[76:77], v97 offset:12288
  v_mfma_f32_16x16x32_bf16 v[28:31], a[4:7], v[84:87], v[28:31]
  ds_read_b64_tr_b16 v[78:79], v97 offset:14336
  v_and_b32 v70, 63, v0
  v_mfma_f32_16x16x32_bf16 v[32:35], a[68:71], v[84:87], v[32:35]
  s_waitcnt vmcnt(7)
  s_barrier
  v_mfma_f32_16x16x32_bf16 v[36:39], a[132:135], v[84:87], v[36:39]
  buffer_load_dwordx4 v6, s[4:7], s57 offen offset:2048 sc1 lds
  s_waitcnt lgkmcnt(4)
  v_mfma_f32_16x16x32_bf16 v[16:19], a[8:11], v[88:91], v[16:19]
  ds_read_b64_tr_b16 v[80:81], v96 offset:16384
  v_lshrrev_b32 v71, 5, v0
  v_mfma_f32_16x16x32_bf16 v[20:23], a[72:75], v[88:91], v[20:23]
  ds_read_b64_tr_b16 v[82:83], v96 offset:18432
  v_lshlrev_b32 v70, 4, v70
  v_mfma_f32_16x16x32_bf16 v[24:27], a[136:139], v[88:91], v[24:27]
  ds_read_b64_tr_b16 v[84:85], v97 offset:16384
  buffer_load_dwordx4 v6, s[4:7], s57 offen offset:3072 sc1 lds
  v_mfma_f32_16x16x32_bf16 v[28:31], a[8:11], v[92:95], v[28:31]
  ds_read_b64_tr_b16 v[86:87], v97 offset:18432
  v_min_u32 v71, 1, v71
  v_mfma_f32_16x16x32_bf16 v[32:35], a[72:75], v[92:95], v[32:35]
  ds_read2_b32 v[104:105], v131 offset1:16
  v_add_u32 v70, 159744, v70
  v_mfma_f32_16x16x32_bf16 v[36:39], a[136:139], v[92:95], v[36:39]
  ds_read_b32 v106, v131 offset:128
  s_waitcnt lgkmcnt(6)
  v_mfma_f32_16x16x32_bf16 v[16:19], a[12:15], v[72:75], v[16:19]
  ds_read_b64_tr_b16 v[88:89], v96 offset:20480
  s_lshl_b32 s51, s3, 7
  v_mfma_f32_16x16x32_bf16 v[20:23], a[76:79], v[72:75], v[20:23]
  ds_read_b64_tr_b16 v[90:91], v96 offset:22528
  s_add_u32 s51, s51, 161792
  v_mfma_f32_16x16x32_bf16 v[24:27], a[140:143], v[72:75], v[24:27]
  ds_read_b64_tr_b16 v[92:93], v97 offset:20480
  v_xor_b32 v130, s3, v129
  v_mfma_f32_16x16x32_bf16 v[28:31], a[12:15], v[76:79], v[28:31]
  ds_read_b64_tr_b16 v[94:95], v97 offset:22528
  v_lshl_add_u32 v100, v128, 3, s51
  v_mfma_f32_16x16x32_bf16 v[32:35], a[76:79], v[76:79], v[32:35]
  v_add_u32 v132, 1, v129
  v_lshl_add_u32 v100, v129, 7, v100
  v_mfma_f32_16x16x32_bf16 v[36:39], a[140:143], v[76:79], v[36:39]
  v_lshrrev_b32 v132, 2, v132
  s_waitcnt lgkmcnt(6)
  v_mfma_f32_16x16x32_bf16 v[16:19], a[16:19], v[80:83], v[16:19]
  ds_read_b64_tr_b16 v[72:73], v96 offset:24576
  s_mul_i32 s54, s35, 132
  v_mfma_f32_16x16x32_bf16 v[20:23], a[80:83], v[80:83], v[20:23]
  ds_read_b64_tr_b16 v[74:75], v96 offset:26624
  v_lshl_add_u32 v71, v71, 31, v70
  v_mfma_f32_16x16x32_bf16 v[24:27], a[144:147], v[80:83], v[24:27]
  ds_read_b64_tr_b16 v[76:77], v97 offset:24576
  s_and_b32 s54, s54, 0x20c
  v_mfma_f32_16x16x32_bf16 v[28:31], a[16:19], v[84:87], v[28:31]
  ds_read_b64_tr_b16 v[78:79], v97 offset:26624
  v_lshl_add_u32 v101, s3, 2, v70
  v_mfma_f32_16x16x32_bf16 v[32:35], a[80:83], v[84:87], v[32:35]
  s_bitcmp1_b32 s3, 0
  s_cselect_b32 s51, -3584, 0
  s_cselect_b32 s52, 31, 3
  v_mfma_f32_16x16x32_bf16 v[36:39], a[144:147], v[84:87], v[36:39]
  v_lshlrev_b32 v128, 4, v128
  s_waitcnt lgkmcnt(4)
  v_mfma_f32_16x16x32_bf16 v[16:19], a[20:23], v[88:91], v[16:19]
  ds_read_b64_tr_b16 v[80:81], v96 offset:28672
  v_and_b32 v133, 1, v130
  v_mfma_f32_16x16x32_bf16 v[20:23], a[84:87], v[88:91], v[20:23]
  ds_read_b64_tr_b16 v[82:83], v96 offset:30720
  v_lshl_add_u32 v7, v129, 9, v128
  v_mfma_f32_16x16x32_bf16 v[24:27], a[148:151], v[88:91], v[24:27]
  ds_read_b64_tr_b16 v[84:85], v97 offset:28672
  v_lshl_add_u32 v133, v133, 8, v128
  v_mfma_f32_16x16x32_bf16 v[28:31], a[20:23], v[92:95], v[28:31]
  ds_read_b64_tr_b16 v[86:87], v97 offset:30720
  v_lshrrev_b32 v130, 1, v129
  v_mfma_f32_16x16x32_bf16 v[32:35], a[84:87], v[92:95], v[32:35]
  s_waitcnt vmcnt(5)
  s_barrier
  v_mfma_f32_16x16x32_bf16 v[36:39], a[148:151], v[92:95], v[36:39]
  v_add_u32 v133, 8388608, v133
  s_waitcnt lgkmcnt(4)
  v_mfma_f32_16x16x32_bf16 v[16:19], a[24:27], v[72:75], v[16:19]
  ds_read_b64_tr_b16 v[88:89], v96 offset:32768
  v_lshl_add_u32 v140, v130, 9, v133
  v_mfma_f32_16x16x32_bf16 v[20:23], a[88:91], v[72:75], v[20:23]
  ds_read_b64_tr_b16 v[90:91], v96 offset:34816
  v_lshl_add_u32 v141, v130, s52, v133
  v_mfma_f32_16x16x32_bf16 v[24:27], a[152:155], v[72:75], v[24:27]
  ds_read_b64_tr_b16 v[92:93], v97 offset:32768
  v_mad_i32_i24 v100, v132, s51, v100
  v_mfma_f32_16x16x32_bf16 v[28:31], a[24:27], v[76:79], v[28:31]
  ds_read_b64_tr_b16 v[94:95], v97 offset:34816
  v_and_b32 v128, 15, v0
  v_mfma_f32_16x16x32_bf16 v[32:35], a[88:91], v[76:79], v[32:35]
  s_lshl_b32 s51, s3, 7
  s_add_u32 s51, s51, 158720
  v_mfma_f32_16x16x32_bf16 v[36:39], a[152:155], v[76:79], v[36:39]
  v_lshl_add_u32 v128, v128, 3, s51
  s_waitcnt lgkmcnt(4)
  v_mfma_f32_16x16x32_bf16 v[16:19], a[28:31], v[80:83], v[16:19]
  ds_read_b64_tr_b16 v[72:73], v96 offset:36864
  v_bfe_u32 v102, v0, 4, 2
  v_mfma_f32_16x16x32_bf16 v[20:23], a[92:95], v[80:83], v[20:23]
  ds_read_b64_tr_b16 v[74:75], v96 offset:38912
  v_mul_u32_u24 v102, 43, v102
  v_mfma_f32_16x16x32_bf16 v[24:27], a[156:159], v[80:83], v[24:27]
  ds_read_b64_tr_b16 v[76:77], v97 offset:36864
  v_add_u32 v103, 172, v102
  v_mfma_f32_16x16x32_bf16 v[28:31], a[28:31], v[84:87], v[28:31]
  ds_read_b64_tr_b16 v[78:79], v97 offset:38912
  s_waitcnt vmcnt(4)
  s_barrier
  v_mfma_f32_16x16x32_bf16 v[32:35], a[92:95], v[84:87], v[32:35]
  buffer_atomic_sub v4, v1, s[4:7], s28 offen sc1
  v_mfma_f32_16x16x32_bf16 v[36:39], a[156:159], v[84:87], v[36:39]
  v_add_u32 v119, 344, v102
  s_waitcnt lgkmcnt(4)
  v_mfma_f32_16x16x32_bf16 v[16:19], a[32:35], v[88:91], v[16:19]
  ds_read_b64_tr_b16 v[80:81], v96 offset:40960
  v_and_b32 v102, 0x180, v102
  v_mfma_f32_16x16x32_bf16 v[20:23], a[96:99], v[88:91], v[20:23]
  ds_read_b64_tr_b16 v[82:83], v96 offset:43008
  v_and_b32 v103, 0x180, v103
  v_mfma_f32_16x16x32_bf16 v[24:27], a[160:163], v[88:91], v[24:27]
  ds_read_b64_tr_b16 v[84:85], v97 offset:40960
  v_and_b32 v119, 0x180, v119
  v_mfma_f32_16x16x32_bf16 v[28:31], a[32:35], v[92:95], v[28:31]
  ds_read_b64_tr_b16 v[86:87], v97 offset:43008
  v_xor_b32 v102, v128, v102
  v_mfma_f32_16x16x32_bf16 v[32:35], a[96:99], v[92:95], v[32:35]
  v_xor_b32 v103, v128, v103
  v_xor_b32 v119, v128, v119
  v_mfma_f32_16x16x32_bf16 v[36:39], a[160:163], v[92:95], v[36:39]
  v_bfe_u32 v133, v0, 2, 4
  s_waitcnt lgkmcnt(4)
  v_mfma_f32_16x16x32_bf16 v[16:19], a[36:39], v[72:75], v[16:19]
  ds_read_b64_tr_b16 v[88:89], v96 offset:45056
  s_lshl_b32 s51, s35, 13
  v_mfma_f32_16x16x32_bf16 v[20:23], a[100:103], v[72:75], v[20:23]
  ds_read_b64_tr_b16 v[90:91], v96 offset:47104
  s_lshl_b32 s52, s3, 11
  v_mfma_f32_16x16x32_bf16 v[24:27], a[164:167], v[72:75], v[24:27]
  ds_read_b64_tr_b16 v[92:93], v97 offset:45056
  s_add_u32 s51, s51, s52
  v_mfma_f32_16x16x32_bf16 v[28:31], a[36:39], v[76:79], v[28:31]
  ds_read_b64_tr_b16 v[94:95], v97 offset:47104
  s_add_u32 s51, s51, 0
  v_mfma_f32_16x16x32_bf16 v[32:35], a[100:103], v[76:79], v[32:35]
  s_waitcnt vmcnt(1)
  s_barrier
  v_mfma_f32_16x16x32_bf16 v[36:39], a[164:167], v[76:79], v[36:39]
  s_lshl_b32 s52, s34, 1
  s_waitcnt lgkmcnt(4)
  v_mfma_f32_16x16x32_bf16 v[16:19], a[40:43], v[80:83], v[16:19]
  ds_read_b64_tr_b16 v[72:73], v96 offset:49152
  v_lshl_add_u32 v134, v133, 7, s51
  v_mfma_f32_16x16x32_bf16 v[20:23], a[104:107], v[80:83], v[20:23]
  ds_read_b64_tr_b16 v[74:75], v96 offset:51200
  v_bfe_u32 v133, v133, 1, 2
  v_mfma_f32_16x16x32_bf16 v[24:27], a[168:171], v[80:83], v[24:27]
  ds_read_b64_tr_b16 v[76:77], v97 offset:49152
  v_and_b32 v135, 3, v0
  v_mfma_f32_16x16x32_bf16 v[28:31], a[40:43], v[84:87], v[28:31]
  ds_read_b64_tr_b16 v[78:79], v97 offset:51200
  v_add_u32 v71, s54, v71
  v_mfma_f32_16x16x32_bf16 v[32:35], a[104:107], v[84:87], v[32:35]
  v_mov_b32 v124, -1
  v_mov_b32 v125, -1
  v_mfma_f32_16x16x32_bf16 v[36:39], a[168:171], v[84:87], v[36:39]
  v_mov_b32 v126, -1
  s_waitcnt lgkmcnt(4)
  v_mfma_f32_16x16x32_bf16 v[16:19], a[44:47], v[88:91], v[16:19]
  ds_read_b64_tr_b16 v[80:81], v96 offset:53248
  v_mov_b32 v127, -1
  v_mfma_f32_16x16x32_bf16 v[20:23], a[108:111], v[88:91], v[20:23]
  ds_read_b64_tr_b16 v[82:83], v96 offset:55296
  v_xor_b32 v133, s52, v133
  v_mfma_f32_16x16x32_bf16 v[24:27], a[172:175], v[88:91], v[24:27]
  ds_read_b64_tr_b16 v[84:85], v97 offset:53248
  s_add_u32 s53, s100, 4194304
  v_mfma_f32_16x16x32_bf16 v[28:31], a[44:47], v[92:95], v[28:31]
  ds_read_b64_tr_b16 v[86:87], v97 offset:55296
  v_lshl_add_u32 v134, v135, 3, v134
  v_mfma_f32_16x16x32_bf16 v[32:35], a[108:111], v[92:95], v[32:35]
  buffer_store_dwordx4 v[124:127], v140, s[4:7], s53 offen sc1
  s_add_u32 s53, s62, 4194304
  v_mfma_f32_16x16x32_bf16 v[36:39], a[172:175], v[92:95], v[36:39]
  v_lshl_add_u32 v134, v133, 5, v134
  v_xor_b32 v133, 32, v134
  s_waitcnt lgkmcnt(4)
  v_mfma_f32_16x16x32_bf16 v[16:19], a[48:51], v[72:75], v[16:19]
  ds_read_b64_tr_b16 v[88:89], v96 offset:57344
  v_mfma_f32_16x16x32_bf16 v[20:23], a[112:115], v[72:75], v[20:23]
  ds_read_b64_tr_b16 v[90:91], v96 offset:59392
  ds_read_b64_tr_b16 v[8:9], v134
  v_mfma_f32_16x16x32_bf16 v[24:27], a[176:179], v[72:75], v[24:27]
  ds_read_b64_tr_b16 v[92:93], v97 offset:57344
  v_mfma_f32_16x16x32_bf16 v[28:31], a[48:51], v[76:79], v[28:31]
  ds_read_b64_tr_b16 v[94:95], v97 offset:59392
  v_mfma_f32_16x16x32_bf16 v[32:35], a[112:115], v[76:79], v[32:35]
  buffer_store_dwordx4 v[124:127], v140, s[4:7], s53 offen sc1
  s_add_u32 s53, s101, 4194304
  v_mfma_f32_16x16x32_bf16 v[36:39], a[176:179], v[76:79], v[36:39]
  ds_read_b64_tr_b16 v[10:11], v133
  s_waitcnt lgkmcnt(0)
  v_mfma_f32_16x16x32_bf16 v[16:19], a[52:55], v[80:83], v[16:19]
  ds_read_b64_tr_b16 v[72:73], v96 offset:61440
  v_dot2_f32_bf16 v68, v8, v8, 0
  v_mfma_f32_16x16x32_bf16 v[20:23], a[116:119], v[80:83], v[20:23]
  ds_read_b64_tr_b16 v[74:75], v96 offset:63488
  v_dot2_f32_bf16 v69, v10, v10, 0
  v_mfma_f32_16x16x32_bf16 v[24:27], a[180:183], v[80:83], v[24:27]
  ds_read_b64_tr_b16 v[76:77], v97 offset:61440
  v_dot2_f32_bf16 v68, v9, v9, v68
  v_mfma_f32_16x16x32_bf16 v[28:31], a[52:55], v[84:87], v[28:31]
  ds_read_b64_tr_b16 v[78:79], v97 offset:63488
  v_dot2_f32_bf16 v69, v11, v11, v69
  v_mfma_f32_16x16x32_bf16 v[32:35], a[116:119], v[84:87], v[32:35]
  buffer_store_dwordx2 v[124:125], v141, s[4:7], s53 offen sc1
  s_add_u32 s53, s31, 4194304
  v_mfma_f32_16x16x32_bf16 v[36:39], a[180:183], v[84:87], v[36:39]
  v_permlane16_swap_b32 v68, v69
  v_mfma_f32_16x16x32_bf16 v[16:19], a[56:59], v[88:91], v[16:19]
  ds_read_b64_tr_b16 v[80:81], v98 offset:0
  v_add_f32 v68, v68, v69
  v_mfma_f32_16x16x32_bf16 v[20:23], a[120:123], v[88:91], v[20:23]
  ds_read_b64_tr_b16 v[82:83], v98 offset:2048
  v_mfma_f32_16x16x32_bf16 v[24:27], a[184:187], v[88:91], v[24:27]
  ds_read_b64_tr_b16 v[84:85], v99 offset:0
  v_mfma_f32_16x16x32_bf16 v[28:31], a[56:59], v[92:95], v[28:31]
  ds_read_b64_tr_b16 v[86:87], v99 offset:2048
  v_mfma_f32_16x16x32_bf16 v[32:35], a[120:123], v[92:95], v[32:35]
  buffer_store_dwordx2 v[124:125], v141, s[4:7], s53 offen sc1
  v_mfma_f32_16x16x32_bf16 v[36:39], a[184:187], v[92:95], v[36:39]
  ds_write_b32 v101, v68
  s_waitcnt lgkmcnt(5)
  v_mfma_f32_16x16x32_bf16 v[24:27], a[188:191], v[72:75], v[24:27]
  ds_read_b64_tr_b16 v[88:89], v98 offset:4096
  v_xor_b32 v96, 0x10000, v96
  v_mfma_f32_16x16x32_bf16 v[36:39], a[188:191], v[76:79], v[36:39]
  ds_read_b64_tr_b16 v[90:91], v98 offset:6144
  v_xor_b32 v97, 0x10000, v97
  v_mfma_f32_16x16x32_bf16 v[16:19], a[60:63], v[72:75], v[16:19]
  ds_read_b64_tr_b16 v[92:93], v99 offset:4096
  v_mfma_f32_16x16x32_bf16 v[20:23], a[124:127], v[72:75], v[20:23]
  ds_read_b64_tr_b16 v[94:95], v99 offset:6144
  v_mul_f32 v65, s46, v24
  s_nop 0
  v_mul_f32 v67, s46, v36
  v_mfma_f32_16x16x32_bf16 v[28:31], a[60:63], v[76:79], v[28:31]
  v_cvt_pk_bf16_f32 v64, 0, -v65
  v_cvt_pk_bf16_f32 v66, 0, -v67
  v_mfma_f32_16x16x32_bf16 v[32:35], a[124:127], v[76:79], v[32:35]
  ds_write2_b64 v100, v[66:67], v[64:65] offset0:0 offset1:16
  s_waitcnt lgkmcnt(6)
  v_mfma_f32_16x16x32_bf16 v[40:43], a[0:3], v[80:83], 0
wpad_0_7:
  s_cbranch_execz wret_0
  ds_read_b64_tr_b16 v[72:73], v98 offset:8192
  v_mfma_f32_16x16x32_bf16 v[44:47], a[64:67], v[80:83], 0
  ds_read_b64_tr_b16 v[74:75], v98 offset:10240
  v_mfma_f32_16x16x32_bf16 v[48:51], a[128:131], v[80:83], 0
  ds_read_b64_tr_b16 v[76:77], v99 offset:8192
  v_mfma_f32_16x16x32_bf16 v[52:55], a[0:3], v[84:87], 0
  ds_read_b64_tr_b16 v[78:79], v99 offset:10240
  v_mfma_f32_16x16x32_bf16 v[56:59], a[64:67], v[84:87], 0
  s_waitcnt lgkmcnt(4)
  s_barrier
  v_mfma_f32_16x16x32_bf16 v[60:63], a[128:131], v[84:87], 0
  ds_read_b32 v118, v119 offset:0
  v_mfma_f32_16x16x32_bf16 v[40:43], a[4:7], v[88:91], v[40:43]
  ds_read_b64_tr_b16 v[80:81], v98 offset:12288
  ds_read_b32 v116, v102 offset:0
  v_mfma_f32_16x16x32_bf16 v[44:47], a[68:71], v[88:91], v[44:47]
  ds_read_b64_tr_b16 v[82:83], v98 offset:14336
  ds_read_b32 v117, v103 offset:0
  v_mfma_f32_16x16x32_bf16 v[48:51], a[132:135], v[88:91], v[48:51]
  ds_read_b64_tr_b16 v[84:85], v99 offset:12288
  s_lshl_b32 s55, s3, 12
  v_mfma_f32_16x16x32_bf16 v[52:55], a[4:7], v[92:95], v[52:55]
  ds_read_b64_tr_b16 v[86:87], v99 offset:14336
  ds_read_b128 v[64:67], v70
  v_mfma_f32_16x16x32_bf16 v[56:59], a[68:71], v[92:95], v[56:59]
  v_mov_b32 v5, 0
  buffer_atomic_add v5, v3, s[4:7], s28 offen sc0 sc1
  v_mfma_f32_16x16x32_bf16 v[60:63], a[132:135], v[92:95], v[60:63]
  s_add_u32 s57, s63, s38
  s_waitcnt lgkmcnt(8)
  v_mfma_f32_16x16x32_bf16 v[40:43], a[8:11], v[72:75], v[40:43]
  ds_read_b64_tr_b16 v[88:89], v98 offset:16384
  s_add_u32 s57, s57, 1048576
  v_mfma_f32_16x16x32_bf16 v[44:47], a[72:75], v[72:75], v[44:47]
  ds_read_b64_tr_b16 v[90:91], v98 offset:18432
  s_add_u32 m0, s55, 65536
  v_mfma_f32_16x16x32_bf16 v[48:51], a[136:139], v[72:75], v[48:51]
  ds_read_b64_tr_b16 v[92:93], v99 offset:16384
  s_waitcnt lgkmcnt(3)
  v_add_f32 v64, v64, v65
  v_add_f32 v66, v66, v67
  v_mfma_f32_16x16x32_bf16 v[52:55], a[8:11], v[76:79], v[52:55]
  ds_read_b64_tr_b16 v[94:95], v99 offset:18432
  v_add_f32 v65, v64, v66
  v_add_f32 v64, v64, v66
  v_mfma_f32_16x16x32_bf16 v[56:59], a[72:75], v[76:79], v[56:59]
  s_nop 0
  v_permlane32_swap_b32 v64, v65
  v_add_f32 v68, v64, v65
  v_mfma_f32_16x16x32_bf16 v[60:63], a[136:139], v[76:79], v[60:63]
  v_mfma_f32_16x16x32_bf16 v[40:43], a[12:15], v[80:83], v[40:43]
  ds_read_b64_tr_b16 v[72:73], v98 offset:20480
  v_mfma_f32_16x16x32_bf16 v[44:47], a[76:79], v[80:83], v[44:47]
  ds_read_b64_tr_b16 v[74:75], v98 offset:22528
  v_mfma_f32_16x16x1_4b_f32 v[16:31], v104, v116, v[16:31]
  v_mfma_f32_16x16x32_bf16 v[48:51], a[140:143], v[80:83], v[48:51]
  ds_read_b64_tr_b16 v[76:77], v99 offset:20480
  v_mfma_f32_16x16x32_bf16 v[52:55], a[12:15], v[84:87], v[52:55]
  ds_read_b64_tr_b16 v[78:79], v99 offset:22528
  v_mfma_f32_16x16x1_4b_f32 v[32:47], v105, v117, v[32:47]
  v_mfma_f32_16x16x32_bf16 v[56:59], a[76:79], v[84:87], v[56:59]
  v_mfma_f32_16x16x32_bf16 v[60:63], a[140:143], v[84:87], v[60:63]
  s_waitcnt lgkmcnt(4)
  v_mfma_f32_16x16x32_bf16 v[40:43], a[16:19], v[88:91], v[40:43]
  ds_read_b64_tr_b16 v[80:81], v98 offset:24576
  buffer_store_dword v68, v71, s[4:7], s30 offen offset:0 sc1
  v_mfma_f32_16x16x32_bf16 v[44:47], a[80:83], v[88:91], v[44:47]
  ds_read_b64_tr_b16 v[82:83], v98 offset:26624
  v_mul_f32 v16, v16, v20
  v_mfma_f32_16x16x32_bf16 v[48:51], a[144:147], v[88:91], v[48:51]
  ds_read_b64_tr_b16 v[84:85], v99 offset:24576
  v_mul_f32 v17, v17, v21
  v_mfma_f32_16x16x32_bf16 v[52:55], a[16:19], v[92:95], v[52:55]
  ds_read_b64_tr_b16 v[86:87], v99 offset:26624
  v_mul_f32 v18, v18, v22
  v_mfma_f32_16x16x32_bf16 v[56:59], a[80:83], v[92:95], v[56:59]
  v_mul_f32 v19, v19, v23
  v_mul_f32 v28, v28, v32
  v_mfma_f32_16x16x32_bf16 v[60:63], a[144:147], v[92:95], v[60:63]
  v_mul_f32 v29, v29, v33
  s_waitcnt lgkmcnt(4)
  v_mfma_f32_16x16x32_bf16 v[40:43], a[20:23], v[72:75], v[40:43]
  ds_read_b64_tr_b16 v[88:89], v98 offset:28672
  v_mul_f32 v30, v30, v34
  v_mfma_f32_16x16x32_bf16 v[44:47], a[84:87], v[72:75], v[44:47]
  ds_read_b64_tr_b16 v[90:91], v98 offset:30720
  v_mul_f32 v31, v31, v35
  v_mfma_f32_16x16x32_bf16 v[48:51], a[148:151], v[72:75], v[48:51]
  ds_read_b64_tr_b16 v[92:93], v99 offset:28672
  v_cvt_pk_bf16_f32 v124, v16, v17
  v_mfma_f32_16x16x32_bf16 v[52:55], a[20:23], v[76:79], v[52:55]
  ds_read_b64_tr_b16 v[94:95], v99 offset:30720
  v_cvt_pk_bf16_f32 v125, v18, v19
  v_mfma_f32_16x16x32_bf16 v[56:59], a[84:87], v[76:79], v[56:59]
  v_cvt_pk_bf16_f32 v126, v28, v29
  v_cvt_pk_bf16_f32 v127, v30, v31
  v_mfma_f32_16x16x32_bf16 v[60:63], a[148:151], v[76:79], v[60:63]
  s_waitcnt lgkmcnt(4)
  v_mfma_f32_16x16x32_bf16 v[40:43], a[24:27], v[80:83], v[40:43]
  ds_read_b64_tr_b16 v[72:73], v98 offset:32768
  v_mfma_f32_16x16x32_bf16 v[44:47], a[88:91], v[80:83], v[44:47]
  ds_read_b64_tr_b16 v[74:75], v98 offset:34816
  v_mfma_f32_16x16x32_bf16 v[48:51], a[152:155], v[80:83], v[48:51]
  ds_read_b64_tr_b16 v[76:77], v99 offset:32768
  v_mfma_f32_16x16x32_bf16 v[52:55], a[24:27], v[84:87], v[52:55]
  ds_read_b64_tr_b16 v[78:79], v99 offset:34816
  v_mfma_f32_16x16x32_bf16 v[56:59], a[88:91], v[84:87], v[56:59]
  v_permlane16_swap_b32 v124, v126
  v_mfma_f32_16x16x32_bf16 v[60:63], a[152:155], v[84:87], v[60:63]
  s_waitcnt lgkmcnt(4)
  v_mfma_f32_16x16x32_bf16 v[40:43], a[28:31], v[88:91], v[40:43]
  ds_read_b64_tr_b16 v[80:81], v98 offset:36864
  s_waitcnt vmcnt(1)
  v_cmp_ne_u32 vcc, 0, v5
  v_mfma_f32_16x16x32_bf16 v[44:47], a[92:95], v[88:91], v[44:47]
  ds_read_b64_tr_b16 v[82:83], v98 offset:38912
  s_cbranch_vccnz poll_16_s
poll_16_ok:
  s_barrier
  v_mfma_f32_16x16x32_bf16 v[48:51], a[156:159], v[88:91], v[48:51]
  ds_read_b64_tr_b16 v[84:85], v99 offset:36864
  buffer_load_dwordx4 v6, s[4:7], s57 offen offset:0 sc1 lds
  v_mfma_f32_16x16x32_bf16 v[52:55], a[28:31], v[92:95], v[52:55]
  ds_read_b64_tr_b16 v[86:87], v99 offset:38912
  buffer_load_dwordx4 v6, s[4:7], s57 offen offset:1024 sc1 lds
  v_mfma_f32_16x16x32_bf16 v[56:59], a[92:95], v[92:95], v[56:59]
  buffer_load_dwordx4 v6, s[4:7], s57 offen offset:2048 sc1 lds
  v_mfma_f32_16x16x32_bf16 v[60:63], a[156:159], v[92:95], v[60:63]
  s_waitcnt lgkmcnt(4)
  v_mfma_f32_16x16x32_bf16 v[40:43], a[32:35], v[72:75], v[40:43]
  ds_read_b64_tr_b16 v[88:89], v98 offset:40960
  buffer_load_dwordx4 v6, s[4:7], s57 offen offset:3072 sc1 lds
  v_mfma_f32_16x16x32_bf16 v[44:47], a[96:99], v[72:75], v[44:47]
  ds_read_b64_tr_b16 v[90:91], v98 offset:43008
  v_permlane16_swap_b32 v125, v127
  v_mfma_f32_16x16x32_bf16 v[48:51], a[160:163], v[72:75], v[48:51]
  ds_read_b64_tr_b16 v[92:93], v99 offset:40960
  s_add_u32 m0, m0, 16384
  s_xor_b32 s57, s57, 32768
  v_mfma_f32_16x16x32_bf16 v[52:55], a[32:35], v[76:79], v[52:55]
  ds_read_b64_tr_b16 v[94:95], v99 offset:43008
  buffer_load_dwordx4 v6, s[4:7], s57 offen offset:0 sc1 lds
  v_mfma_f32_16x16x32_bf16 v[56:59], a[96:99], v[76:79], v[56:59]
  buffer_load_dwordx4 v6, s[4:7], s57 offen offset:1024 sc1 lds
  v_mfma_f32_16x16x32_bf16 v[60:63], a[160:163], v[76:79], v[60:63]
  s_waitcnt lgkmcnt(4)
  v_mfma_f32_16x16x32_bf16 v[40:43], a[36:39], v[80:83], v[40:43]
  ds_read_b64_tr_b16 v[72:73], v98 offset:45056
  buffer_load_dwordx4 v6, s[4:7], s57 offen offset:2048 sc1 lds
  v_mfma_f32_16x16x32_bf16 v[44:47], a[100:103], v[80:83], v[44:47]
  ds_read_b64_tr_b16 v[74:75], v98 offset:47104
  v_mfma_f32_16x16x1_4b_f32 v[48:63], v106, v118, v[48:63]
  v_mfma_f32_16x16x32_bf16 v[48:51], a[164:167], v[80:83], v[48:51]
  ds_read_b64_tr_b16 v[76:77], v99 offset:45056
  buffer_load_dwordx4 v6, s[4:7], s57 offen offset:3072 sc1 lds
  v_mfma_f32_16x16x32_bf16 v[52:55], a[36:39], v[84:87], v[52:55]
  ds_read_b64_tr_b16 v[78:79], v99 offset:47104
  buffer_store_dwordx4 v[124:127], v140, s[4:7], s100 offen sc1
  v_mfma_f32_16x16x32_bf16 v[56:59], a[100:103], v[84:87], v[56:59]
  v_permlane16_swap_b32 v24, v36
  s_add_u32 m0, m0, 16384
  v_mfma_f32_16x16x32_bf16 v[60:63], a[164:167], v[84:87], v[60:63]
  s_xor_b32 s57, s57, 98304
  s_waitcnt lgkmcnt(4)
  v_mfma_f32_16x16x32_bf16 v[40:43], a[40:43], v[88:91], v[40:43]
  ds_read_b64_tr_b16 v[80:81], v98 offset:49152
  v_mfma_f32_16x16x32_bf16 v[44:47], a[104:107], v[88:91], v[44:47]
  ds_read_b64_tr_b16 v[82:83], v98 offset:51200
  v_permlane16_swap_b32 v25, v37
  v_mfma_f32_16x16x32_bf16 v[48:51], a[168:171], v[88:91], v[48:51]
  ds_read_b64_tr_b16 v[84:85], v99 offset:49152
  buffer_load_dwordx4 v6, s[4:7], s57 offen offset:0 sc1 lds
  v_mfma_f32_16x16x32_bf16 v[52:55], a[40:43], v[92:95], v[52:55]
  ds_read_b64_tr_b16 v[86:87], v99 offset:51200
  v_mfma_f32_16x16x32_bf16 v[56:59], a[104:107], v[92:95], v[56:59]
  buffer_load_dwordx4 v6, s[4:7], s57 offen offset:1024 sc1 lds
  v_mfma_f32_16x16x32_bf16 v[60:63], a[168:171], v[92:95], v[60:63]
  v_permlane16_swap_b32 v26, v38
  s_waitcnt lgkmcnt(4)
  v_mfma_f32_16x16x32_bf16 v[40:43], a[44:47], v[72:75], v[40:43]
  ds_read_b64_tr_b16 v[88:89], v98 offset:53248
  v_mfma_f32_16x16x32_bf16 v[44:47], a[108:111], v[72:75], v[44:47]
  ds_read_b64_tr_b16 v[90:91], v98 offset:55296
  v_mfma_f32_16x16x32_bf16 v[48:51], a[172:175], v[72:75], v[48:51]
  ds_read_b64_tr_b16 v[92:93], v99 offset:53248
  v_mfma_f32_16x16x32_bf16 v[52:55], a[44:47], v[76:79], v[52:55]
  ds_read_b64_tr_b16 v[94:95], v99 offset:55296
  v_mfma_f32_16x16x32_bf16 v[56:59], a[108:111], v[76:79], v[56:59]
  buffer_load_dwordx4 v6, s[4:7], s57 offen offset:2048 sc1 lds
  v_mfma_f32_16x16x32_bf16 v[60:63], a[172:175], v[76:79], v[60:63]
  v_permlane16_swap_b32 v27, v39
  s_waitcnt lgkmcnt(4)
  v_mfma_f32_16x16x32_bf16 v[40:43], a[48:51], v[80:83], v[40:43]
  ds_read_b64_tr_b16 v[72:73], v98 offset:57344
  v_mul_f32 v24, v24, v36
  v_mfma_f32_16x16x32_bf16 v[44:47], a[112:115], v[80:83], v[44:47]
  ds_read_b64_tr_b16 v[74:75], v98 offset:59392
  v_mul_f32 v25, v25, v37
  v_mfma_f32_16x16x32_bf16 v[48:51], a[176:179], v[80:83], v[48:51]
  ds_read_b64_tr_b16 v[76:77], v99 offset:57344
  v_mul_f32 v26, v26, v38
  v_mfma_f32_16x16x32_bf16 v[52:55], a[48:51], v[84:87], v[52:55]
  ds_read_b64_tr_b16 v[78:79], v99 offset:59392
  buffer_load_dwordx4 v6, s[4:7], s57 offen offset:3072 sc1 lds
  v_mfma_f32_16x16x32_bf16 v[56:59], a[112:115], v[84:87], v[56:59]
  s_add_u32 m0, m0, 16384
  s_xor_b32 s57, s57, 32768
  v_mfma_f32_16x16x32_bf16 v[60:63], a[176:179], v[84:87], v[60:63]
  buffer_load_dwordx4 v6, s[4:7], s57 offen offset:0 sc1 lds
  v_mul_f32 v27, v27, v39
  s_waitcnt lgkmcnt(4)
  v_mfma_f32_16x16x32_bf16 v[40:43], a[52:55], v[88:91], v[40:43]
  ds_read_b64_tr_b16 v[80:81], v98 offset:61440
  v_cvt_pk_bf16_f32 v120, v24, v25
  v_mfma_f32_16x16x32_bf16 v[44:47], a[116:119], v[88:91], v[44:47]
  ds_read_b64_tr_b16 v[82:83], v98 offset:63488
  v_cvt_pk_bf16_f32 v121, v26, v27
  v_mfma_f32_16x16x32_bf16 v[48:51], a[180:183], v[88:91], v[48:51]
  ds_read_b64_tr_b16 v[84:85], v99 offset:61440
  v_mfma_f32_16x16x32_bf16 v[52:55], a[52:55], v[92:95], v[52:55]
  ds_read_b64_tr_b16 v[86:87], v99 offset:63488
  v_mfma_f32_16x16x32_bf16 v[56:59], a[116:119], v[92:95], v[56:59]
  s_waitcnt vmcnt(10)
  s_barrier
  v_mfma_f32_16x16x32_bf16 v[60:63], a[180:183], v[92:95], v[60:63]
  buffer_store_dwordx2 v[120:121], v141, s[4:7], s101 offen sc1
  s_waitcnt lgkmcnt(4)
  v_mfma_f32_16x16x32_bf16 v[40:43], a[56:59], v[72:75], v[40:43]
  ds_read_b64_tr_b16 v[88:89], v96 offset:0
  v_mfma_f32_16x16x32_bf16 v[44:47], a[120:123], v[72:75], v[44:47]
  ds_read_b64_tr_b16 v[90:91], v96 offset:2048
  v_mfma_f32_16x16x32_bf16 v[48:51], a[184:187], v[72:75], v[48:51]
  ds_read_b64_tr_b16 v[92:93], v97 offset:0
  v_mfma_f32_16x16x32_bf16 v[52:55], a[56:59], v[76:79], v[52:55]
  ds_read_b64_tr_b16 v[94:95], v97 offset:2048
  v_mfma_f32_16x16x32_bf16 v[56:59], a[120:123], v[76:79], v[56:59]
  buffer_load_dwordx4 v6, s[4:7], s57 offen offset:1024 sc1 lds
  v_mfma_f32_16x16x32_bf16 v[60:63], a[184:187], v[76:79], v[60:63]
  s_waitcnt lgkmcnt(4)
  v_mfma_f32_16x16x32_bf16 v[40:43], a[60:63], v[80:83], v[40:43]
  ds_read_b64_tr_b16 v[72:73], v96 offset:4096
  v_mfma_f32_16x16x32_bf16 v[44:47], a[124:127], v[80:83], v[44:47]
  ds_read_b64_tr_b16 v[74:75], v96 offset:6144
  v_mfma_f32_16x16x32_bf16 v[48:51], a[188:191], v[80:83], v[48:51]
  ds_read_b64_tr_b16 v[76:77], v97 offset:4096
  buffer_load_dwordx4 v6, s[4:7], s57 offen offset:2048 sc1 lds
  v_mfma_f32_16x16x32_bf16 v[52:55], a[60:63], v[84:87], v[52:55]
  ds_read_b64_tr_b16 v[78:79], v97 offset:6144
  v_mfma_f32_16x16x32_bf16 v[56:59], a[124:127], v[84:87], v[56:59]
  buffer_load_dwordx4 v6, s[4:7], s57 offen offset:3072 sc1 lds
  v_mfma_f32_16x16x32_bf16 v[60:63], a[188:191], v[84:87], v[60:63]
  s_waitcnt lgkmcnt(4)
  v_mfma_f32_16x16x32_bf16 v[16:19], a[0:3], v[88:91], 0
  ds_read_b64_tr_b16 v[80:81], v96 offset:8192
  v_mul_f32 v40, v40, v44
  v_mul_f32 v41, v41, v45
  v_mfma_f32_16x16x32_bf16 v[20:23], a[64:67], v[88:91], 0
  ds_read_b64_tr_b16 v[82:83], v96 offset:10240
  v_mul_f32 v42, v42, v46
  v_mul_f32 v43, v43, v47
  v_mfma_f32_16x16x32_bf16 v[24:27], a[128:131], v[88:91], 0
  ds_read_b64_tr_b16 v[84:85], v97 offset:8192
  v_mul_f32 v52, v52, v56
  v_mul_f32 v53, v53, v57
  v_mfma_f32_16x16x32_bf16 v[28:31], a[0:3], v[92:95], 0
  ds_read_b64_tr_b16 v[86:87], v97 offset:10240
  v_mul_f32 v54, v54, v58
  v_mul_f32 v55, v55, v59
  v_mfma_f32_16x16x32_bf16 v[32:35], a[64:67], v[92:95], 0
  v_cvt_pk_bf16_f32 v124, v40, v41
  v_cvt_pk_bf16_f32 v125, v42, v43
  v_mfma_f32_16x16x32_bf16 v[36:39], a[128:131], v[92:95], 0
  v_cvt_pk_bf16_f32 v126, v52, v53
  v_cvt_pk_bf16_f32 v127, v54, v55
  s_waitcnt lgkmcnt(4)
  v_mfma_f32_16x16x32_bf16 v[16:19], a[4:7], v[72:75], v[16:19]
  ds_read_b64_tr_b16 v[88:89], v96 offset:12288
  v_permlane16_swap_b32 v124, v126
  v_mfma_f32_16x16x32_bf16 v[20:23], a[68:71], v[72:75], v[20:23]
  ds_read_b64_tr_b16 v[90:91], v96 offset:14336
  v_permlane16_swap_b32 v125, v127
  v_mfma_f32_16x16x32_bf16 v[24:27], a[132:135], v[72:75], v[24:27]
  ds_read_b64_tr_b16 v[92:93], v97 offset:12288
  v_xor_b32 v98, 0x10000, v98
  v_mfma_f32_16x16x32_bf16 v[28:31], a[4:7], v[76:79], v[28:31]
  ds_read_b64_tr_b16 v[94:95], v97 offset:14336
  v_xor_b32 v99, 0x10000, v99
  v_mfma_f32_16x16x32_bf16 v[32:35], a[68:71], v[76:79], v[32:35]
  s_waitcnt vmcnt(10)
  s_barrier
  v_mfma_f32_16x16x32_bf16 v[36:39], a[132:135], v[76:79], v[36:39]
  buffer_store_dwordx4 v[124:127], v140, s[4:7], s62 offen sc1
  s_waitcnt lgkmcnt(4)
  v_mfma_f32_16x16x32_bf16 v[16:19], a[8:11], v[80:83], v[16:19]
  ds_read_b64_tr_b16 v[72:73], v96 offset:16384
  v_permlane16_swap_b32 v48, v60
  v_mfma_f32_16x16x32_bf16 v[20:23], a[72:75], v[80:83], v[20:23]
  ds_read_b64_tr_b16 v[74:75], v96 offset:18432
  v_mfma_f32_16x16x32_bf16 v[24:27], a[136:139], v[80:83], v[24:27]
  ds_read_b64_tr_b16 v[76:77], v97 offset:16384
  v_mfma_f32_16x16x32_bf16 v[28:31], a[8:11], v[84:87], v[28:31]
  ds_read_b64_tr_b16 v[78:79], v97 offset:18432
  v_mfma_f32_16x16x32_bf16 v[32:35], a[72:75], v[84:87], v[32:35]
  v_permlane16_swap_b32 v49, v61
  v_mfma_f32_16x16x32_bf16 v[36:39], a[136:139], v[84:87], v[36:39]
  v_bfe_u32 v133, v0, 2, 4
  s_waitcnt lgkmcnt(4)
  v_mfma_f32_16x16x32_bf16 v[16:19], a[12:15], v[88:91], v[16:19]
  ds_read_b64_tr_b16 v[80:81], v96 offset:20480
  s_lshl_b32 s51, s35, 13
  v_mfma_f32_16x16x32_bf16 v[20:23], a[76:79], v[88:91], v[20:23]
  ds_read_b64_tr_b16 v[82:83], v96 offset:22528
  s_lshl_b32 s52, s3, 11
  v_mfma_f32_16x16x32_bf16 v[24:27], a[140:143], v[88:91], v[24:27]
  ds_read_b64_tr_b16 v[84:85], v97 offset:20480
  s_add_u32 s51, s51, s52
  v_mfma_f32_16x16x32_bf16 v[28:31], a[12:15], v[92:95], v[28:31]
  ds_read_b64_tr_b16 v[86:87], v97 offset:22528
  v_permlane16_swap_b32 v50, v62
  v_mfma_f32_16x16x32_bf16 v[32:35], a[76:79], v[92:95], v[32:35]
  v_permlane16_swap_b32 v51, v63
  v_mfma_f32_16x16x32_bf16 v[36:39], a[140:143], v[92:95], v[36:39]
  v_mul_f32 v48, v48, v60
  s_waitcnt lgkmcnt(4)
  v_mfma_f32_16x16x32_bf16 v[16:19], a[16:19], v[72:75], v[16:19]
  ds_read_b64_tr_b16 v[88:89], v96 offset:24576
  v_mul_f32 v49, v49, v61
  v_mfma_f32_16x16x32_bf16 v[20:23], a[80:83], v[72:75], v[20:23]
  ds_read_b64_tr_b16 v[90:91], v96 offset:26624
  v_mul_f32 v50, v50, v62
  v_mfma_f32_16x16x32_bf16 v[24:27], a[144:147], v[72:75], v[24:27]
  ds_read_b64_tr_b16 v[92:93], v97 offset:24576
  v_mul_f32 v51, v51, v63
  v_mfma_f32_16x16x32_bf16 v[28:31], a[16:19], v[76:79], v[28:31]
  ds_read_b64_tr_b16 v[94:95], v97 offset:26624
  v_cvt_pk_bf16_f32 v120, v48, v49
  v_mfma_f32_16x16x32_bf16 v[32:35], a[80:83], v[76:79], v[32:35]
  v_cvt_pk_bf16_f32 v121, v50, v51
  s_add_u32 s51, s51, 65536
  v_mfma_f32_16x16x32_bf16 v[36:39], a[144:147], v[76:79], v[36:39]
  buffer_store_dwordx2 v[120:121], v141, s[4:7], s31 offen sc1
  s_waitcnt lgkmcnt(4)
  v_mfma_f32_16x16x32_bf16 v[16:19], a[20:23], v[80:83], v[16:19]
  ds_read_b64_tr_b16 v[72:73], v96 offset:28672
  v_add_u32 v140, 4194304, v140
  v_mfma_f32_16x16x32_bf16 v[20:23], a[84:87], v[80:83], v[20:23]
  ds_read_b64_tr_b16 v[74:75], v96 offset:30720
  v_add_u32 v141, 4194304, v141
  v_mfma_f32_16x16x32_bf16 v[24:27], a[148:151], v[80:83], v[24:27]
  ds_read_b64_tr_b16 v[76:77], v97 offset:28672
  s_lshl_b32 s52, s34, 1
  v_mfma_f32_16x16x32_bf16 v[28:31], a[20:23], v[84:87], v[28:31]
  ds_read_b64_tr_b16 v[78:79], v97 offset:30720
  v_lshl_add_u32 v134, v133, 7, s51
  v_mfma_f32_16x16x32_bf16 v[32:35], a[84:87], v[84:87], v[32:35]
  s_waitcnt vmcnt(7)
  s_barrier
  v_mfma_f32_16x16x32_bf16 v[36:39], a[148:151], v[84:87], v[36:39]
  v_bfe_u32 v133, v133, 1, 2
  s_waitcnt lgkmcnt(4)
  v_mfma_f32_16x16x32_bf16 v[16:19], a[24:27], v[88:91], v[16:19]
  ds_read_b64_tr_b16 v[80:81], v96 offset:32768
  v_and_b32 v135, 3, v0
  v_mfma_f32_16x16x32_bf16 v[20:23], a[88:91], v[88:91], v[20:23]
  ds_read_b64_tr_b16 v[82:83], v96 offset:34816
  v_xor_b32 v133, s52, v133
  v_mfma_f32_16x16x32_bf16 v[24:27], a[152:155], v[88:91], v[24:27]
  ds_read_b64_tr_b16 v[84:85], v97 offset:32768
  v_lshl_add_u32 v134, v135, 3, v134
  v_mfma_f32_16x16x32_bf16 v[28:31], a[24:27], v[92:95], v[28:31]
  ds_read_b64_tr_b16 v[86:87], v97 offset:34816
  v_lshl_add_u32 v134, v133, 5, v134
  v_mfma_f32_16x16x32_bf16 v[32:35], a[88:91], v[92:95], v[32:35]
  v_xor_b32 v133, 32, v134
  v_mfma_f32_16x16x32_bf16 v[36:39], a[152:155], v[92:95], v[36:39]
  s_waitcnt lgkmcnt(4)
  v_mfma_f32_16x16x32_bf16 v[16:19], a[28:31], v[72:75], v[16:19]
  ds_read_b64_tr_b16 v[88:89], v96 offset:36864
  v_mfma_f32_16x16x32_bf16 v[20:23], a[92:95], v[72:75], v[20:23]
  ds_read_b64_tr_b16 v[90:91], v96 offset:38912
  v_mfma_f32_16x16x32_bf16 v[24:27], a[156:159], v[72:75], v[24:27]
  ds_read_b64_tr_b16 v[92:93], v97 offset:36864
  v_mfma_f32_16x16x32_bf16 v[28:31], a[28:31], v[76:79], v[28:31]
  ds_read_b64_tr_b16 v[94:95], v97 offset:38912
  v_mfma_f32_16x16x32_bf16 v[32:35], a[92:95], v[76:79], v[32:35]
  v_mfma_f32_16x16x32_bf16 v[36:39], a[156:159], v[76:79], v[36:39]
  s_waitcnt lgkmcnt(4)
  v_mfma_f32_16x16x32_bf16 v[16:19], a[32:35], v[80:83], v[16:19]
  ds_read_b64_tr_b16 v[72:73], v96 offset:40960
  v_mfma_f32_16x16x32_bf16 v[20:23], a[96:99], v[80:83], v[20:23]
  ds_read_b64_tr_b16 v[74:75], v96 offset:43008
  v_mfma_f32_16x16x32_bf16 v[24:27], a[160:163], v[80:83], v[24:27]
  ds_read_b64_tr_b16 v[76:77], v97 offset:40960
  v_mfma_f32_16x16x32_bf16 v[28:31], a[32:35], v[84:87], v[28:31]
  ds_read_b64_tr_b16 v[78:79], v97 offset:43008
  v_mfma_f32_16x16x32_bf16 v[32:35], a[96:99], v[84:87], v[32:35]
  s_lshl_b32 s28, s32, 10
  v_lshrrev_b32 v6, 2, v0
  v_mfma_f32_16x16x32_bf16 v[36:39], a[160:163], v[84:87], v[36:39]
  s_add_u32 s28, s28, 36077568
  s_waitcnt lgkmcnt(4)
  v_mfma_f32_16x16x32_bf16 v[16:19], a[36:39], v[88:91], v[16:19]
  ds_read_b64_tr_b16 v[80:81], v96 offset:45056
  v_lshlrev_b32 v123, 8, v0
  v_mfma_f32_16x16x32_bf16 v[20:23], a[100:103], v[88:91], v[20:23]
  ds_read_b64_tr_b16 v[82:83], v96 offset:47104
  v_min_u32 v6, 1, v6
  v_mfma_f32_16x16x32_bf16 v[24:27], a[164:167], v[88:91], v[24:27]
  ds_read_b64_tr_b16 v[84:85], v97 offset:45056
  s_and_b32 s53, s35, 3
  v_mfma_f32_16x16x32_bf16 v[28:31], a[36:39], v[92:95], v[28:31]
  ds_read_b64_tr_b16 v[86:87], v97 offset:47104
  v_lshl_add_u32 v123, v6, 31, v123
  v_mfma_f32_16x16x32_bf16 v[32:35], a[100:103], v[92:95], v[32:35]
  s_waitcnt vmcnt(2)
  s_barrier
  v_mfma_f32_16x16x32_bf16 v[36:39], a[164:167], v[92:95], v[36:39]
  s_lshl_b32 s53, s53, 8
  s_waitcnt lgkmcnt(4)
  v_mfma_f32_16x16x32_bf16 v[16:19], a[40:43], v[72:75], v[16:19]
  ds_read_b64_tr_b16 v[88:89], v96 offset:49152
  v_and_b32 v6, 63, v0
  v_mfma_f32_16x16x32_bf16 v[20:23], a[104:107], v[72:75], v[20:23]
  ds_read_b64_tr_b16 v[90:91], v96 offset:51200
  v_lshl_add_u32 v6, v6, 26, s53
  v_mfma_f32_16x16x32_bf16 v[24:27], a[168:171], v[72:75], v[24:27]
  ds_read_b64_tr_b16 v[92:93], v97 offset:49152
  v_mov_b32 v122, 0x10000000
  v_mfma_f32_16x16x32_bf16 v[28:31], a[40:43], v[76:79], v[28:31]
  ds_read_b64_tr_b16 v[94:95], v97 offset:51200
  v_mfma_f32_16x16x32_bf16 v[32:35], a[104:107], v[76:79], v[32:35]
  ds_read_b64_tr_b16 v[12:13], v134
  v_mfma_f32_16x16x32_bf16 v[36:39], a[168:171], v[76:79], v[36:39]
  ds_read_b64_tr_b16 v[14:15], v133
  s_waitcnt lgkmcnt(6)
  v_mfma_f32_16x16x32_bf16 v[16:19], a[44:47], v[80:83], v[16:19]
  ds_read_b64_tr_b16 v[72:73], v96 offset:53248
  v_mfma_f32_16x16x32_bf16 v[20:23], a[108:111], v[80:83], v[20:23]
  ds_read_b64_tr_b16 v[74:75], v96 offset:55296
  v_mfma_f32_16x16x32_bf16 v[24:27], a[172:175], v[80:83], v[24:27]
  ds_read_b64_tr_b16 v[76:77], v97 offset:53248
  v_mfma_f32_16x16x32_bf16 v[28:31], a[44:47], v[84:87], v[28:31]
  ds_read_b64_tr_b16 v[78:79], v97 offset:55296
  v_mfma_f32_16x16x32_bf16 v[32:35], a[108:111], v[84:87], v[32:35]
  v_mfma_f32_16x16x32_bf16 v[36:39], a[172:175], v[84:87], v[36:39]
  s_waitcnt lgkmcnt(6)
  v_mfma_f32_16x16x32_bf16 v[16:19], a[48:51], v[88:91], v[16:19]
  ds_read_b64_tr_b16 v[80:81], v96 offset:57344
  s_waitcnt lgkmcnt(5)
  v_dot2_f32_bf16 v68, v12, v12, 0
  v_mfma_f32_16x16x32_bf16 v[20:23], a[112:115], v[88:91], v[20:23]
  ds_read_b64_tr_b16 v[82:83], v96 offset:59392
  v_dot2_f32_bf16 v69, v14, v14, 0
  v_mfma_f32_16x16x32_bf16 v[24:27], a[176:179], v[88:91], v[24:27]
  ds_read_b64_tr_b16 v[84:85], v97 offset:57344
  v_dot2_f32_bf16 v68, v13, v13, v68
  v_mfma_f32_16x16x32_bf16 v[28:31], a[48:51], v[92:95], v[28:31]
  ds_read_b64_tr_b16 v[86:87], v97 offset:59392
  v_dot2_f32_bf16 v69, v15, v15, v69
  v_mfma_f32_16x16x32_bf16 v[32:35], a[112:115], v[92:95], v[32:35]
  s_nop 1
  v_permlane16_swap_b32 v68, v69
  v_mfma_f32_16x16x32_bf16 v[36:39], a[176:179], v[92:95], v[36:39]
  v_add_f32 v68, v68, v69
  s_waitcnt lgkmcnt(4)
  v_mfma_f32_16x16x32_bf16 v[16:19], a[52:55], v[72:75], v[16:19]
  ds_read_b64_tr_b16 v[88:89], v96 offset:61440
  s_waitcnt vmcnt(0)
  s_barrier
  v_mfma_f32_16x16x32_bf16 v[20:23], a[116:119], v[72:75], v[20:23]
  ds_read_b64_tr_b16 v[90:91], v96 offset:63488
  v_mfma_f32_16x16x32_bf16 v[24:27], a[180:183], v[72:75], v[24:27]
  ds_read_b64_tr_b16 v[92:93], v97 offset:61440
  v_mfma_f32_16x16x32_bf16 v[28:31], a[52:55], v[76:79], v[28:31]
  ds_read_b64_tr_b16 v[94:95], v97 offset:63488
  v_mfma_f32_16x16x32_bf16 v[32:35], a[116:119], v[76:79], v[32:35]
  buffer_atomic_sub v4, v2, s[4:7], s41 offen sc1
  v_mfma_f32_16x16x32_bf16 v[36:39], a[180:183], v[76:79], v[36:39]
  ds_write_b32 v101, v68
  s_waitcnt lgkmcnt(5)
  v_mfma_f32_16x16x32_bf16 v[16:19], a[56:59], v[80:83], v[16:19]
  ds_read_b64_tr_b16 v[72:73], v98 offset:0
  v_mfma_f32_16x16x32_bf16 v[20:23], a[120:123], v[80:83], v[20:23]
  ds_read_b64_tr_b16 v[74:75], v98 offset:2048
  v_mfma_f32_16x16x32_bf16 v[24:27], a[184:187], v[80:83], v[24:27]
  ds_read_b64_tr_b16 v[76:77], v99 offset:0
  v_mfma_f32_16x16x32_bf16 v[28:31], a[56:59], v[84:87], v[28:31]
  ds_read_b64_tr_b16 v[78:79], v99 offset:2048
  v_mfma_f32_16x16x32_bf16 v[32:35], a[120:123], v[84:87], v[32:35]
  v_mfma_f32_16x16x32_bf16 v[36:39], a[184:187], v[84:87], v[36:39]
  s_waitcnt lgkmcnt(5)
  v_mfma_f32_16x16x32_bf16 v[24:27], a[188:191], v[88:91], v[24:27]
  ds_read_b64_tr_b16 v[80:81], v98 offset:4096
  v_mfma_f32_16x16x32_bf16 v[36:39], a[188:191], v[92:95], v[36:39]
  ds_read_b64_tr_b16 v[82:83], v98 offset:6144
  v_mfma_f32_16x16x32_bf16 v[16:19], a[60:63], v[88:91], v[16:19]
  ds_read_b64_tr_b16 v[84:85], v99 offset:4096
  v_mfma_f32_16x16x32_bf16 v[20:23], a[124:127], v[88:91], v[20:23]
  ds_read_b64_tr_b16 v[86:87], v99 offset:6144
  s_nop 0
  v_mul_f32 v65, s46, v24
  s_nop 0
  v_mul_f32 v67, s46, v36
  v_mfma_f32_16x16x32_bf16 v[28:31], a[60:63], v[92:95], v[28:31]
  v_cvt_pk_bf16_f32 v64, 0, -v65
  v_cvt_pk_bf16_f32 v66, 0, -v67
  v_mfma_f32_16x16x32_bf16 v[32:35], a[124:127], v[92:95], v[32:35]
  ds_write2_b64 v100, v[66:67], v[64:65] offset0:64 offset1:80
  s_waitcnt lgkmcnt(5)
  v_mfma_f32_16x16x32_bf16 v[40:43], a[0:3], v[72:75], 0
  ds_read_b64_tr_b16 v[88:89], v98 offset:8192
  v_mfma_f32_16x16x32_bf16 v[44:47], a[64:67], v[72:75], 0
  ds_read_b64_tr_b16 v[90:91], v98 offset:10240
  v_mfma_f32_16x16x32_bf16 v[48:51], a[128:131], v[72:75], 0
  ds_read_b64_tr_b16 v[92:93], v99 offset:8192
  v_mfma_f32_16x16x32_bf16 v[52:55], a[0:3], v[76:79], 0
  ds_read_b64_tr_b16 v[94:95], v99 offset:10240
  v_mfma_f32_16x16x32_bf16 v[56:59], a[64:67], v[76:79], 0
  s_waitcnt lgkmcnt(4)
  s_barrier
  v_mfma_f32_16x16x32_bf16 v[60:63], a[128:131], v[76:79], 0
  ds_read_b32 v118, v119 offset:512
  v_mfma_f32_16x16x32_bf16 v[40:43], a[4:7], v[80:83], v[40:43]
  ds_read_b64_tr_b16 v[72:73], v98 offset:12288
  ds_read_b32 v116, v102 offset:512
  v_mfma_f32_16x16x32_bf16 v[44:47], a[68:71], v[80:83], v[44:47]
  ds_read_b64_tr_b16 v[74:75], v98 offset:14336
  ds_read_b32 v117, v103 offset:512
  v_mfma_f32_16x16x32_bf16 v[48:51], a[132:135], v[80:83], v[48:51]
  ds_read_b64_tr_b16 v[76:77], v99 offset:12288
  v_mfma_f32_16x16x32_bf16 v[52:55], a[4:7], v[84:87], v[52:55]
  ds_read_b64_tr_b16 v[78:79], v99 offset:14336
  ds_read_b128 v[64:67], v70
  v_mfma_f32_16x16x32_bf16 v[56:59], a[68:71], v[84:87], v[56:59]
  v_mfma_f32_16x16x32_bf16 v[60:63], a[132:135], v[84:87], v[60:63]
  s_waitcnt lgkmcnt(8)
  v_mfma_f32_16x16x32_bf16 v[40:43], a[8:11], v[88:91], v[40:43]
  ds_read_b64_tr_b16 v[80:81], v98 offset:16384
  v_mfma_f32_16x16x32_bf16 v[44:47], a[72:75], v[88:91], v[44:47]
  ds_read_b64_tr_b16 v[82:83], v98 offset:18432
  v_mfma_f32_16x16x32_bf16 v[48:51], a[136:139], v[88:91], v[48:51]
  ds_read_b64_tr_b16 v[84:85], v99 offset:16384
  s_waitcnt lgkmcnt(3)
  v_add_f32 v64, v64, v65
  v_add_f32 v66, v66, v67
  v_mfma_f32_16x16x32_bf16 v[52:55], a[8:11], v[92:95], v[52:55]
  ds_read_b64_tr_b16 v[86:87], v99 offset:18432
  v_add_f32 v65, v64, v66
  v_add_f32 v64, v64, v66
  v_mfma_f32_16x16x32_bf16 v[56:59], a[72:75], v[92:95], v[56:59]
  s_nop 0
  v_permlane32_swap_b32 v64, v65
  v_mfma_f32_16x16x32_bf16 v[60:63], a[136:139], v[92:95], v[60:63]
  v_add_f32 v68, v64, v65
  v_mfma_f32_16x16x32_bf16 v[40:43], a[12:15], v[72:75], v[40:43]
  ds_read_b64_tr_b16 v[88:89], v98 offset:20480
  v_mfma_f32_16x16x32_bf16 v[44:47], a[76:79], v[72:75], v[44:47]
  ds_read_b64_tr_b16 v[90:91], v98 offset:22528
  v_mfma_f32_16x16x1_4b_f32 v[16:31], v104, v116, v[16:31]
  v_mfma_f32_16x16x32_bf16 v[48:51], a[140:143], v[72:75], v[48:51]
  ds_read_b64_tr_b16 v[92:93], v99 offset:20480
  v_mfma_f32_16x16x32_bf16 v[52:55], a[12:15], v[76:79], v[52:55]
  ds_read_b64_tr_b16 v[94:95], v99 offset:22528
  v_mfma_f32_16x16x1_4b_f32 v[32:47], v105, v117, v[32:47]
  v_mfma_f32_16x16x32_bf16 v[56:59], a[76:79], v[76:79], v[56:59]
  v_mfma_f32_16x16x32_bf16 v[60:63], a[140:143], v[76:79], v[60:63]
  s_waitcnt lgkmcnt(4)
  v_mfma_f32_16x16x32_bf16 v[40:43], a[16:19], v[80:83], v[40:43]
  ds_read_b64_tr_b16 v[72:73], v98 offset:24576
  v_mfma_f32_16x16x32_bf16 v[44:47], a[80:83], v[80:83], v[44:47]
  ds_read_b64_tr_b16 v[74:75], v98 offset:26624
  v_mul_f32 v16, v16, v20
  v_mul_f32 v17, v17, v21
  v_mfma_f32_16x16x32_bf16 v[48:51], a[144:147], v[80:83], v[48:51]
  ds_read_b64_tr_b16 v[76:77], v99 offset:24576
  v_mul_f32 v18, v18, v22
  v_mul_f32 v19, v19, v23
  v_mfma_f32_16x16x32_bf16 v[52:55], a[16:19], v[84:87], v[52:55]
wpad_0_8:
  s_cbranch_execz wret_0
  ds_read_b64_tr_b16 v[78:79], v99 offset:26624
  v_mul_f32 v28, v28, v32
  v_mul_f32 v29, v29, v33
  v_mfma_f32_16x16x32_bf16 v[56:59], a[80:83], v[84:87], v[56:59]
  v_mov_b32 v5, 0
  buffer_atomic_add v5, v2, s[4:7], s41 offen sc0 sc1
  v_mul_f32 v30, v30, v34
  v_mfma_f32_16x16x32_bf16 v[60:63], a[144:147], v[84:87], v[60:63]
  v_mul_f32 v31, v31, v35
  v_cvt_pk_bf16_f32 v124, v16, v17
  s_waitcnt lgkmcnt(4)
  v_mfma_f32_16x16x32_bf16 v[40:43], a[20:23], v[88:91], v[40:43]
  ds_read_b64_tr_b16 v[80:81], v98 offset:28672
  buffer_store_dword v68, v71, s[4:7], s30 offen offset:1024 sc1
  v_mfma_f32_16x16x32_bf16 v[44:47], a[84:87], v[88:91], v[44:47]
  ds_read_b64_tr_b16 v[82:83], v98 offset:30720
  v_cvt_pk_bf16_f32 v125, v18, v19
  v_cvt_pk_bf16_f32 v126, v28, v29
  v_mfma_f32_16x16x32_bf16 v[48:51], a[148:151], v[88:91], v[48:51]
  ds_read_b64_tr_b16 v[84:85], v99 offset:28672
  v_cvt_pk_bf16_f32 v127, v30, v31
  v_mfma_f32_16x16x32_bf16 v[52:55], a[20:23], v[92:95], v[52:55]
  ds_read_b64_tr_b16 v[86:87], v99 offset:30720
  v_permlane16_swap_b32 v124, v126
  v_mfma_f32_16x16x32_bf16 v[56:59], a[84:87], v[92:95], v[56:59]
  v_permlane16_swap_b32 v125, v127
  s_lshl_b32 s57, s34, 18
  v_mfma_f32_16x16x32_bf16 v[60:63], a[148:151], v[92:95], v[60:63]
  buffer_store_dwordx4 v[124:127], v140, s[4:7], s100 offen sc1
  s_add_u32 s57, s57, s39
  s_waitcnt lgkmcnt(4)
  v_mfma_f32_16x16x32_bf16 v[40:43], a[24:27], v[72:75], v[40:43]
  ds_read_b64_tr_b16 v[88:89], v98 offset:32768
  v_permlane16_swap_b32 v24, v36
  v_mfma_f32_16x16x32_bf16 v[44:47], a[88:91], v[72:75], v[44:47]
  ds_read_b64_tr_b16 v[90:91], v98 offset:34816
  v_permlane16_swap_b32 v25, v37
  v_mfma_f32_16x16x32_bf16 v[48:51], a[152:155], v[72:75], v[48:51]
  ds_read_b64_tr_b16 v[92:93], v99 offset:32768
  v_permlane16_swap_b32 v26, v38
  v_mfma_f32_16x16x32_bf16 v[52:55], a[24:27], v[76:79], v[52:55]
  ds_read_b64_tr_b16 v[94:95], v99 offset:34816
  s_mul_i32 s55, s3, 49152
  s_add_u32 s57, s57, s55
  v_mfma_f32_16x16x32_bf16 v[56:59], a[88:91], v[76:79], v[56:59]
  v_permlane16_swap_b32 v27, v39
  v_mfma_f32_16x16x32_bf16 v[60:63], a[152:155], v[76:79], v[60:63]
  v_mul_f32 v24, v24, v36
  s_waitcnt lgkmcnt(4)
  v_mfma_f32_16x16x32_bf16 v[40:43], a[28:31], v[80:83], v[40:43]
  ds_read_b64_tr_b16 v[72:73], v98 offset:36864
  v_mul_f32 v25, v25, v37
  v_mfma_f32_16x16x32_bf16 v[44:47], a[92:95], v[80:83], v[44:47]
  ds_read_b64_tr_b16 v[74:75], v98 offset:38912
  v_mul_f32 v26, v26, v38
  v_mfma_f32_16x16x32_bf16 v[48:51], a[156:159], v[80:83], v[48:51]
  ds_read_b64_tr_b16 v[76:77], v99 offset:36864
  v_mul_f32 v27, v27, v39
  v_mfma_f32_16x16x32_bf16 v[52:55], a[28:31], v[84:87], v[52:55]
  ds_read_b64_tr_b16 v[78:79], v99 offset:38912
  v_cvt_pk_bf16_f32 v120, v24, v25
  v_mfma_f32_16x16x32_bf16 v[56:59], a[92:95], v[84:87], v[56:59]
  v_cvt_pk_bf16_f32 v121, v26, v27
  v_mfma_f32_16x16x32_bf16 v[60:63], a[156:159], v[84:87], v[60:63]
  buffer_store_dwordx2 v[120:121], v141, s[4:7], s101 offen sc1
  s_waitcnt lgkmcnt(4)
  v_mfma_f32_16x16x32_bf16 v[40:43], a[32:35], v[88:91], v[40:43]
  ds_read_b64_tr_b16 v[80:81], v98 offset:40960
  s_barrier
  v_mfma_f32_16x16x32_bf16 v[44:47], a[96:99], v[88:91], v[44:47]
  ds_read_b64_tr_b16 v[82:83], v98 offset:43008
  buffer_atomic_sub v122, v123, s[4:7], s28 offen sc1
  v_mfma_f32_16x16x32_bf16 v[48:51], a[160:163], v[88:91], v[48:51]
  ds_read_b64_tr_b16 v[84:85], v99 offset:40960
  s_lshl_b32 s51, s34, 8
  v_mfma_f32_16x16x32_bf16 v[52:55], a[32:35], v[92:95], v[52:55]
  ds_read_b64_tr_b16 v[86:87], v99 offset:43008
  s_add_u32 s51, s51, 158724
  v_mfma_f32_16x16x32_bf16 v[56:59], a[96:99], v[92:95], v[56:59]
  v_and_b32 v117, 31, v0
  v_lshl_add_u32 v117, v117, 3, s51
  v_mfma_f32_16x16x32_bf16 v[60:63], a[160:163], v[92:95], v[60:63]
  ds_read_b32 v117, v117
  s_waitcnt lgkmcnt(5)
  v_mfma_f32_16x16x32_bf16 v[40:43], a[36:39], v[72:75], v[40:43]
  ds_read_b64_tr_b16 v[88:89], v98 offset:45056
  v_mfma_f32_16x16x32_bf16 v[44:47], a[100:103], v[72:75], v[44:47]
  ds_read_b64_tr_b16 v[90:91], v98 offset:47104
  v_mfma_f32_16x16x1_4b_f32 v[48:63], v106, v118, v[48:63]
  v_mfma_f32_16x16x32_bf16 v[48:51], a[164:167], v[72:75], v[48:51]
  ds_read_b64_tr_b16 v[92:93], v99 offset:45056
  v_mfma_f32_16x16x32_bf16 v[52:55], a[36:39], v[76:79], v[52:55]
  ds_read_b64_tr_b16 v[94:95], v99 offset:47104
  v_mfma_f32_16x16x32_bf16 v[56:59], a[100:103], v[76:79], v[56:59]
  s_waitcnt vmcnt(4)
  v_cmp_ne_u32 vcc, 0, v5
  s_cbranch_vccnz poll_17_s
poll_17_ok:
  v_mfma_f32_16x16x32_bf16 v[60:63], a[164:167], v[76:79], v[60:63]
  s_barrier
  s_waitcnt lgkmcnt(5)
  v_mfma_f32_16x16x32_bf16 v[40:43], a[40:43], v[80:83], v[40:43]
  ds_read_b64_tr_b16 v[72:73], v98 offset:49152
  buffer_load_dwordx4 v[64:67], v7, s[4:7], s57 offen offset:0 sc1
  v_mfma_f32_16x16x32_bf16 v[44:47], a[104:107], v[80:83], v[44:47]
  ds_read_b64_tr_b16 v[74:75], v98 offset:51200
  v_mfma_f32_16x16x32_bf16 v[48:51], a[168:171], v[80:83], v[48:51]
  ds_read_b64_tr_b16 v[76:77], v99 offset:49152
  buffer_load_dwordx4 v[128:131], v7, s[4:7], s57 offen offset:256 sc1
  v_mfma_f32_16x16x32_bf16 v[52:55], a[40:43], v[84:87], v[52:55]
  ds_read_b64_tr_b16 v[78:79], v99 offset:51200
  v_mfma_f32_16x16x32_bf16 v[56:59], a[104:107], v[84:87], v[56:59]
  v_mfma_f32_16x16x32_bf16 v[60:63], a[168:171], v[84:87], v[60:63]
  buffer_load_dwordx4 v[132:135], v7, s[4:7], s57 offen offset:2048 sc1
  s_waitcnt lgkmcnt(4)
  v_mfma_f32_16x16x32_bf16 v[40:43], a[44:47], v[88:91], v[40:43]
  ds_read_b64_tr_b16 v[80:81], v98 offset:53248
  v_mfma_f32_16x16x32_bf16 v[44:47], a[108:111], v[88:91], v[44:47]
  ds_read_b64_tr_b16 v[82:83], v98 offset:55296
  v_mfma_f32_16x16x32_bf16 v[48:51], a[172:175], v[88:91], v[48:51]
  ds_read_b64_tr_b16 v[84:85], v99 offset:53248
  v_mfma_f32_16x16x32_bf16 v[52:55], a[44:47], v[92:95], v[52:55]
  ds_read_b64_tr_b16 v[86:87], v99 offset:55296
  buffer_load_dwordx4 v[136:139], v7, s[4:7], s57 offen offset:2304 sc1
  v_mfma_f32_16x16x32_bf16 v[56:59], a[108:111], v[92:95], v[56:59]
  s_add_u32 s57, s57, 4096
  v_mfma_f32_16x16x32_bf16 v[60:63], a[172:175], v[92:95], v[60:63]
  s_waitcnt lgkmcnt(4)
  v_mfma_f32_16x16x32_bf16 v[40:43], a[48:51], v[72:75], v[40:43]
  ds_read_b64_tr_b16 v[88:89], v98 offset:57344
  buffer_load_dwordx4 v[16:19], v7, s[4:7], s57 offen offset:0 sc1
  v_mfma_f32_16x16x32_bf16 v[44:47], a[112:115], v[72:75], v[44:47]
  ds_read_b64_tr_b16 v[90:91], v98 offset:59392
  v_mfma_f32_16x16x32_bf16 v[48:51], a[176:179], v[72:75], v[48:51]
  ds_read_b64_tr_b16 v[92:93], v99 offset:57344
  v_mfma_f32_16x16x32_bf16 v[52:55], a[48:51], v[76:79], v[52:55]
  ds_read_b64_tr_b16 v[94:95], v99 offset:59392
  v_mfma_f32_16x16x32_bf16 v[56:59], a[112:115], v[76:79], v[56:59]
  buffer_load_dwordx4 v[20:23], v7, s[4:7], s57 offen offset:256 sc1
  v_mfma_f32_16x16x32_bf16 v[60:63], a[176:179], v[76:79], v[60:63]
  s_waitcnt lgkmcnt(4)
  v_mfma_f32_16x16x32_bf16 v[40:43], a[52:55], v[80:83], v[40:43]
  ds_read_b64_tr_b16 v[72:73], v98 offset:61440
  v_mfma_f32_16x16x32_bf16 v[44:47], a[116:119], v[80:83], v[44:47]
  ds_read_b64_tr_b16 v[74:75], v98 offset:63488
  v_mfma_f32_16x16x32_bf16 v[48:51], a[180:183], v[80:83], v[48:51]
  ds_read_b64_tr_b16 v[76:77], v99 offset:61440
  v_mfma_f32_16x16x32_bf16 v[52:55], a[52:55], v[84:87], v[52:55]
  ds_read_b64_tr_b16 v[78:79], v99 offset:63488
  v_mfma_f32_16x16x32_bf16 v[56:59], a[116:119], v[84:87], v[56:59]
  buffer_load_dwordx4 v[24:27], v7, s[4:7], s57 offen offset:2048 sc1
  v_mfma_f32_16x16x32_bf16 v[60:63], a[180:183], v[84:87], v[60:63]
  s_waitcnt lgkmcnt(4)
  v_mfma_f32_16x16x32_bf16 v[40:43], a[56:59], v[88:91], v[40:43]
  buffer_load_dwordx4 v[28:31], v7, s[4:7], s57 offen offset:2304 sc1
  s_add_u32 s57, s57, 12288
  v_mfma_f32_16x16x32_bf16 v[44:47], a[120:123], v[88:91], v[44:47]
  v_mfma_f32_16x16x32_bf16 v[48:51], a[184:187], v[88:91], v[48:51]
  buffer_load_dwordx4 v[32:35], v7, s[4:7], s57 offen offset:0 sc1
  v_mfma_f32_16x16x32_bf16 v[52:55], a[56:59], v[92:95], v[52:55]
  v_mfma_f32_16x16x32_bf16 v[56:59], a[120:123], v[92:95], v[56:59]
  v_mfma_f32_16x16x32_bf16 v[60:63], a[184:187], v[92:95], v[60:63]
  buffer_load_dwordx4 v[36:39], v7, s[4:7], s57 offen offset:2048 sc1
  s_add_u32 s57, s57, 4096
  s_waitcnt lgkmcnt(0)
  v_mfma_f32_16x16x32_bf16 v[40:43], a[60:63], v[72:75], v[40:43]
  v_mfma_f32_16x16x32_bf16 v[44:47], a[124:127], v[72:75], v[44:47]
  v_mfma_f32_16x16x32_bf16 v[48:51], a[188:191], v[72:75], v[48:51]
  v_mfma_f32_16x16x32_bf16 v[52:55], a[60:63], v[76:79], v[52:55]
  buffer_load_dwordx4 v[68:71], v70, s[4:7], s30 offen offset:0 sc1
  v_mfma_f32_16x16x32_bf16 v[56:59], a[124:127], v[76:79], v[56:59]
  v_mfma_f32_16x16x32_bf16 v[60:63], a[188:191], v[76:79], v[60:63]
  s_waitcnt vmcnt(10)
  v_mfma_f32_16x16x32_bf16 v[80:83], a[196:199], v[64:67], 0
  s_nop 0
  v_mul_f32 v40, v40, v44
  v_mul_f32 v41, v41, v45
  v_mul_f32 v42, v42, v46
  v_mfma_f32_16x16x32_bf16 v[88:91], a[200:203], v[64:67], 0
  v_mul_f32 v43, v43, v47
  v_mul_f32 v52, v52, v56
  v_mul_f32 v53, v53, v57
  v_mfma_f32_16x16x32_bf16 v[96:99], a[204:207], v[64:67], 0
  v_mul_f32 v54, v54, v58
  v_mul_f32 v55, v55, v59
  v_cvt_pk_bf16_f32 v124, v40, v41
  v_mfma_f32_16x16x32_bf16 v[72:75], a[192:195], v[64:67], 0
  buffer_load_dwordx4 v[64:67], v7, s[4:7], s57 offen offset:0 sc1
  v_cvt_pk_bf16_f32 v125, v42, v43
  s_waitcnt vmcnt(10)
  v_mfma_f32_16x16x32_bf16 v[84:87], a[196:199], v[128:131], 0
  v_cvt_pk_bf16_f32 v126, v52, v53
  v_cvt_pk_bf16_f32 v127, v54, v55
  s_nop 0
  v_permlane16_swap_b32 v124, v126
  v_mfma_f32_16x16x32_bf16 v[92:95], a[200:203], v[128:131], 0
  v_permlane16_swap_b32 v125, v127
  v_permlane16_swap_b32 v48, v60
  v_mfma_f32_16x16x32_bf16 v[100:103], a[204:207], v[128:131], 0
  v_permlane16_swap_b32 v49, v61
  v_permlane16_swap_b32 v50, v62
  v_mfma_f32_16x16x32_bf16 v[76:79], a[192:195], v[128:131], 0
  buffer_load_dwordx4 v[40:43], v7, s[4:7], s57 offen offset:2048 sc1
  s_add_u32 s57, s57, 12288
  s_waitcnt vmcnt(10)
  v_mfma_f32_16x16x32_bf16 v[80:83], a[212:215], v[132:135], v[80:83]
  v_permlane16_swap_b32 v51, v63
  v_mul_f32 v48, v48, v60
  v_mfma_f32_16x16x32_bf16 v[88:91], a[216:219], v[132:135], v[88:91]
  v_mul_f32 v49, v49, v61
  v_mul_f32 v50, v50, v62
  v_mul_f32 v51, v51, v63
  v_mfma_f32_16x16x32_bf16 v[96:99], a[220:223], v[132:135], v[96:99]
  v_cvt_pk_bf16_f32 v120, v48, v49
  v_cvt_pk_bf16_f32 v121, v50, v51
  v_mov_b32 v5, 0
  buffer_atomic_add v5, v6, s[4:7], s28 offen sc0 sc1
  v_mfma_f32_16x16x32_bf16 v[72:75], a[208:211], v[132:135], v[72:75]
  buffer_load_dwordx4 v[44:47], v7, s[4:7], s57 offen offset:0 sc1
  buffer_store_dwordx4 v[124:127], v140, s[4:7], s62 offen sc1
  s_waitcnt vmcnt(12)
  v_mfma_f32_16x16x32_bf16 v[84:87], a[212:215], v[136:139], v[84:87]
  buffer_store_dwordx2 v[120:121], v141, s[4:7], s31 offen sc1
  v_mfma_f32_16x16x32_bf16 v[92:95], a[216:219], v[136:139], v[92:95]
  s_barrier
  v_mfma_f32_16x16x32_bf16 v[100:103], a[220:223], v[136:139], v[100:103]
  buffer_atomic_sub v4, v123, s[4:7], s28 offen sc1
  v_and_b32 v104, 63, v0
  v_mfma_f32_16x16x32_bf16 v[76:79], a[208:211], v[136:139], v[76:79]
  buffer_load_dwordx4 v[52:55], v7, s[4:7], s57 offen offset:2048 sc1
  s_add_u32 s57, s57, 4096
  s_waitcnt vmcnt(14)
  v_mfma_f32_16x16x32_bf16 v[80:83], a[228:231], v[16:19], v[80:83]
  s_lshl_b32 s51, s3, 13
  s_add_u32 s51, s51, 0
  v_lshl_add_u32 v104, v104, 4, s51
  v_mfma_f32_16x16x32_bf16 v[88:91], a[232:235], v[16:19], v[88:91]
  v_xor_b32 v105, 8192, v104
  v_xor_b32 v106, 16384, v104
  v_xor_b32 v107, 24576, v104
  v_mfma_f32_16x16x32_bf16 v[96:99], a[236:239], v[16:19], v[96:99]
  v_lshlrev_b32 v108, 16, v8
  v_and_b32 v109, 0xffff0000, v8
  v_lshlrev_b32 v110, 16, v9
  v_mfma_f32_16x16x32_bf16 v[72:75], a[224:227], v[16:19], v[72:75]
  buffer_load_dwordx4 v[56:59], v7, s[4:7], s57 offen offset:0 sc1
  s_add_u32 s57, s57, -20480
  s_waitcnt vmcnt(14)
  v_mfma_f32_16x16x32_bf16 v[84:87], a[228:231], v[20:23], v[84:87]
  v_and_b32 v111, 0xffff0000, v9
  v_lshlrev_b32 v112, 16, v10
  v_and_b32 v113, 0xffff0000, v10
  v_mfma_f32_16x16x32_bf16 v[92:95], a[232:235], v[20:23], v[92:95]
  v_lshlrev_b32 v114, 16, v11
  v_and_b32 v115, 0xffff0000, v11
  v_and_b32 v120, 15, v0
  v_mfma_f32_16x16x32_bf16 v[100:103], a[236:239], v[20:23], v[100:103]
  v_bfe_u32 v121, v0, 4, 2
  s_lshl1_add_u32 s58, s32, s34
  v_mfma_f32_16x16x32_bf16 v[76:79], a[224:227], v[20:23], v[76:79]
  buffer_load_dwordx4 v[128:131], v7, s[4:7], s57 offen offset:256 sc1
  s_waitcnt vmcnt(14)
  v_mfma_f32_16x16x32_bf16 v[80:83], a[244:247], v[24:27], v[80:83]
  s_lshl2_add_u32 s52, s35, s3
  v_lshlrev_b32 v120, 10, v120
  v_mfma_f32_16x16x32_bf16 v[88:91], a[248:251], v[24:27], v[88:91]
  s_lshl_b32 s58, s58, 15
  s_lshl_b32 s52, s52, 5
  v_mfma_f32_16x16x32_bf16 v[96:99], a[252:255], v[24:27], v[96:99]
  v_lshl_add_u32 v142, v121, 3, v120
  s_add_u32 s58, s58, s52
  v_mfma_f32_16x16x32_bf16 v[72:75], a[240:243], v[24:27], v[72:75]
  buffer_load_dwordx4 v[132:135], v7, s[4:7], s57 offen offset:2304 sc1
  s_add_u32 s57, s57, 4096
  s_waitcnt vmcnt(14)
  v_mfma_f32_16x16x32_bf16 v[84:87], a[244:247], v[28:31], v[84:87]
  s_add_u32 s59, s58, 16384
  s_lshl_b32 s9, s3, 13
  v_mfma_f32_16x16x32_bf16 v[92:95], a[248:251], v[28:31], v[92:95]
  s_add_u32 m0, s9, 71680
  s_sub_u32 s9, s30, s9
  v_mfma_f32_16x16x32_bf16 v[100:103], a[252:255], v[28:31], v[100:103]
  s_add_u32 s9, s9, 160768
  v_mfma_f32_16x16x32_bf16 v[76:79], a[240:243], v[28:31], v[76:79]
  buffer_load_dwordx4 v[136:139], v7, s[4:7], s57 offen offset:256 sc1
  s_waitcnt vmcnt(14)
  v_mfma_f32_16x16x32_bf16 v[80:83], v[148:151], v[32:35], v[80:83]
  v_mul_f32 v117, v117, v117
  s_waitcnt vmcnt(12)
  v_add_f32 v68, v68, v69
  v_mfma_f32_16x16x32_bf16 v[88:91], v[152:155], v[32:35], v[88:91]
  v_add_f32 v70, v70, v71
  v_add_f32 v69, v68, v70
  v_mfma_f32_16x16x32_bf16 v[96:99], v[156:159], v[32:35], v[96:99]
  v_add_f32 v68, v68, v70
  v_mfma_f32_16x16x32_bf16 v[72:75], v[144:147], v[32:35], v[72:75]
  buffer_load_dwordx4 v[16:19], v7, s[4:7], s57 offen offset:2304 sc1
  s_add_u32 s57, s57, 12288
  v_mfma_f32_16x16x32_bf16 v[80:83], v[164:167], v[36:39], v[80:83]
  v_permlane32_swap_b32 v68, v69
  v_mfma_f32_16x16x32_bf16 v[88:91], v[168:171], v[36:39], v[88:91]
  v_add_f32 v116, v68, v69
  v_fma_f32 v116, v116, s46, -v117
  v_mfma_f32_16x16x32_bf16 v[96:99], v[172:175], v[36:39], v[96:99]
  v_max_f32 v116, 0, v116
  v_cvt_pk_bf16_f32 v116, 0, v116
  v_mfma_f32_16x16x32_bf16 v[72:75], v[160:163], v[36:39], v[72:75]
  buffer_load_dwordx4 v[20:23], v7, s[4:7], s57 offen offset:256 sc1
  s_waitcnt vmcnt(13)
  v_mfma_f32_16x16x32_bf16 v[80:83], v[180:183], v[64:67], v[80:83]
  v_add_f32 v116, s48, v116
  v_cvt_pk_bf16_f32 v116, 0, v116
  v_mfma_f32_16x16x32_bf16 v[88:91], v[184:187], v[64:67], v[88:91]
  v_sqrt_f32 v116, v116
  v_mfma_f32_16x16x32_bf16 v[96:99], v[188:191], v[64:67], v[96:99]
  v_cvt_pk_bf16_f32 v116, 0, v116
  v_mul_f32 v116, v116, v116
  v_mfma_f32_16x16x32_bf16 v[72:75], v[176:179], v[64:67], v[72:75]
  buffer_load_dwordx4 v[24:27], v7, s[4:7], s57 offen offset:2304 sc1
  s_add_u32 s57, s57, 4096
  s_waitcnt vmcnt(13)
  v_mfma_f32_16x16x32_bf16 v[80:83], v[196:199], v[40:43], v[80:83]
  v_rcp_f32 v116, v116
  v_mfma_f32_16x16x32_bf16 v[88:91], v[200:203], v[40:43], v[88:91]
  v_mov_b32 v117, v116
  v_mfma_f32_16x16x32_bf16 v[96:99], v[204:207], v[40:43], v[96:99]
  s_nop 0
  v_permlane16_swap_b32 v116, v117
  s_waitcnt vmcnt(12)
  v_mfma_f32_16x16x32_bf16 v[72:75], v[192:195], v[40:43], v[72:75]
  buffer_load_dwordx4 v[28:31], v7, s[4:7], s57 offen offset:256 sc1
  v_cmp_lt_u32 vcc, 16, v5
  s_waitcnt vmcnt(12)
  v_mfma_f32_16x16x32_bf16 v[80:83], v[212:215], v[44:47], v[80:83]
  s_cbranch_vccnz prb_19_s
prb_19_ok:
  s_lshl_b32 s57, s34, 18
  s_add_u32 s57, s57, s39
  v_mfma_f32_16x16x32_bf16 v[88:91], v[216:219], v[44:47], v[88:91]
  s_add_u32 s57, s57, 4194304
  s_mul_i32 s55, s3, 49152
  s_add_u32 s57, s57, s55
  v_mfma_f32_16x16x32_bf16 v[96:99], v[220:223], v[44:47], v[96:99]
  buffer_load_dwordx4 v[48:51], v7, s[4:7], s57 offen offset:0 sc1
  v_mfma_f32_16x16x32_bf16 v[72:75], v[208:211], v[44:47], v[72:75]
  s_waitcnt vmcnt(9)
  v_mfma_f32_16x16x32_bf16 v[80:83], v[228:231], v[52:55], v[80:83]
  buffer_load_dwordx4 v[60:63], v7, s[4:7], s57 offen offset:2048 sc1
  s_add_u32 s57, s57, 4096
  v_mfma_f32_16x16x32_bf16 v[88:91], v[232:235], v[52:55], v[88:91]
  v_mfma_f32_16x16x32_bf16 v[96:99], v[236:239], v[52:55], v[96:99]
  buffer_load_dwordx4 v[124:127], v7, s[4:7], s57 offen offset:0 sc1
  v_mfma_f32_16x16x32_bf16 v[72:75], v[224:227], v[52:55], v[72:75]
  s_waitcnt vmcnt(10)
  v_mfma_f32_16x16x32_bf16 v[80:83], v[244:247], v[56:59], v[80:83]
  v_mfma_f32_16x16x32_bf16 v[88:91], v[248:251], v[56:59], v[88:91]
  v_mfma_f32_16x16x32_bf16 v[96:99], v[252:255], v[56:59], v[96:99]
  buffer_load_dwordx4 v[68:71], v7, s[4:7], s57 offen offset:2048 sc1
  s_add_u32 s57, s57, 12288
  v_mfma_f32_16x16x32_bf16 v[72:75], v[240:243], v[56:59], v[72:75]
  v_mov_b32 v123, 0
  s_waitcnt vmcnt(10)
  v_mfma_f32_16x16x32_bf16 v[84:87], v[148:151], v[128:131], v[84:87]
  buffer_atomic_add v123, v6, s[4:7], s28 offen sc0 sc1
  v_mfma_f32_16x16x32_bf16 v[92:95], v[152:155], v[128:131], v[92:95]
  ds_write_b128 v105, v[80:83] offset:0
  v_mfma_f32_16x16x32_bf16 v[100:103], v[156:159], v[128:131], v[100:103]
  buffer_load_dwordx4 v[32:35], v7, s[4:7], s57 offen offset:0 sc1
  s_add_u32 s57, s57, -16384
  s_waitcnt vmcnt(11)
  v_mfma_f32_16x16x32_bf16 v[84:87], v[164:167], v[132:135], v[84:87]
  ds_write_b128 v106, v[88:91] offset:2048
  v_mfma_f32_16x16x32_bf16 v[92:95], v[168:171], v[132:135], v[92:95]
  v_mfma_f32_16x16x32_bf16 v[100:103], v[172:175], v[132:135], v[100:103]
  ds_write_b128 v107, v[96:99] offset:4096
  s_waitcnt vmcnt(10)
  v_mfma_f32_16x16x32_bf16 v[84:87], v[180:183], v[136:139], v[84:87]
  buffer_load_dwordx4 v[36:39], v7, s[4:7], s57 offen offset:256 sc1
  v_mfma_f32_16x16x32_bf16 v[92:95], v[184:187], v[136:139], v[92:95]
  v_mfma_f32_16x16x32_bf16 v[100:103], v[188:191], v[136:139], v[100:103]
  s_waitcnt vmcnt(10)
  v_mfma_f32_16x16x32_bf16 v[84:87], v[196:199], v[16:19], v[84:87]
  s_waitcnt lgkmcnt(0)
  s_barrier
  v_mfma_f32_16x16x32_bf16 v[92:95], v[200:203], v[16:19], v[92:95]
  buffer_load_dwordx4 v[64:67], v7, s[4:7], s57 offen offset:2304 sc1
  s_add_u32 s57, s57, 4096
  v_mfma_f32_16x16x32_bf16 v[100:103], v[204:207], v[16:19], v[100:103]
  ds_read_b128 v[80:83], v104 offset:0
  s_waitcnt vmcnt(10)
  v_mfma_f32_16x16x32_bf16 v[84:87], v[212:215], v[20:23], v[84:87]
  ds_read_b128 v[88:91], v104 offset:2048
  v_mfma_f32_16x16x32_bf16 v[92:95], v[216:219], v[20:23], v[92:95]
  ds_read_b128 v[96:99], v104 offset:4096
  v_mfma_f32_16x16x32_bf16 v[100:103], v[220:223], v[20:23], v[100:103]
  buffer_load_dwordx4 v[40:43], v7, s[4:7], s57 offen offset:256 sc1
  s_waitcnt vmcnt(10)
  v_mfma_f32_16x16x32_bf16 v[84:87], v[228:231], v[24:27], v[84:87]
  v_mfma_f32_16x16x32_bf16 v[92:95], v[232:235], v[24:27], v[92:95]
  v_mfma_f32_16x16x32_bf16 v[100:103], v[236:239], v[24:27], v[100:103]
  s_waitcnt lgkmcnt(1)
  v_add_f32 v80, v80, v88
  s_waitcnt vmcnt(9)
  v_mfma_f32_16x16x32_bf16 v[84:87], v[244:247], v[28:31], v[84:87]
  buffer_load_dwordx4 v[44:47], v7, s[4:7], s57 offen offset:2304 sc1
  s_add_u32 s57, s57, 12288
  v_mfma_f32_16x16x32_bf16 v[92:95], v[248:251], v[28:31], v[92:95]
  v_add_f32 v81, v81, v89
  v_add_f32 v82, v82, v90
  v_mfma_f32_16x16x32_bf16 v[100:103], v[252:255], v[28:31], v[100:103]
  v_mov_b32 v5, 0
  buffer_atomic_add v5, v6, s[4:7], s28 offen sc0 sc1
  v_add_f32 v83, v83, v91
  s_waitcnt lgkmcnt(0)
  v_mfma_f32_16x16x32_bf16 v[76:79], v[144:147], v[128:131], v[76:79]
  v_add_f32 v80, v80, v96
  v_add_f32 v81, v81, v97
  v_mfma_f32_16x16x32_bf16 v[76:79], v[160:163], v[132:135], v[76:79]
  buffer_load_dwordx4 v[52:55], v7, s[4:7], s57 offen offset:256 sc1
  v_add_f32 v82, v82, v98
  v_mfma_f32_16x16x32_bf16 v[76:79], v[176:179], v[136:139], v[76:79]
  ds_write_b128 v105, v[84:87] offset:1024
  v_add_f32 v83, v83, v99
  v_fma_f32 v80, v80, v116, v108
  v_mfma_f32_16x16x32_bf16 v[76:79], v[192:195], v[16:19], v[76:79]
  v_fma_f32 v81, v81, v116, v109
  v_fma_f32 v82, v82, v116, v110
  v_mfma_f32_16x16x32_bf16 v[76:79], v[208:211], v[20:23], v[76:79]
  ds_write_b128 v106, v[92:95] offset:3072
  v_fma_f32 v83, v83, v116, v111
  v_fma_f32 v72, v72, v116, v80
  v_mfma_f32_16x16x32_bf16 v[76:79], v[224:227], v[24:27], v[76:79]
  v_fma_f32 v73, v73, v116, v81
  v_fma_f32 v74, v74, v116, v82
  v_mfma_f32_16x16x32_bf16 v[76:79], v[240:243], v[28:31], v[76:79]
  ds_write_b128 v107, v[100:103] offset:5120
  v_fma_f32 v75, v75, v116, v83
  v_cvt_pk_bf16_f32 v8, v72, v73
  v_cvt_pk_bf16_f32 v9, v74, v75
  s_waitcnt vmcnt(11)
  v_mfma_f32_16x16x32_bf16 v[80:83], a[196:199], v[48:51], 0
  s_waitcnt lgkmcnt(0)
  s_barrier
  s_waitcnt vmcnt(7)
  v_mfma_f32_16x16x32_bf16 v[88:91], a[200:203], v[48:51], 0
  ds_read_b128 v[84:87], v104 offset:1024
  v_cmp_ne_u32 vcc, 0, v123
  s_cbranch_vccnz prb_18_b
prb_18_ok:
  v_mfma_f32_16x16x32_bf16 v[96:99], a[204:207], v[48:51], 0
  buffer_load_dwordx4 v104, s[4:7], s9 offen sc1 lds
  v_mfma_f32_16x16x32_bf16 v[72:75], a[192:195], v[48:51], 0
  ds_read_b128 v[92:95], v104 offset:3072
  v_mfma_f32_16x16x32_bf16 v[80:83], a[212:215], v[60:63], v[80:83]
  buffer_load_dwordx4 v[56:59], v7, s[4:7], s57 offen offset:2048 sc1
  s_add_u32 s57, s57, 4096
  v_mfma_f32_16x16x32_bf16 v[88:91], a[216:219], v[60:63], v[88:91]
  ds_read_b128 v[100:103], v104 offset:5120
  s_waitcnt lgkmcnt(1)
  v_add_f32 v84, v84, v92
  v_mfma_f32_16x16x32_bf16 v[96:99], a[220:223], v[60:63], v[96:99]
  buffer_load_dwordx4 v[128:131], v7, s[4:7], s57 offen offset:0 sc1
  v_add_f32 v85, v85, v93
  v_mfma_f32_16x16x32_bf16 v[72:75], a[208:211], v[60:63], v[72:75]
  v_add_f32 v86, v86, v94
  v_add_f32 v87, v87, v95
  s_waitcnt lgkmcnt(0)
  v_mfma_f32_16x16x32_bf16 v[80:83], a[228:231], v[124:127], v[80:83]
  buffer_load_dwordx4 v[132:135], v7, s[4:7], s57 offen offset:2048 sc1
  s_add_u32 s57, s57, 12288
  v_mfma_f32_16x16x32_bf16 v[88:91], a[232:235], v[124:127], v[88:91]
  v_add_f32 v84, v84, v100
  v_add_f32 v85, v85, v101
  v_mfma_f32_16x16x32_bf16 v[96:99], a[236:239], v[124:127], v[96:99]
  buffer_load_dwordx4 v[136:139], v7, s[4:7], s57 offen offset:0 sc1
  v_add_f32 v86, v86, v102
  v_mfma_f32_16x16x32_bf16 v[72:75], a[224:227], v[124:127], v[72:75]
  v_add_f32 v87, v87, v103
  v_fma_f32 v84, v84, v117, v112
  v_mfma_f32_16x16x32_bf16 v[80:83], a[244:247], v[68:71], v[80:83]
  buffer_load_dwordx4 v[16:19], v7, s[4:7], s57 offen offset:2048 sc1
  s_add_u32 s57, s57, 4096
  v_mfma_f32_16x16x32_bf16 v[88:91], a[248:251], v[68:71], v[88:91]
  v_fma_f32 v85, v85, v117, v113
  v_fma_f32 v86, v86, v117, v114
  v_mfma_f32_16x16x32_bf16 v[96:99], a[252:255], v[68:71], v[96:99]
  v_fma_f32 v87, v87, v117, v115
  v_fma_f32 v76, v76, v117, v84
  v_mfma_f32_16x16x32_bf16 v[72:75], a[240:243], v[68:71], v[72:75]
  buffer_load_dwordx4 v[20:23], v7, s[4:7], s57 offen offset:0 sc1
  s_add_u32 s57, s57, -20480
  s_waitcnt vmcnt(13)
  v_mfma_f32_16x16x32_bf16 v[80:83], v[148:151], v[32:35], v[80:83]
  v_fma_f32 v77, v77, v117, v85
  v_fma_f32 v78, v78, v117, v86
  v_mfma_f32_16x16x32_bf16 v[88:91], v[152:155], v[32:35], v[88:91]
  v_fma_f32 v79, v79, v117, v87
  v_cvt_pk_bf16_f32 v10, v76, v77
  v_mfma_f32_16x16x32_bf16 v[96:99], v[156:159], v[32:35], v[96:99]
  buffer_load_dwordx4 v[24:27], v7, s[4:7], s57 offen offset:2304 sc1
  s_add_u32 s57, s57, 4096
  v_mfma_f32_16x16x32_bf16 v[72:75], v[144:147], v[32:35], v[72:75]
  v_cvt_pk_bf16_f32 v11, v78, v79
  s_waitcnt vmcnt(13)
  v_mfma_f32_16x16x32_bf16 v[84:87], a[196:199], v[36:39], 0
  v_and_b32 v104, 63, v0
  s_lshl_b32 s51, s3, 13
  v_mfma_f32_16x16x32_bf16 v[92:95], a[200:203], v[36:39], 0
  buffer_load_dwordx4 v[28:31], v7, s[4:7], s57 offen offset:256 sc1
  v_mfma_f32_16x16x32_bf16 v[100:103], a[204:207], v[36:39], 0
  s_add_u32 s51, s51, 65536
  v_lshl_add_u32 v104, v104, 4, s51
  v_mfma_f32_16x16x32_bf16 v[76:79], a[192:195], v[36:39], 0
  v_xor_b32 v105, 8192, v104
  s_waitcnt vmcnt(13)
  v_mfma_f32_16x16x32_bf16 v[84:87], a[212:215], v[64:67], v[84:87]
  buffer_load_dwordx4 v[48:51], v7, s[4:7], s57 offen offset:2304 sc1
  s_add_u32 s57, s57, 12288
  v_mfma_f32_16x16x32_bf16 v[92:95], a[216:219], v[64:67], v[92:95]
  v_xor_b32 v106, 16384, v104
  v_xor_b32 v107, 24576, v104
  v_mfma_f32_16x16x32_bf16 v[100:103], a[220:223], v[64:67], v[100:103]
  v_lshlrev_b32 v108, 16, v12
  v_and_b32 v109, 0xffff0000, v12
  v_mfma_f32_16x16x32_bf16 v[76:79], a[208:211], v[64:67], v[76:79]
  buffer_load_dwordx4 v[60:63], v7, s[4:7], s57 offen offset:256 sc1
  s_waitcnt vmcnt(14)
  v_mfma_f32_16x16x32_bf16 v[84:87], a[228:231], v[40:43], v[84:87]
  v_lshlrev_b32 v110, 16, v13
  v_and_b32 v111, 0xffff0000, v13
  v_mfma_f32_16x16x32_bf16 v[92:95], a[232:235], v[40:43], v[92:95]
  v_lshlrev_b32 v112, 16, v14
  v_and_b32 v113, 0xffff0000, v14
  v_mfma_f32_16x16x32_bf16 v[100:103], a[236:239], v[40:43], v[100:103]
  buffer_load_dwordx4 v[124:127], v7, s[4:7], s57 offen offset:2304 sc1
  s_add_u32 s57, s57, 4096
  v_mfma_f32_16x16x32_bf16 v[76:79], a[224:227], v[40:43], v[76:79]
  v_lshlrev_b32 v114, 16, v15
  s_waitcnt vmcnt(14)
  v_mfma_f32_16x16x32_bf16 v[84:87], a[244:247], v[44:47], v[84:87]
  v_and_b32 v115, 0xffff0000, v15
  s_lshl_b32 s51, s34, 8
  v_mfma_f32_16x16x32_bf16 v[92:95], a[248:251], v[44:47], v[92:95]
  buffer_load_dwordx4 v[68:71], v7, s[4:7], s57 offen offset:256 sc1
  v_mfma_f32_16x16x32_bf16 v[100:103], a[252:255], v[44:47], v[100:103]
  s_add_u32 s51, s51, 159236
  v_and_b32 v117, 31, v0
  v_mfma_f32_16x16x32_bf16 v[76:79], a[240:243], v[44:47], v[76:79]
  v_lshl_add_u32 v117, v117, 3, s51
  s_waitcnt vmcnt(13)
  v_mfma_f32_16x16x32_bf16 v[84:87], v[148:151], v[52:55], v[84:87]
  ds_read_b32 v117, v117
  v_mfma_f32_16x16x32_bf16 v[92:95], v[152:155], v[52:55], v[92:95]
  buffer_store_dwordx2 v[8:9], v142, s[12:15], s58 offen
  v_mfma_f32_16x16x32_bf16 v[100:103], v[156:159], v[52:55], v[100:103]
  v_mfma_f32_16x16x32_bf16 v[76:79], v[144:147], v[52:55], v[76:79]
  buffer_store_dwordx2 v[10:11], v142, s[12:15], s59 offen
  s_waitcnt vmcnt(13)
  v_mfma_f32_16x16x32_bf16 v[80:83], v[164:167], v[56:59], v[80:83]
  s_waitcnt lgkmcnt(0)
  v_mul_f32 v117, v117, v117
  s_add_u32 s58, s58, 1048576
  v_mfma_f32_16x16x32_bf16 v[88:91], v[168:171], v[56:59], v[88:91]
  ds_read_b128 v[32:35], v104 offset:6144
  s_add_u32 s59, s59, 1048576
  v_mfma_f32_16x16x32_bf16 v[96:99], v[172:175], v[56:59], v[96:99]
  s_waitcnt vmcnt(12)
  v_mfma_f32_16x16x32_bf16 v[80:83], v[180:183], v[128:131], v[80:83]
  v_mfma_f32_16x16x32_bf16 v[88:91], v[184:187], v[128:131], v[88:91]
  v_mfma_f32_16x16x32_bf16 v[96:99], v[188:191], v[128:131], v[96:99]
  s_waitcnt vmcnt(11)
  v_mfma_f32_16x16x32_bf16 v[80:83], v[196:199], v[132:135], v[80:83]
  v_mfma_f32_16x16x32_bf16 v[88:91], v[200:203], v[132:135], v[88:91]
  s_waitcnt lgkmcnt(0)
  v_add_f32 v32, v32, v33
  v_add_f32 v34, v34, v35
  v_mfma_f32_16x16x32_bf16 v[96:99], v[204:207], v[132:135], v[96:99]
  v_add_f32 v33, v32, v34
  v_add_f32 v32, v32, v34
  s_waitcnt vmcnt(10)
  v_mfma_f32_16x16x32_bf16 v[80:83], v[212:215], v[136:139], v[80:83]
  v_permlane32_swap_b32 v32, v33
  v_add_f32 v116, v32, v33
  v_mfma_f32_16x16x32_bf16 v[88:91], v[216:219], v[136:139], v[88:91]
  v_fma_f32 v116, v116, s46, -v117
  v_max_f32 v116, 0, v116
  v_mfma_f32_16x16x32_bf16 v[96:99], v[220:223], v[136:139], v[96:99]
  v_cvt_pk_bf16_f32 v116, 0, v116
  v_add_f32 v116, s48, v116
  s_waitcnt vmcnt(9)
  v_mfma_f32_16x16x32_bf16 v[80:83], v[228:231], v[16:19], v[80:83]
  v_cvt_pk_bf16_f32 v116, 0, v116
  v_mfma_f32_16x16x32_bf16 v[88:91], v[232:235], v[16:19], v[88:91]
  v_sqrt_f32 v116, v116
  s_nop 0
  v_cvt_pk_bf16_f32 v116, 0, v116
  v_mfma_f32_16x16x32_bf16 v[96:99], v[236:239], v[16:19], v[96:99]
  v_mul_f32 v116, v116, v116
  s_waitcnt vmcnt(8)
  v_mfma_f32_16x16x32_bf16 v[80:83], v[244:247], v[20:23], v[80:83]
  v_rcp_f32 v116, v116
  s_nop 0
  v_mov_b32 v117, v116
  v_mfma_f32_16x16x32_bf16 v[88:91], v[248:251], v[20:23], v[88:91]
  s_nop 0
  v_permlane16_swap_b32 v116, v117
  v_mfma_f32_16x16x32_bf16 v[96:99], v[252:255], v[20:23], v[96:99]
wpad_0_9:
  s_cbranch_execz wret_0
  s_waitcnt vmcnt(7)
  v_mfma_f32_16x16x32_bf16 v[84:87], v[164:167], v[24:27], v[84:87]
  v_cmp_u_f32 vcc, v80, v80
  s_cbranch_vccnz redo_20_s
redo_20_ok:
  v_mfma_f32_16x16x32_bf16 v[92:95], v[168:171], v[24:27], v[92:95]
  v_mfma_f32_16x16x32_bf16 v[100:103], v[172:175], v[24:27], v[100:103]
  ds_write_b128 v105, v[80:83] offset:0
  s_waitcnt vmcnt(6)
  v_mfma_f32_16x16x32_bf16 v[84:87], v[180:183], v[28:31], v[84:87]
  v_mfma_f32_16x16x32_bf16 v[92:95], v[184:187], v[28:31], v[92:95]
  ds_write_b128 v106, v[88:91] offset:2048
  v_mfma_f32_16x16x32_bf16 v[100:103], v[188:191], v[28:31], v[100:103]
  s_waitcnt vmcnt(5)
  v_mfma_f32_16x16x32_bf16 v[84:87], v[196:199], v[48:51], v[84:87]
  ds_write_b128 v107, v[96:99] offset:4096
  v_mfma_f32_16x16x32_bf16 v[92:95], v[200:203], v[48:51], v[92:95]
  v_mfma_f32_16x16x32_bf16 v[100:103], v[204:207], v[48:51], v[100:103]
  s_waitcnt vmcnt(4)
  v_mfma_f32_16x16x32_bf16 v[84:87], v[212:215], v[60:63], v[84:87]
  v_mfma_f32_16x16x32_bf16 v[92:95], v[216:219], v[60:63], v[92:95]
  s_waitcnt lgkmcnt(0)
  s_barrier
  v_mfma_f32_16x16x32_bf16 v[100:103], v[220:223], v[60:63], v[100:103]
  ds_read_b128 v[80:83], v104 offset:0
  s_waitcnt vmcnt(3)
  v_mfma_f32_16x16x32_bf16 v[84:87], v[228:231], v[124:127], v[84:87]
  ds_read_b128 v[88:91], v104 offset:2048
  v_mfma_f32_16x16x32_bf16 v[92:95], v[232:235], v[124:127], v[92:95]
  ds_read_b128 v[96:99], v104 offset:4096
  v_mfma_f32_16x16x32_bf16 v[100:103], v[236:239], v[124:127], v[100:103]
  s_waitcnt vmcnt(2)
  v_mfma_f32_16x16x32_bf16 v[84:87], v[244:247], v[68:71], v[84:87]
  v_mfma_f32_16x16x32_bf16 v[92:95], v[248:251], v[68:71], v[92:95]
  v_mfma_f32_16x16x32_bf16 v[100:103], v[252:255], v[68:71], v[100:103]
  v_mfma_f32_16x16x32_bf16 v[72:75], v[160:163], v[56:59], v[72:75]
  s_waitcnt lgkmcnt(1)
  v_add_f32 v80, v80, v88
  v_add_f32 v81, v81, v89
  v_mfma_f32_16x16x32_bf16 v[72:75], v[176:179], v[128:131], v[72:75]
  v_add_f32 v82, v82, v90
  v_add_f32 v83, v83, v91
  s_waitcnt lgkmcnt(0)
  v_cmp_u_f32 vcc, v84, v84
  v_mfma_f32_16x16x32_bf16 v[72:75], v[192:195], v[132:135], v[72:75]
  v_add_f32 v80, v80, v96
  v_add_f32 v81, v81, v97
  s_cbranch_vccnz redo_21_s
redo_21_ok:
  v_mfma_f32_16x16x32_bf16 v[72:75], v[208:211], v[136:139], v[72:75]
  ds_write_b128 v105, v[84:87] offset:1024
  v_add_f32 v82, v82, v98
  v_add_f32 v83, v83, v99
  v_mfma_f32_16x16x32_bf16 v[72:75], v[224:227], v[16:19], v[72:75]
  ds_write_b128 v106, v[92:95] offset:3072
  v_fma_f32 v80, v80, v116, v108
  v_fma_f32 v81, v81, v116, v109
  v_mfma_f32_16x16x32_bf16 v[72:75], v[240:243], v[20:23], v[72:75]
  v_fma_f32 v82, v82, v116, v110
  v_fma_f32 v83, v83, v116, v111
  v_mfma_f32_16x16x32_bf16 v[76:79], v[160:163], v[24:27], v[76:79]
  ds_write_b128 v107, v[100:103] offset:5120
  v_mfma_f32_16x16x32_bf16 v[76:79], v[176:179], v[28:31], v[76:79]
  v_mfma_f32_16x16x32_bf16 v[76:79], v[192:195], v[48:51], v[76:79]
  v_mfma_f32_16x16x32_bf16 v[76:79], v[208:211], v[60:63], v[76:79]
  s_nop 0
  v_fma_f32 v72, v72, v116, v80
  v_fma_f32 v73, v73, v116, v81
  v_mfma_f32_16x16x32_bf16 v[76:79], v[224:227], v[124:127], v[76:79]
  s_waitcnt lgkmcnt(0)
  s_barrier
  v_fma_f32 v74, v74, v116, v82
  v_mfma_f32_16x16x32_bf16 v[76:79], v[240:243], v[68:71], v[76:79]
  ds_read_b128 v[84:87], v104 offset:1024
  v_fma_f32 v75, v75, v116, v83
  v_cvt_pk_bf16_f32 v80, v72, v73
  ds_read_b128 v[92:95], v104 offset:3072
  ds_read_b128 v[100:103], v104 offset:5120
  v_cvt_pk_bf16_f32 v81, v74, v75
  buffer_store_dwordx2 v[80:81], v142, s[12:15], s58 offen
  s_waitcnt lgkmcnt(1)
  v_pk_add_f32 v[84:85], v[84:85], v[92:93]
  v_pk_add_f32 v[86:87], v[86:87], v[94:95]
  s_waitcnt lgkmcnt(0)
  v_pk_add_f32 v[84:85], v[84:85], v[100:101]
  v_pk_add_f32 v[86:87], v[86:87], v[102:103]
  v_pk_fma_f32 v[84:85], v[84:85], v[116:117], v[112:113] op_sel:[0,1,0] op_sel_hi:[1,1,1]
  v_pk_fma_f32 v[86:87], v[86:87], v[116:117], v[114:115] op_sel:[0,1,0] op_sel_hi:[1,1,1]
  v_pk_fma_f32 v[76:77], v[76:77], v[116:117], v[84:85] op_sel:[0,1,0] op_sel_hi:[1,1,1]
  v_pk_fma_f32 v[78:79], v[78:79], v[116:117], v[86:87] op_sel:[0,1,0] op_sel_hi:[1,1,1]
  v_cvt_pk_bf16_f32 v82, v76, v77
  v_cvt_pk_bf16_f32 v83, v78, v79
  buffer_store_dwordx2 v[82:83], v142, s[12:15], s59 offen
mega_end:
  s_endpgm
dpoll0_s:
  s_mov_b32 s56, 0
dpoll0_c:
  s_mov_b64 exec, 15
  v_mov_b32 v5, 0
  buffer_atomic_add v5, v3, s[4:7], s37 offen sc0 sc1
  s_mov_b64 exec, -1
  s_add_u32 s56, s56, 1
  s_and_b32 s55, s56, 7
  s_cbranch_scc1 dpoll0_n
  v_lshlrev_b32 v144, 8, v0
  buffer_load_dword v144, v144, s[96:99], 0 offen sc1
  s_waitcnt vmcnt(0)
  v_cmp_ne_u32 vcc, 0, v144
  s_cbranch_vccnz dpoll0_ok
dpoll0_n:
  s_waitcnt vmcnt(0)
  v_sub_u32 v144, v5, v142
  v_and_b32 v145, 0xff, v144
  v_cmp_ne_u32 vcc, v143, v145
  s_and_b32 s55, vcc_lo, 15
  s_cbranch_scc0 dpoll0_ok
  s_cmp_lt_u32 s56, 0x8000
  s_cbranch_scc1 dpoll0_c
  s_branch dpoll0_ok
dpoll1_s:
  s_mov_b32 s56, 0
dpoll1_c:
  s_mov_b64 exec, 240
  v_mov_b32 v5, 0
  buffer_atomic_add v5, v3, s[4:7], s37 offen sc0 sc1
  s_mov_b64 exec, -1
  s_add_u32 s56, s56, 1
  s_and_b32 s55, s56, 7
  s_cbranch_scc1 dpoll1_n
  v_lshlrev_b32 v144, 8, v0
  buffer_load_dword v144, v144, s[96:99], 0 offen sc1
  s_waitcnt vmcnt(0)
  v_cmp_ne_u32 vcc, 0, v144
  s_cbranch_vccnz dpoll1_ok
dpoll1_n:
  s_waitcnt vmcnt(0)
  v_sub_u32 v144, v5, v142
  v_and_b32 v145, 0xff, v144
  v_cmp_ne_u32 vcc, v143, v145
  s_and_b32 s55, vcc_lo, 240
  s_cbranch_scc0 dpoll1_ok
  s_cmp_lt_u32 s56, 0x8000
  s_cbranch_scc1 dpoll1_c
  s_branch dpoll1_ok
poll_2_s:
  s_mov_b32 s56, 0
poll_2_c:
  s_cmp_lg_u32 s56, 12
  s_cbranch_scc1 poll_2_h
  s_waitcnt vmcnt(0)
  v_lshlrev_b32 v5, 8, v0
  v_mov_b32 v4, s37
  buffer_store_dword v4, v5, s[96:99], 0 offen sc1
  s_waitcnt vmcnt(0)
  v_mov_b32 v5, 1
  v_mov_b32 v4, 1
poll_2_h:
  v_mov_b32 v5, 0
  buffer_atomic_add v5, v3, s[4:7], s40 offen sc0 sc1
  s_add_u32 s56, s56, 1
  s_waitcnt vmcnt(0)
  v_cmp_ne_u32 vcc, 0, v5
  s_cbranch_vccz poll_2_ok
  s_cmp_lt_u32 s56, 0x10000
  s_cbranch_scc1 poll_2_c
  s_branch poll_2_ok
poll_4_s:
  s_mov_b32 s56, 0
poll_4_c:
  v_mov_b32 v5, 0
  buffer_atomic_add v5, v3, s[4:7], s28 offen sc0 sc1
  s_add_u32 s56, s56, 1
  s_waitcnt vmcnt(0)
  v_cmp_ne_u32 vcc, 0, v5
  s_cbranch_vccz poll_4_ok
  s_cmp_lt_u32 s56, 0x10000
  s_cbranch_scc1 poll_4_c
  s_branch poll_4_ok
poll_5_s:
  s_mov_b32 s56, 0
poll_5_c:
  v_mov_b32 v5, 0
  buffer_atomic_add v5, v2, s[4:7], s41 offen sc0 sc1
  s_add_u32 s56, s56, 1
  s_waitcnt vmcnt(0)
  v_cmp_ne_u32 vcc, 0, v5
  s_cbranch_vccz poll_5_ok
  s_cmp_lt_u32 s56, 0x10000
  s_cbranch_scc1 poll_5_c
  s_branch poll_5_ok
prb_6_s:
  s_mov_b32 s56, 0
prb_6_c:
  s_mov_b64 exec, vcc
  v_mov_b32 v5, 0
  buffer_atomic_add v5, v6, s[4:7], s28 offen sc0 sc1
  s_add_u32 s56, s56, 1
  s_waitcnt vmcnt(0)
  v_cmp_ne_u32 vcc, 0, v5
  s_mov_b64 exec, -1
  s_cbranch_vccz prb_6_ok
  s_cmp_lt_u32 s56, 0x8000
  s_cbranch_scc1 prb_6_c
  s_branch prb_6_ok
prb_7_s:
  s_mov_b32 s56, 0
prb_7_c:
  s_mov_b64 exec, vcc
  v_mov_b32 v5, 0
  buffer_atomic_add v5, v6, s[4:7], s28 offen sc0 sc1
  s_add_u32 s56, s56, 1
  s_waitcnt vmcnt(0)
  v_cmp_lt_u32 vcc, 16, v5
  s_mov_b64 exec, -1
  s_cbranch_vccz prb_7_ok
  s_cmp_lt_u32 s56, 0x8000
  s_cbranch_scc1 prb_7_c
  s_branch prb_7_ok
prb_6_b:
  s_waitcnt vmcnt(3)
  v_cmp_ne_u32 vcc, 0, v5
  s_cbranch_vccz prb_6_ok
  s_branch prb_6_s
redo_9_s:
  s_mov_b32 s56, 0
redo_9_c:
  s_lshl_b32 s57, s34, 18
  s_add_u32 s57, s57, s39
  s_add_u32 s57, s57, 4194304
  s_mul_i32 s55, s3, 49152
  s_add_u32 s57, s57, s55
  buffer_load_dwordx4 v[52:55], v7, s[4:7], s57 offen offset:0 sc1
  buffer_load_dwordx4 v[44:47], v7, s[4:7], s57 offen offset:2048 sc1
  s_add_u32 s57, s57, 4096
  buffer_load_dwordx4 v[40:43], v7, s[4:7], s57 offen offset:0 sc1
  buffer_load_dwordx4 v[64:67], v7, s[4:7], s57 offen offset:2048 sc1
  s_add_u32 s57, s57, 12288
  buffer_load_dwordx4 v[36:39], v7, s[4:7], s57 offen offset:0 sc1
  buffer_load_dwordx4 v[56:59], v7, s[4:7], s57 offen offset:2048 sc1
  s_add_u32 s57, s57, 4096
  buffer_load_dwordx4 v[128:131], v7, s[4:7], s57 offen offset:0 sc1
  buffer_load_dwordx4 v[132:135], v7, s[4:7], s57 offen offset:2048 sc1
  s_add_u32 s57, s57, 12288
  buffer_load_dwordx4 v[136:139], v7, s[4:7], s57 offen offset:0 sc1
  buffer_load_dwordx4 v[16:19], v7, s[4:7], s57 offen offset:2048 sc1
  s_add_u32 s57, s57, 4096
  buffer_load_dwordx4 v[20:23], v7, s[4:7], s57 offen offset:0 sc1
  s_waitcnt vmcnt(0)
  v_mfma_f32_16x16x32_bf16 v[80:83], a[196:199], v[52:55], 0
  v_mfma_f32_16x16x32_bf16 v[88:91], a[200:203], v[52:55], 0
  v_mfma_f32_16x16x32_bf16 v[96:99], a[204:207], v[52:55], 0
  v_mfma_f32_16x16x32_bf16 v[72:75], a[192:195], v[52:55], 0
  v_mfma_f32_16x16x32_bf16 v[80:83], a[212:215], v[44:47], v[80:83]
  v_mfma_f32_16x16x32_bf16 v[88:91], a[216:219], v[44:47], v[88:91]
  v_mfma_f32_16x16x32_bf16 v[96:99], a[220:223], v[44:47], v[96:99]
  v_mfma_f32_16x16x32_bf16 v[72:75], a[208:211], v[44:47], v[72:75]
  v_mfma_f32_16x16x32_bf16 v[80:83], a[228:231], v[40:43], v[80:83]
  v_mfma_f32_16x16x32_bf16 v[88:91], a[232:235], v[40:43], v[88:91]
  v_mfma_f32_16x16x32_bf16 v[96:99], a[236:239], v[40:43], v[96:99]
  v_mfma_f32_16x16x32_bf16 v[72:75], a[224:227], v[40:43], v[72:75]
  v_mfma_f32_16x16x32_bf16 v[80:83], a[244:247], v[64:67], v[80:83]
  v_mfma_f32_16x16x32_bf16 v[88:91], a[248:251], v[64:67], v[88:91]
  v_mfma_f32_16x16x32_bf16 v[96:99], a[252:255], v[64:67], v[96:99]
  v_mfma_f32_16x16x32_bf16 v[72:75], a[240:243], v[64:67], v[72:75]
  v_mfma_f32_16x16x32_bf16 v[80:83], v[148:151], v[36:39], v[80:83]
  v_mfma_f32_16x16x32_bf16 v[88:91], v[152:155], v[36:39], v[88:91]
  v_mfma_f32_16x16x32_bf16 v[96:99], v[156:159], v[36:39], v[96:99]
  v_mfma_f32_16x16x32_bf16 v[72:75], v[144:147], v[36:39], v[72:75]
  v_mfma_f32_16x16x32_bf16 v[80:83], v[164:167], v[56:59], v[80:83]
  v_mfma_f32_16x16x32_bf16 v[88:91], v[168:171], v[56:59], v[88:91]
  v_mfma_f32_16x16x32_bf16 v[96:99], v[172:175], v[56:59], v[96:99]
  v_mfma_f32_16x16x32_bf16 v[80:83], v[180:183], v[128:131], v[80:83]
  v_mfma_f32_16x16x32_bf16 v[88:91], v[184:187], v[128:131], v[88:91]
  v_mfma_f32_16x16x32_bf16 v[96:99], v[188:191], v[128:131], v[96:99]
  v_mfma_f32_16x16x32_bf16 v[80:83], v[196:199], v[132:135], v[80:83]
  v_mfma_f32_16x16x32_bf16 v[88:91], v[200:203], v[132:135], v[88:91]
  v_mfma_f32_16x16x32_bf16 v[96:99], v[204:207], v[132:135], v[96:99]
  v_mfma_f32_16x16x32_bf16 v[80:83], v[212:215], v[136:139], v[80:83]
  v_mfma_f32_16x16x32_bf16 v[88:91], v[216:219], v[136:139], v[88:91]
  v_mfma_f32_16x16x32_bf16 v[96:99], v[220:223], v[136:139], v[96:99]
  v_mfma_f32_16x16x32_bf16 v[80:83], v[228:231], v[16:19], v[80:83]
  v_mfma_f32_16x16x32_bf16 v[88:91], v[232:235], v[16:19], v[88:91]
  v_mfma_f32_16x16x32_bf16 v[96:99], v[236:239], v[16:19], v[96:99]
  v_mfma_f32_16x16x32_bf16 v[80:83], v[244:247], v[20:23], v[80:83]
  v_mfma_f32_16x16x32_bf16 v[88:91], v[248:251], v[20:23], v[88:91]
  v_mfma_f32_16x16x32_bf16 v[96:99], v[252:255], v[20:23], v[96:99]
  s_add_u32 s56, s56, 1
  s_nop 7
  v_cmp_u_f32 vcc, v80, v80
  s_cbranch_vccz redo_9_ok
  s_cmp_lt_u32 s56, 16
  s_cbranch_scc1 redo_9_c
  s_branch redo_9_ok
redo_10_s:
  s_mov_b32 s56, 0
redo_10_c:
  s_lshl_b32 s57, s34, 18
  s_add_u32 s57, s57, s39
  s_add_u32 s57, s57, 4194304
  s_mul_i32 s55, s3, 49152
  s_add_u32 s57, s57, s55
  buffer_load_dwordx4 v[132:135], v7, s[4:7], s57 offen offset:256 sc1
  buffer_load_dwordx4 v[128:131], v7, s[4:7], s57 offen offset:2304 sc1
  s_add_u32 s57, s57, 4096
  buffer_load_dwordx4 v[56:59], v7, s[4:7], s57 offen offset:256 sc1
  buffer_load_dwordx4 v[52:55], v7, s[4:7], s57 offen offset:2304 sc1
  s_add_u32 s57, s57, 12288
  buffer_load_dwordx4 v[44:47], v7, s[4:7], s57 offen offset:256 sc1
  buffer_load_dwordx4 v[24:27], v7, s[4:7], s57 offen offset:2304 sc1
  s_add_u32 s57, s57, 4096
  buffer_load_dwordx4 v[28:31], v7, s[4:7], s57 offen offset:256 sc1
  buffer_load_dwordx4 v[48:51], v7, s[4:7], s57 offen offset:2304 sc1
  s_add_u32 s57, s57, 12288
  buffer_load_dwordx4 v[60:63], v7, s[4:7], s57 offen offset:256 sc1
  buffer_load_dwordx4 v[124:127], v7, s[4:7], s57 offen offset:2304 sc1
  s_add_u32 s57, s57, 4096
  buffer_load_dwordx4 v[68:71], v7, s[4:7], s57 offen offset:256 sc1
  s_waitcnt vmcnt(0)
  v_mfma_f32_16x16x32_bf16 v[84:87], a[196:199], v[132:135], 0
  v_mfma_f32_16x16x32_bf16 v[92:95], a[200:203], v[132:135], 0
  v_mfma_f32_16x16x32_bf16 v[100:103], a[204:207], v[132:135], 0
  v_mfma_f32_16x16x32_bf16 v[76:79], a[192:195], v[132:135], 0
  v_mfma_f32_16x16x32_bf16 v[84:87], a[212:215], v[128:131], v[84:87]
  v_mfma_f32_16x16x32_bf16 v[92:95], a[216:219], v[128:131], v[92:95]
  v_mfma_f32_16x16x32_bf16 v[100:103], a[220:223], v[128:131], v[100:103]
  v_mfma_f32_16x16x32_bf16 v[76:79], a[208:211], v[128:131], v[76:79]
  v_mfma_f32_16x16x32_bf16 v[84:87], a[228:231], v[56:59], v[84:87]
  v_mfma_f32_16x16x32_bf16 v[92:95], a[232:235], v[56:59], v[92:95]
  v_mfma_f32_16x16x32_bf16 v[100:103], a[236:239], v[56:59], v[100:103]
  v_mfma_f32_16x16x32_bf16 v[76:79], a[224:227], v[56:59], v[76:79]
  v_mfma_f32_16x16x32_bf16 v[84:87], a[244:247], v[52:55], v[84:87]
  v_mfma_f32_16x16x32_bf16 v[92:95], a[248:251], v[52:55], v[92:95]
  v_mfma_f32_16x16x32_bf16 v[100:103], a[252:255], v[52:55], v[100:103]
  v_mfma_f32_16x16x32_bf16 v[76:79], a[240:243], v[52:55], v[76:79]
  v_mfma_f32_16x16x32_bf16 v[84:87], v[148:151], v[44:47], v[84:87]
  v_mfma_f32_16x16x32_bf16 v[92:95], v[152:155], v[44:47], v[92:95]
  v_mfma_f32_16x16x32_bf16 v[100:103], v[156:159], v[44:47], v[100:103]
  v_mfma_f32_16x16x32_bf16 v[76:79], v[144:147], v[44:47], v[76:79]
  v_mfma_f32_16x16x32_bf16 v[84:87], v[164:167], v[24:27], v[84:87]
  v_mfma_f32_16x16x32_bf16 v[92:95], v[168:171], v[24:27], v[92:95]
  v_mfma_f32_16x16x32_bf16 v[100:103], v[172:175], v[24:27], v[100:103]
  v_mfma_f32_16x16x32_bf16 v[84:87], v[180:183], v[28:31], v[84:87]
  v_mfma_f32_16x16x32_bf16 v[92:95], v[184:187], v[28:31], v[92:95]
  v_mfma_f32_16x16x32_bf16 v[100:103], v[188:191], v[28:31], v[100:103]
  v_mfma_f32_16x16x32_bf16 v[84:87], v[196:199], v[48:51], v[84:87]
  v_mfma_f32_16x16x32_bf16 v[92:95], v[200:203], v[48:51], v[92:95]
  v_mfma_f32_16x16x32_bf16 v[100:103], v[204:207], v[48:51], v[100:103]
  v_mfma_f32_16x16x32_bf16 v[84:87], v[212:215], v[60:63], v[84:87]
  v_mfma_f32_16x16x32_bf16 v[92:95], v[216:219], v[60:63], v[92:95]
  v_mfma_f32_16x16x32_bf16 v[100:103], v[220:223], v[60:63], v[100:103]
  v_mfma_f32_16x16x32_bf16 v[84:87], v[228:231], v[124:127], v[84:87]
  v_mfma_f32_16x16x32_bf16 v[92:95], v[232:235], v[124:127], v[92:95]
  v_mfma_f32_16x16x32_bf16 v[100:103], v[236:239], v[124:127], v[100:103]
  v_mfma_f32_16x16x32_bf16 v[84:87], v[244:247], v[68:71], v[84:87]
  v_mfma_f32_16x16x32_bf16 v[92:95], v[248:251], v[68:71], v[92:95]
  v_mfma_f32_16x16x32_bf16 v[100:103], v[252:255], v[68:71], v[100:103]
  s_add_u32 s56, s56, 1
  s_nop 7
  v_cmp_u_f32 vcc, v84, v84
  s_cbranch_vccz redo_10_ok
  s_cmp_lt_u32 s56, 16
  s_cbranch_scc1 redo_10_c
  s_branch redo_10_ok
poll_11_s:
  s_mov_b32 s56, 0
poll_11_c:
  v_mov_b32 v5, 0
  buffer_atomic_add v5, v3, s[4:7], s29 offen sc0 sc1
  s_add_u32 s56, s56, 1
  s_waitcnt vmcnt(0)
  v_cmp_ne_u32 vcc, 0, v5
  s_cbranch_vccz poll_11_ok
  s_cmp_lt_u32 s56, 0x10000
  s_cbranch_scc1 poll_11_c
  s_branch poll_11_ok
poll_13_s:
  s_mov_b32 s56, 0
poll_13_c:
  v_mov_b32 v5, 0
  buffer_atomic_add v5, v3, s[4:7], s98 offen sc0 sc1
  s_add_u32 s56, s56, 1
  s_waitcnt vmcnt(0)
  v_cmp_ne_u32 vcc, 0, v5
  s_cbranch_vccz poll_13_ok
  s_cmp_lt_u32 s56, 0x10000
  s_cbranch_scc1 poll_13_c
  s_branch poll_13_ok
poll_14_s:
  s_mov_b32 s56, 0
poll_14_c:
  v_mov_b32 v5, 0
  buffer_atomic_add v5, v3, s[4:7], s40 offen sc0 sc1
  s_add_u32 s56, s56, 1
  s_waitcnt vmcnt(0)
  v_cmp_ne_u32 vcc, 0, v5
  s_cbranch_vccz poll_14_ok
  s_cmp_lt_u32 s56, 0x10000
  s_cbranch_scc1 poll_14_c
  s_branch poll_14_ok
poll_16_s:
  s_mov_b32 s56, 0
poll_16_c:
  v_mov_b32 v5, 0
  buffer_atomic_add v5, v3, s[4:7], s28 offen sc0 sc1
  s_add_u32 s56, s56, 1
  s_waitcnt vmcnt(0)
  v_cmp_ne_u32 vcc, 0, v5
  s_cbranch_vccz poll_16_ok
  s_cmp_lt_u32 s56, 0x10000
  s_cbranch_scc1 poll_16_c
  s_branch poll_16_ok
poll_17_s:
  s_mov_b32 s56, 0
poll_17_c:
  v_mov_b32 v5, 0
  buffer_atomic_add v5, v2, s[4:7], s41 offen sc0 sc1
  s_add_u32 s56, s56, 1
  s_waitcnt vmcnt(0)
  v_cmp_ne_u32 vcc, 0, v5
  s_cbranch_vccz poll_17_ok
  s_cmp_lt_u32 s56, 0x10000
  s_cbranch_scc1 poll_17_c
  s_branch poll_17_ok
prb_18_s:
  s_mov_b32 s56, 0
prb_18_c:
  s_mov_b64 exec, vcc
  v_mov_b32 v5, 0
  buffer_atomic_add v5, v6, s[4:7], s28 offen sc0 sc1
  s_add_u32 s56, s56, 1
  s_waitcnt vmcnt(0)
  v_cmp_ne_u32 vcc, 0, v5
  s_mov_b64 exec, -1
  s_cbranch_vccz prb_18_ok
  s_cmp_lt_u32 s56, 0x8000
  s_cbranch_scc1 prb_18_c
  s_branch prb_18_ok
prb_19_s:
  s_mov_b32 s56, 0
prb_19_c:
  s_mov_b64 exec, vcc
  v_mov_b32 v5, 0
  buffer_atomic_add v5, v6, s[4:7], s28 offen sc0 sc1
  s_add_u32 s56, s56, 1
  s_waitcnt vmcnt(0)
  v_cmp_lt_u32 vcc, 16, v5
  s_mov_b64 exec, -1
  s_cbranch_vccz prb_19_ok
  s_cmp_lt_u32 s56, 0x8000
  s_cbranch_scc1 prb_19_c
  s_branch prb_19_ok
prb_18_b:
  s_waitcnt vmcnt(1)
  v_cmp_ne_u32 vcc, 0, v5
  s_cbranch_vccz prb_18_ok
  s_branch prb_18_s
redo_20_s:
  s_mov_b32 s56, 0
redo_20_c:
  s_lshl_b32 s57, s34, 18
  s_add_u32 s57, s57, s39
  s_add_u32 s57, s57, 4194304
  s_mul_i32 s55, s3, 49152
  s_add_u32 s57, s57, s55
  buffer_load_dwordx4 v[52:55], v7, s[4:7], s57 offen offset:0 sc1
  buffer_load_dwordx4 v[44:47], v7, s[4:7], s57 offen offset:2048 sc1
  s_add_u32 s57, s57, 4096
  buffer_load_dwordx4 v[40:43], v7, s[4:7], s57 offen offset:0 sc1
  buffer_load_dwordx4 v[64:67], v7, s[4:7], s57 offen offset:2048 sc1
  s_add_u32 s57, s57, 12288
  buffer_load_dwordx4 v[36:39], v7, s[4:7], s57 offen offset:0 sc1
  buffer_load_dwordx4 v[56:59], v7, s[4:7], s57 offen offset:2048 sc1
  s_add_u32 s57, s57, 4096
  buffer_load_dwordx4 v[128:131], v7, s[4:7], s57 offen offset:0 sc1
  buffer_load_dwordx4 v[132:135], v7, s[4:7], s57 offen offset:2048 sc1
  s_add_u32 s57, s57, 12288
  buffer_load_dwordx4 v[136:139], v7, s[4:7], s57 offen offset:0 sc1
  buffer_load_dwordx4 v[16:19], v7, s[4:7], s57 offen offset:2048 sc1
  s_add_u32 s57, s57, 4096
  buffer_load_dwordx4 v[20:23], v7, s[4:7], s57 offen offset:0 sc1
  s_waitcnt vmcnt(0)
  v_mfma_f32_16x16x32_bf16 v[80:83], a[196:199], v[52:55], 0
  v_mfma_f32_16x16x32_bf16 v[88:91], a[200:203], v[52:55], 0
  v_mfma_f32_16x16x32_bf16 v[96:99], a[204:207], v[52:55], 0
  v_mfma_f32_16x16x32_bf16 v[72:75], a[192:195], v[52:55], 0
  v_mfma_f32_16x16x32_bf16 v[80:83], a[212:215], v[44:47], v[80:83]
  v_mfma_f32_16x16x32_bf16 v[88:91], a[216:219], v[44:47], v[88:91]
  v_mfma_f32_16x16x32_bf16 v[96:99], a[220:223], v[44:47], v[96:99]
  v_mfma_f32_16x16x32_bf16 v[72:75], a[208:211], v[44:47], v[72:75]
  v_mfma_f32_16x16x32_bf16 v[80:83], a[228:231], v[40:43], v[80:83]
  v_mfma_f32_16x16x32_bf16 v[88:91], a[232:235], v[40:43], v[88:91]
  v_mfma_f32_16x16x32_bf16 v[96:99], a[236:239], v[40:43], v[96:99]
  v_mfma_f32_16x16x32_bf16 v[72:75], a[224:227], v[40:43], v[72:75]
  v_mfma_f32_16x16x32_bf16 v[80:83], a[244:247], v[64:67], v[80:83]
  v_mfma_f32_16x16x32_bf16 v[88:91], a[248:251], v[64:67], v[88:91]
  v_mfma_f32_16x16x32_bf16 v[96:99], a[252:255], v[64:67], v[96:99]
  v_mfma_f32_16x16x32_bf16 v[72:75], a[240:243], v[64:67], v[72:75]
  v_mfma_f32_16x16x32_bf16 v[80:83], v[148:151], v[36:39], v[80:83]
  v_mfma_f32_16x16x32_bf16 v[88:91], v[152:155], v[36:39], v[88:91]
  v_mfma_f32_16x16x32_bf16 v[96:99], v[156:159], v[36:39], v[96:99]
  v_mfma_f32_16x16x32_bf16 v[72:75], v[144:147], v[36:39], v[72:75]
  v_mfma_f32_16x16x32_bf16 v[80:83], v[164:167], v[56:59], v[80:83]
  v_mfma_f32_16x16x32_bf16 v[88:91], v[168:171], v[56:59], v[88:91]
  v_mfma_f32_16x16x32_bf16 v[96:99], v[172:175], v[56:59], v[96:99]
  v_mfma_f32_16x16x32_bf16 v[80:83], v[180:183], v[128:131], v[80:83]
  v_mfma_f32_16x16x32_bf16 v[88:91], v[184:187], v[128:131], v[88:91]
  v_mfma_f32_16x16x32_bf16 v[96:99], v[188:191], v[128:131], v[96:99]
  v_mfma_f32_16x16x32_bf16 v[80:83], v[196:199], v[132:135], v[80:83]
  v_mfma_f32_16x16x32_bf16 v[88:91], v[200:203], v[132:135], v[88:91]
  v_mfma_f32_16x16x32_bf16 v[96:99], v[204:207], v[132:135], v[96:99]
  v_mfma_f32_16x16x32_bf16 v[80:83], v[212:215], v[136:139], v[80:83]
  v_mfma_f32_16x16x32_bf16 v[88:91], v[216:219], v[136:139], v[88:91]
  v_mfma_f32_16x16x32_bf16 v[96:99], v[220:223], v[136:139], v[96:99]
  v_mfma_f32_16x16x32_bf16 v[80:83], v[228:231], v[16:19], v[80:83]
  v_mfma_f32_16x16x32_bf16 v[88:91], v[232:235], v[16:19], v[88:91]
  v_mfma_f32_16x16x32_bf16 v[96:99], v[236:239], v[16:19], v[96:99]
  v_mfma_f32_16x16x32_bf16 v[80:83], v[244:247], v[20:23], v[80:83]
  v_mfma_f32_16x16x32_bf16 v[88:91], v[248:251], v[20:23], v[88:91]
  v_mfma_f32_16x16x32_bf16 v[96:99], v[252:255], v[20:23], v[96:99]
  s_add_u32 s56, s56, 1
  s_nop 7
  v_cmp_u_f32 vcc, v80, v80
  s_cbranch_vccz redo_20_ok
  s_cmp_lt_u32 s56, 16
  s_cbranch_scc1 redo_20_c
  s_branch redo_20_ok
redo_21_s:
  s_mov_b32 s56, 0
redo_21_c:
  s_lshl_b32 s57, s34, 18
  s_add_u32 s57, s57, s39
  s_add_u32 s57, s57, 4194304
  s_mul_i32 s55, s3, 49152
  s_add_u32 s57, s57, s55
  buffer_load_dwordx4 v[132:135], v7, s[4:7], s57 offen offset:256 sc1
  buffer_load_dwordx4 v[128:131], v7, s[4:7], s57 offen offset:2304 sc1
  s_add_u32 s57, s57, 4096
  buffer_load_dwordx4 v[56:59], v7, s[4:7], s57 offen offset:256 sc1
  buffer_load_dwordx4 v[52:55], v7, s[4:7], s57 offen offset:2304 sc1
  s_add_u32 s57, s57, 12288
  buffer_load_dwordx4 v[44:47], v7, s[4:7], s57 offen offset:256 sc1
  buffer_load_dwordx4 v[24:27], v7, s[4:7], s57 offen offset:2304 sc1
  s_add_u32 s57, s57, 4096
  buffer_load_dwordx4 v[28:31], v7, s[4:7], s57 offen offset:256 sc1
  buffer_load_dwordx4 v[48:51], v7, s[4:7], s57 offen offset:2304 sc1
  s_add_u32 s57, s57, 12288
  buffer_load_dwordx4 v[60:63], v7, s[4:7], s57 offen offset:256 sc1
  buffer_load_dwordx4 v[124:127], v7, s[4:7], s57 offen offset:2304 sc1
  s_add_u32 s57, s57, 4096
  buffer_load_dwordx4 v[68:71], v7, s[4:7], s57 offen offset:256 sc1
  s_waitcnt vmcnt(0)
  v_mfma_f32_16x16x32_bf16 v[84:87], a[196:199], v[132:135], 0
  v_mfma_f32_16x16x32_bf16 v[92:95], a[200:203], v[132:135], 0
  v_mfma_f32_16x16x32_bf16 v[100:103], a[204:207], v[132:135], 0
  v_mfma_f32_16x16x32_bf16 v[76:79], a[192:195], v[132:135], 0
  v_mfma_f32_16x16x32_bf16 v[84:87], a[212:215], v[128:131], v[84:87]
  v_mfma_f32_16x16x32_bf16 v[92:95], a[216:219], v[128:131], v[92:95]
  v_mfma_f32_16x16x32_bf16 v[100:103], a[220:223], v[128:131], v[100:103]
  v_mfma_f32_16x16x32_bf16 v[76:79], a[208:211], v[128:131], v[76:79]
  v_mfma_f32_16x16x32_bf16 v[84:87], a[228:231], v[56:59], v[84:87]
  v_mfma_f32_16x16x32_bf16 v[92:95], a[232:235], v[56:59], v[92:95]
  v_mfma_f32_16x16x32_bf16 v[100:103], a[236:239], v[56:59], v[100:103]
  v_mfma_f32_16x16x32_bf16 v[76:79], a[224:227], v[56:59], v[76:79]
  v_mfma_f32_16x16x32_bf16 v[84:87], a[244:247], v[52:55], v[84:87]
  v_mfma_f32_16x16x32_bf16 v[92:95], a[248:251], v[52:55], v[92:95]
  v_mfma_f32_16x16x32_bf16 v[100:103], a[252:255], v[52:55], v[100:103]
  v_mfma_f32_16x16x32_bf16 v[76:79], a[240:243], v[52:55], v[76:79]
  v_mfma_f32_16x16x32_bf16 v[84:87], v[148:151], v[44:47], v[84:87]
  v_mfma_f32_16x16x32_bf16 v[92:95], v[152:155], v[44:47], v[92:95]
  v_mfma_f32_16x16x32_bf16 v[100:103], v[156:159], v[44:47], v[100:103]
  v_mfma_f32_16x16x32_bf16 v[76:79], v[144:147], v[44:47], v[76:79]
  v_mfma_f32_16x16x32_bf16 v[84:87], v[164:167], v[24:27], v[84:87]
  v_mfma_f32_16x16x32_bf16 v[92:95], v[168:171], v[24:27], v[92:95]
  v_mfma_f32_16x16x32_bf16 v[100:103], v[172:175], v[24:27], v[100:103]
  v_mfma_f32_16x16x32_bf16 v[84:87], v[180:183], v[28:31], v[84:87]
  v_mfma_f32_16x16x32_bf16 v[92:95], v[184:187], v[28:31], v[92:95]
  v_mfma_f32_16x16x32_bf16 v[100:103], v[188:191], v[28:31], v[100:103]
  v_mfma_f32_16x16x32_bf16 v[84:87], v[196:199], v[48:51], v[84:87]
  v_mfma_f32_16x16x32_bf16 v[92:95], v[200:203], v[48:51], v[92:95]
  v_mfma_f32_16x16x32_bf16 v[100:103], v[204:207], v[48:51], v[100:103]
  v_mfma_f32_16x16x32_bf16 v[84:87], v[212:215], v[60:63], v[84:87]
  v_mfma_f32_16x16x32_bf16 v[92:95], v[216:219], v[60:63], v[92:95]
  v_mfma_f32_16x16x32_bf16 v[100:103], v[220:223], v[60:63], v[100:103]
  v_mfma_f32_16x16x32_bf16 v[84:87], v[228:231], v[124:127], v[84:87]
  v_mfma_f32_16x16x32_bf16 v[92:95], v[232:235], v[124:127], v[92:95]
  v_mfma_f32_16x16x32_bf16 v[100:103], v[236:239], v[124:127], v[100:103]
  v_mfma_f32_16x16x32_bf16 v[84:87], v[244:247], v[68:71], v[84:87]
  v_mfma_f32_16x16x32_bf16 v[92:95], v[248:251], v[68:71], v[92:95]
  v_mfma_f32_16x16x32_bf16 v[100:103], v[252:255], v[68:71], v[100:103]
  s_add_u32 s56, s56, 1
  s_nop 7
  v_cmp_u_f32 vcc, v84, v84
  s_cbranch_vccz redo_21_ok
  s_cmp_lt_u32 s56, 16
  s_cbranch_scc1 redo_21_c
  s_branch redo_21_ok
mega_cend:
.section .rodata,"a"
.p2align 6
.amdhsa_kernel mega_kernel
  .amdhsa_next_free_vgpr 512
  .amdhsa_next_free_sgpr 102
  .amdhsa_accum_offset 256
  .amdhsa_group_segment_fixed_size 0
  .amdhsa_kernarg_size 112
  .amdhsa_user_sgpr_count 2
  .amdhsa_user_sgpr_kernarg_segment_ptr 1
  .amdhsa_system_sgpr_workgroup_id_x 1
.end_amdhsa_kernel
```
